```python
import torch

def _softmax(x, axis=-1):
    return torch.softmax(x, dim=axis)
def _gelu(x):
    return torch.nn.functional.gelu(x, approximate="tanh")
def _silu(x):
    return torch.nn.functional.silu(x)
def _sigmoid(x):
    return torch.sigmoid(x)
def _layernorm(x, axis=-1, eps=1e-5):
    m = x.mean(dim=axis, keepdim=True)
    v = x.var(dim=axis, keepdim=True, unbiased=False)
    return (x - m) / torch.sqrt(v + eps)
def _scatter_add(tgt, idx, src, axis=0):
    return tgt.clone().index_add_(axis, idx, src)
def _segment_sum(src, seg, n):
    out = torch.zeros((n,) + src.shape[1:], dtype=src.dtype)
    return out.index_add_(0, seg, src)
def _pad(x, pw):
    flat = tuple(v for pair in reversed(pw) for v in pair)
    return torch.nn.functional.pad(x, flat)

kernel_name = 'gated_mix__linear_kernel_hedgehog__dense_activation_mish__prompt'

def setup_inputs():

    _w = (lambda a: (lambda t: t.to(torch.bfloat16) if t.is_floating_point() else t)(torch.as_tensor(a)))
    def _A_setup():
        B, S, D, H = 1, 2048, 1024, 32
        Dh = D // H
        return {
            "x": _w((lambda *s: torch.randn(*s, dtype=torch.bfloat16) * 0.05)(B, S, D)),
            "wqkv": _w((lambda *s: torch.randn(*s, dtype=torch.bfloat16) * 0.8)(D, 3 * D)),
            "w_phi": _w((lambda *s: torch.randn(*s, dtype=torch.bfloat16) * 0.8)(H, Dh, Dh) * (Dh ** -0.5)),
            "wo": _w((lambda *s: torch.randn(*s, dtype=torch.bfloat16) * 0.05)(D, D)),
        }
    _A_in = _A_setup()

    def _B_setup():
        B, S, D, F = 1, 2048, 1024, 3584
        return {
            "x": _w((lambda *s: torch.randn(*s, dtype=torch.bfloat16) * 0.05)(B, S, D)),
            "w1": _w((lambda *s: torch.randn(*s, dtype=torch.bfloat16) * 12.8)(D, F) * (D ** -0.5)),
            "b1": _w((lambda *s: torch.randn(*s, dtype=torch.bfloat16) * 0.2)(F)),
            "w2": _w((lambda *s: torch.randn(*s, dtype=torch.bfloat16) * 0.1)(F, D) * (F ** -0.5)),
        }
    _B_in = _B_setup()

    return {
        "A_x": _A_in["x"],
        "A_wqkv": _A_in["wqkv"],
        "A_w_phi": _A_in["w_phi"],
        "A_wo": _A_in["wo"],
        "B_x": _B_in["x"],
        "B_w1": _B_in["w1"],
        "B_b1": _B_in["b1"],
        "B_w2": _B_in["w2"],
        "gate_w": _w((lambda *s: torch.randn(*s, dtype=torch.bfloat16) * 0.05)(1024) * 16.0),
    }

def reference(A_x, A_wqkv, A_w_phi, A_wo, B_x, B_w1, B_b1, B_w2, gate_w):
    def _A_ref(x, wqkv, w_phi, wo):
        B, S, D = x.shape
        H = 32; Dh = D // H
        qkv = (lambda x, *d: x.permute(*d))((x @ wqkv).reshape(B, S, 3, H, Dh), 2, 0, 3, 1, 4)
        q, k, v = qkv[0], qkv[1], qkv[2]
        pq = torch.einsum("bhsd,hdf->bhsf", q, w_phi)
        pk = torch.einsum("bhsd,hdf->bhsf", k, w_phi)
        phi_q = torch.concatenate([_softmax(pq, axis=-1), _softmax(-pq, axis=-1)], axis=-1)
        phi_k = torch.concatenate([_softmax(pk, axis=-1), _softmax(-pk, axis=-1)], axis=-1)
        kv = torch.einsum("bhsf,bhsd->bhfd", phi_k, v)
        z  = torch.einsum("bhsf->bhf", phi_k)
        num = torch.einsum("bhqf,bhfd->bhqd", phi_q, kv)
        den = torch.einsum("bhqf,bhf->bhq", phi_q, z)[..., None] + 1e-6
        o = num / den
        return (lambda x, *d: x.permute(*d))(o, 0, 2, 1, 3).reshape(B, S, D) @ wo

    def _B_ref(x, w1, b1, w2):
        h = torch.einsum("bsd,df->bsf", x, w1) + b1
        sp = torch.log1p(torch.exp(-torch.abs(h))) + torch.where(h > 0, h, torch.zeros_like(h))
        act = h * torch.tanh(sp)
        return torch.einsum("bsf,fd->bsd", act, w2)

    x = A_x
    g = _sigmoid((x * gate_w).sum(-1, keepdims=True))
    a = _A_ref(x, A_wqkv, A_w_phi, A_wo)
    b = _B_ref(x, B_w1, B_b1, B_w2)
    return g * a + (1 - g) * b
```

```asm
; @launch grid=(256,1,1) block=(512,1,1) lds=163840
.amdgcn_target "amdgcn-amd-amdhsa--gfx950"
.text
.globl gated_mix__linear_kernel_hedgehog__dense_activation_mish__prompt_kernel
.p2align 8
.type gated_mix__linear_kernel_hedgehog__dense_activation_mish__prompt_kernel,@function
gated_mix__linear_kernel_hedgehog__dense_activation_mish__prompt_kernel:
    s_cmp_ge_u32 s2, 256
    s_cbranch_scc1 L_end
    s_load_dwordx16 s[64:79], s[0:1], 0
    s_load_dwordx8 s[80:87], s[0:1], 64
    v_lshrrev_b32 v1, 6, v0
    v_and_b32 v0, 63, v0
    v_readfirstlane_b32 s3, v1
    v_lshlrev_b32_e64 v249, 4, v0
    s_bfe_u32 s5, s2, 65536
    s_lshl_b32 s5, s5, 3
    s_bfe_u32 s88, s2, 196611
    s_add_u32 s5, s5, s88
    s_bfe_u32 s6, s2, 131073
    s_lshl_b32 s6, s6, 2
    s_lshr_b32 s88, s2, 6
    s_add_u32 s6, s6, s88
    s_and_b32 s4, s3, 3
    s_lshl_b32 s56, s4, 12
    s_cmp_lt_u32 s3, 4
    s_cbranch_scc1 L_g0
    s_setprio 1
    s_and_b32 s59, s6, 12
    s_mov_b32 s89, s5
    s_sub_u32 s59, s89, s59
    s_mul_i32 s57, s4, 7168
    v_lshrrev_b32 v1, 3, v0
    v_and_b32 v2, 7, v0
    v_lshrrev_b32 v3, 4, v0
    v_xor_b32 v2, v2, v3
    s_lshl_b32 s92, s5, 2
    s_add_u32 s92, s92, s4
    s_lshl_b32 s92, s92, 16
    v_lshlrev_b32 v1, 11, v1
    v_add_u32 v1, s92, v1
    v_lshl_add_u32 v216, v2, 4, v1
    v_xor_b32_e64 v2, 4, v2
    v_lshl_add_u32 v2, v2, 4, v1
    v_add_u32 v217, 15360, v2
    v_add_u32 v218, 30720, v216
    v_add_u32 v219, 30720, v217
    s_mul_i32 s92, s4, 114688
    s_mul_i32 s91, s6, 448
    s_add_u32 s92, s92, s91
    s_movk_i32 s91, 6720
    v_mul_u32_u24 v1, 2341, v0
    v_add_u32_e64 v2, s92, v249
    s_and_b32 s59, s59, 15
    s_lshl_b32 s88, s59, 7
    s_mul_i32 s89, s59, 458752
    s_mov_b32 s10, 4194304
    s_mov_b32 s11, 0x20000
    s_mov_b32 s14, 7340032
    s_mov_b32 s15, 0x20000
    s_mov_b32 s46, 7168
    s_mov_b32 s47, 0x20000
    s_mul_i32 s90, s6, 448
    s_lshr_b32 s93, s56, 2
    s_add_u32 s93, s93, 143360
    s_mov_b32 m0, s93
    s_waitcnt lgkmcnt(0)
    s_mov_b32 s44, s76
    s_mov_b32 s45, s77
    buffer_load_dwordx4 v249, s[44:47], s90 offen offset:0 lds
    s_add_u32 m0, s56, 147456
    s_mov_b32 s8, s64
    s_mov_b32 s9, s65
    s_mov_b32 s12, s74
    s_mov_b32 s13, s75
    buffer_load_dwordx4 v216, s[8:11], s88 offen offset:0 lds
    v_lshrrev_b32 v3, 16, v1
    v_mad_u32_u24 v226, v3, s91, v2
    buffer_load_dwordx4 v217, s[8:11], s88 offen offset:1024 lds
    v_add_u32 v1, 149824, v1
    v_lshrrev_b32_e64 v3, 16, v1
    v_mad_u32_u24 v227, v3, s91, v2
    buffer_load_dwordx4 v218, s[8:11], s88 offen offset:2048 lds
    v_add_u32 v1, 149824, v1
    v_lshrrev_b32_e64 v3, 16, v1
    v_mad_u32_u24 v228, v3, s91, v2
    buffer_load_dwordx4 v219, s[8:11], s88 offen offset:3072 lds
    v_and_b32 v4, 32, v0
    v_xor_b32 v4, v4, v2
    v_add_u32 v1, 149824, v1
    v_lshrrev_b32_e64 v3, 16, v1
    v_mad_u32_u24 v229, v3, s91, v4
    s_add_u32 m0, s57, 16384
    s_nop 0
    buffer_load_dwordx4 v226, s[12:15], s89 offen offset:0 lds
    v_xor_b32 v2, 32, v2
    v_add_u32 v2, 4096, v2
    v_add_u32 v1, 149824, v1
    v_lshrrev_b32_e64 v3, 16, v1
    v_mad_u32_u24 v230, v3, s91, v2
    buffer_load_dwordx4 v227, s[12:15], s89 offen offset:1024 lds
    v_add_u32 v1, 149824, v1
    v_lshrrev_b32_e64 v3, 16, v1
    v_mad_u32_u24 v231, v3, s91, v2
    buffer_load_dwordx4 v228, s[12:15], s89 offen offset:2048 lds
    v_add_u32 v1, 149824, v1
    v_lshrrev_b32_e64 v3, 16, v1
    v_mad_u32_u24 v232, v3, s91, v2
    buffer_load_dwordx4 v229, s[12:15], s89 offen offset:3072 lds
    s_add_u32 m0, s57, 20480
    s_nop 0
    buffer_load_dwordx4 v230, s[12:15], s89 offen offset:0 lds
    buffer_load_dwordx4 v231, s[12:15], s89 offen offset:1024 lds
    buffer_load_dwordx4 v232, s[12:15], s89 offen offset:2048 lds
    s_lshr_b32 s7, s6, 3
    s_and_b32 s54, s6, 7
    s_lshl_b32 s55, s5, 4
    s_add_u32 s55, s55, s6
    s_lshr_b32 s52, s4, 1
    s_and_b32 s53, s4, 1
    s_mul_i32 s58, s4, 6144
    s_and_b32 s60, s5, 7
    s_mul_i32 s60, s60, 7
    s_and_b32 s62, s5, 15
    s_mul_i32 s62, s62, 2
    s_add_u32 s62, s62, s52
    s_xor_b32 s61, s6, 4
    s_mov_b32 s96, 0x3fb8aa3b
    s_mov_b32 s97, 0xbfb8aa3b
    s_mov_b32 s16, s66
    s_mov_b32 s17, s67
    s_mov_b32 s18, 6291456
    s_mov_b32 s19, 0x20000
    s_mov_b32 s24, s70
    s_mov_b32 s25, s71
    s_mov_b32 s26, 2097152
    s_mov_b32 s27, 0x20000
    s_mov_b32 s28, s86
    s_mov_b32 s29, s87
    s_mov_b32 s30, 28483584
    s_mov_b32 s31, 0x20000
    s_mov_b32 s40, s68
    s_mov_b32 s41, s69
    s_mov_b32 s42, 65536
    s_mov_b32 s43, 0x20000
    s_mov_b32 s48, s80
    s_mov_b32 s49, s81
    s_mov_b32 s50, 2048
    s_mov_b32 s51, 0x20000
    s_lshl_b32 s91, s55, 3
    s_lshl_b32 s92, s4, 1
    s_add_u32 s91, s91, s92
    s_lshl_b32 s91, s91, 11
    v_add_u32 v185, s91, v249
    v_lshrrev_b32_e64 v1, 3, v0
    v_bfe_u32 v2, v0, 1, 2
    v_bfe_u32 v3, v0, 4, 1
    v_xor_b32 v2, v2, v3
    v_and_b32 v3, 1, v0
    v_mul_u32_u24 v1, 6144, v1
    v_lshl_add_u32 v1, v3, 4, v1
    s_mul_i32 s92, s4, 98304
    s_xor_b32 s91, s6, 0
    s_lshl_b32 s91, s91, 7
    s_add_u32 s92, s92, s91
    v_add_u32 v1, s92, v1
    v_lshl_add_u32 v220, v2, 5, v1
    v_xor_b32_e64 v2, 2, v2
    v_lshl_add_u32 v2, v2, 5, v1
    v_add_u32 v223, 49152, v2
    v_add_u32 v221, 1024, v220
    v_add_u32 v224, 1024, v223
    v_add_u32 v222, 2048, v220
    v_add_u32 v225, 2048, v223
    s_sub_u32 s91, s61, s6
    s_lshl_b32 s91, s91, 7
    v_add_u32 v220, s91, v220
    v_add_u32 v223, s91, v223
    v_and_b32 v1, 15, v0
    v_lshrrev_b32 v2, 4, v0
    v_bfe_u32 v3, v0, 2, 2
    v_and_b32 v4, 3, v0
    v_lshrrev_b32 v5, 1, v1
    v_xor_b32 v5, v5, v2
    v_lshlrev_b32 v5, 4, v5
    v_lshl_add_u32 v5, v1, 7, v5
    s_lshl_b32 s92, s52, 13
    s_add_u32 s92, s92, 0
    v_add_u32 v239, s92, v5
    v_xor_b32 v5, 64, v5
    v_add_u32_e64 v240, s92, v5
    v_mul_u32_u24 v5, 3072, v2
    v_lshl_add_u32 v5, v3, 7, v5
    v_lshl_add_u32 v5, v4, 3, v5
    v_add_u32 v5, 16384, v5
    v_and_b32 v6, 1, v2
    v_lshlrev_b32 v6, 1, v6
    v_lshrrev_b32 v7, 1, v3
    v_or_b32 v6, v6, v7
    s_lshl_b32 s92, s53, 1
    s_add_u32 s92, s92, 0
    v_xor_b32_e64 v7, s92, v6
    v_lshl_add_u32 v241, v7, 5, v5
    s_lshl_b32 s92, s53, 1
    s_add_u32 s92, s92, 1
    v_xor_b32_e64 v7, s92, v6
    v_lshl_add_u32 v242, v7, 5, v5
    s_lshl_b32 s92, s5, 1
    s_add_u32 s92, s92, s52
    s_lshl_b32 s93, s6, 1
    s_add_u32 s93, s93, s53
    s_lshl_b32 s91, s93, 8
    s_add_u32 s91, s91, s92
    s_lshl_b32 s91, s91, 9
    s_add_u32 s91, s91, 23068672
    v_lshrrev_b32 v1, 5, v0
    v_and_b32 v2, 31, v0
    v_lshlrev_b32 v2, 4, v2
    v_lshl_add_u32 v2, v1, 14, v2
    v_add_u32 v124, s91, v2
    s_lshl_b32 s91, s93, 5
    s_add_u32 s91, s91, s92
    s_lshl_b32 s91, s91, 8
    s_add_u32 s91, s91, 27262976
    v_and_b32 v3, 15, v0
    v_lshrrev_b32 v4, 4, v0
    v_lshlrev_b32 v5, 5, v4
    v_and_b32 v6, 1, v0
    v_lshl_add_u32 v5, v6, 4, v5
    v_and_b32_e64 v6, 2, v0
    v_lshl_add_u32 v5, v6, 6, v5
    v_add_u32 v5, s91, v5
    v_cmp_gt_u32 vcc, 4, v3
    v_mov_b32 v7, 1073741824
    s_nop 0
    v_cndmask_b32 v125, v7, v5, vcc
    s_lshl_b32 s91, s6, 4
    s_add_u32 s91, s91, s5
    s_lshl_b32 s92, s91, 2
    s_add_u32 s92, s92, s4
    s_lshl_b32 s92, s92, 7
    s_add_u32 s92, s92, 27525120
    v_lshlrev_b32_e64 v5, 4, v3
    v_lshl_add_u32 v5, v4, 3, v5
    v_add_u32 v5, s92, v5
    v_and_b32 v6, 40, v0
    v_cmp_eq_u32 vcc, 0, v6
    s_lshl_b32 s91, s91, 5
    s_add_u32 s91, s91, s4
    v_cndmask_b32_e64 v126, v7, v5, vcc
    s_lshl_b32 s91, s91, 2
    s_add_u32 s91, s91, 27656192
    v_cmp_eq_u32 vcc, 0, v0
    v_mov_b32 v4, s91
    s_nop 0
    v_cndmask_b32_e64 v127, v7, v4, vcc
    s_lshl_b32 s91, s6, 4
    s_add_u32 s91, s91, s5
    s_lshl_b32 s93, s91, 14
    s_lshl_b32 s92, s4, 7
    s_add_u32 s93, s93, s92
    s_add_u32 s93, s93, 23068672
    v_and_b32 v1, 7, v0
    v_lshrrev_b32 v2, 3, v0
    v_lshlrev_b32_e64 v2, 9, v2
    v_lshl_add_u32 v2, v1, 4, v2
    v_add_u32 v12, s93, v2
    s_lshr_b32 s91, s91, 3
    s_lshl_b32 s91, s91, 13
    s_and_b32 s92, s5, 7
    s_lshl_b32 s92, s92, 5
    s_add_u32 s91, s91, s92
    s_lshl_b32 s92, s4, 3
    s_add_u32 s91, s91, s92
    s_add_u32 s91, s91, 27262976
    v_and_b32 v1, 31, v0
    v_lshlrev_b32 v1, 8, v1
    v_add_u32_e64 v13, s91, v1
    s_mul_i32 s91, s5, 144
    s_lshl_b32 s92, s61, 1
    s_add_u32 s91, s91, s92
    s_add_u32 s91, s91, s53
    s_add_u32 s91, s91, 112
    s_lshl_b32 s91, s91, 13
    s_lshl_b32 s92, s52, 12
    s_add_u32 s91, s91, s92
    v_add_u32_e64 v15, s91, v249
    s_waitcnt vmcnt(11)
    s_barrier
    s_add_u32 s88, s59, 1
    s_and_b32 s88, s88, 15
    s_add_u32 m0, s56, 45056
    s_lshl_b32 s88, s88, 7
    buffer_load_dwordx4 v216, s[8:11], s88 offen offset:0 lds
    buffer_load_dwordx4 v217, s[8:11], s88 offen offset:1024 lds
    buffer_load_dwordx4 v218, s[8:11], s88 offen offset:2048 lds
    buffer_load_dwordx4 v219, s[8:11], s88 offen offset:3072 lds
    s_add_u32 s59, s59, 1
    s_and_b32 s59, s59, 15
    s_lshl_b32 s88, s59, 7
    s_mul_i32 s89, s59, 458752
    s_add_u32 m0, s57, 61440
    s_nop 0
    buffer_load_dwordx4 v226, s[12:15], s89 offen offset:0 lds
    buffer_load_dwordx4 v227, s[12:15], s89 offen offset:1024 lds
    buffer_load_dwordx4 v228, s[12:15], s89 offen offset:2048 lds
    buffer_load_dwordx4 v229, s[12:15], s89 offen offset:3072 lds
    s_waitcnt vmcnt(8)
    s_barrier
    s_add_u32 m0, s57, 65536
    s_nop 0
    buffer_load_dwordx4 v230, s[12:15], s89 offen offset:0 lds
    buffer_load_dwordx4 v231, s[12:15], s89 offen offset:1024 lds
    buffer_load_dwordx4 v232, s[12:15], s89 offen offset:2048 lds
    s_add_u32 s88, s59, 1
    s_and_b32 s88, s88, 15
    s_add_u32 m0, s56, 90112
    s_lshl_b32 s88, s88, 7
    buffer_load_dwordx4 v216, s[8:11], s88 offen offset:0 lds
    buffer_load_dwordx4 v217, s[8:11], s88 offen offset:1024 lds
    buffer_load_dwordx4 v218, s[8:11], s88 offen offset:2048 lds
    buffer_load_dwordx4 v219, s[8:11], s88 offen offset:3072 lds
    s_add_u32 s88, s59, 2
    s_and_b32 s88, s88, 15
    s_add_u32 m0, s56, 0
    s_lshl_b32 s88, s88, 7
    buffer_load_dwordx4 v216, s[8:11], s88 offen offset:0 lds
    buffer_load_dwordx4 v217, s[8:11], s88 offen offset:1024 lds
    buffer_load_dwordx4 v218, s[8:11], s88 offen offset:2048 lds
    buffer_load_dwordx4 v219, s[8:11], s88 offen offset:3072 lds
    s_add_u32 s59, s59, 1
    s_and_b32 s59, s59, 15
    s_lshl_b32 s88, s59, 7
    s_mul_i32 s89, s59, 458752
    s_add_u32 m0, s57, 106496
    s_nop 0
    buffer_load_dwordx4 v226, s[12:15], s89 offen offset:0 lds
    s_waitcnt vmcnt(9)
    s_barrier
    buffer_load_dwordx4 v227, s[12:15], s89 offen offset:1024 lds
    buffer_load_dwordx4 v228, s[12:15], s89 offen offset:2048 lds
    buffer_load_dwordx4 v229, s[12:15], s89 offen offset:3072 lds
    s_add_u32 m0, s57, 110592
    s_nop 0
    buffer_load_dwordx4 v230, s[12:15], s89 offen offset:0 lds
    buffer_load_dwordx4 v231, s[12:15], s89 offen offset:1024 lds
    buffer_load_dwordx4 v232, s[12:15], s89 offen offset:2048 lds
    s_add_u32 s59, s59, 1
    s_and_b32 s59, s59, 15
    s_lshl_b32 s88, s59, 7
    s_mul_i32 s89, s59, 458752
    s_add_u32 m0, s57, 16384
    s_nop 0
    buffer_load_dwordx4 v226, s[12:15], s89 offen offset:0 lds
    buffer_load_dwordx4 v227, s[12:15], s89 offen offset:1024 lds
    buffer_load_dwordx4 v228, s[12:15], s89 offen offset:2048 lds
    buffer_load_dwordx4 v229, s[12:15], s89 offen offset:3072 lds
    s_waitcnt vmcnt(4)
    s_barrier
    s_add_u32 m0, s57, 20480
    s_nop 0
    buffer_load_dwordx4 v230, s[12:15], s89 offen offset:0 lds
    buffer_load_dwordx4 v231, s[12:15], s89 offen offset:1024 lds
    buffer_load_dwordx4 v232, s[12:15], s89 offen offset:2048 lds
    s_add_u32 s59, s59, 1
    s_and_b32 s59, s59, 15
    s_lshl_b32 s88, s59, 7
    s_add_u32 m0, s56, 45056
    s_mul_i32 s89, s59, 458752
    buffer_load_dwordx4 v216, s[8:11], s88 offen offset:0 lds
    buffer_load_dwordx4 v217, s[8:11], s88 offen offset:1024 lds
    buffer_load_dwordx4 v218, s[8:11], s88 offen offset:2048 lds
    buffer_load_dwordx4 v219, s[8:11], s88 offen offset:3072 lds
    s_add_u32 m0, s57, 61440
    s_nop 0
    buffer_load_dwordx4 v226, s[12:15], s89 offen offset:0 lds
    buffer_load_dwordx4 v227, s[12:15], s89 offen offset:1024 lds
    buffer_load_dwordx4 v228, s[12:15], s89 offen offset:2048 lds
    buffer_load_dwordx4 v229, s[12:15], s89 offen offset:3072 lds
    s_waitcnt vmcnt(8)
    s_barrier
    s_add_u32 m0, s57, 65536
    s_nop 0
    buffer_load_dwordx4 v230, s[12:15], s89 offen offset:0 lds
    buffer_load_dwordx4 v231, s[12:15], s89 offen offset:1024 lds
    buffer_load_dwordx4 v232, s[12:15], s89 offen offset:2048 lds
    s_add_u32 s59, s59, 1
    s_and_b32 s59, s59, 15
    s_lshl_b32 s88, s59, 7
    s_add_u32 m0, s56, 90112
    s_mul_i32 s89, s59, 458752
    buffer_load_dwordx4 v216, s[8:11], s88 offen offset:0 lds
    buffer_load_dwordx4 v217, s[8:11], s88 offen offset:1024 lds
    buffer_load_dwordx4 v218, s[8:11], s88 offen offset:2048 lds
    buffer_load_dwordx4 v219, s[8:11], s88 offen offset:3072 lds
    s_add_u32 m0, s57, 106496
    s_nop 0
    buffer_load_dwordx4 v226, s[12:15], s89 offen offset:0 lds
    buffer_load_dwordx4 v227, s[12:15], s89 offen offset:1024 lds
    buffer_load_dwordx4 v228, s[12:15], s89 offen offset:2048 lds
    buffer_load_dwordx4 v229, s[12:15], s89 offen offset:3072 lds
    s_waitcnt vmcnt(8)
    s_barrier
    s_add_u32 m0, s57, 110592
    s_nop 0
    buffer_load_dwordx4 v230, s[12:15], s89 offen offset:0 lds
    buffer_load_dwordx4 v231, s[12:15], s89 offen offset:1024 lds
    buffer_load_dwordx4 v232, s[12:15], s89 offen offset:2048 lds
    s_add_u32 s59, s59, 1
    s_and_b32 s59, s59, 15
    s_lshl_b32 s88, s59, 7
    s_add_u32 m0, s56, 0
    s_mul_i32 s89, s59, 458752
    buffer_load_dwordx4 v216, s[8:11], s88 offen offset:0 lds
    buffer_load_dwordx4 v217, s[8:11], s88 offen offset:1024 lds
    buffer_load_dwordx4 v218, s[8:11], s88 offen offset:2048 lds
    buffer_load_dwordx4 v219, s[8:11], s88 offen offset:3072 lds
    s_add_u32 m0, s57, 16384
    s_nop 0
    buffer_load_dwordx4 v226, s[12:15], s89 offen offset:0 lds
    buffer_load_dwordx4 v227, s[12:15], s89 offen offset:1024 lds
    buffer_load_dwordx4 v228, s[12:15], s89 offen offset:2048 lds
    buffer_load_dwordx4 v229, s[12:15], s89 offen offset:3072 lds
    s_waitcnt vmcnt(8)
    s_barrier
    s_add_u32 m0, s57, 20480
    s_nop 0
    buffer_load_dwordx4 v230, s[12:15], s89 offen offset:0 lds
    buffer_load_dwordx4 v231, s[12:15], s89 offen offset:1024 lds
    buffer_load_dwordx4 v232, s[12:15], s89 offen offset:2048 lds
    s_add_u32 s59, s59, 1
    s_and_b32 s59, s59, 15
    s_lshl_b32 s88, s59, 7
    s_add_u32 m0, s56, 45056
    s_mul_i32 s89, s59, 458752
    buffer_load_dwordx4 v216, s[8:11], s88 offen offset:0 lds
    buffer_load_dwordx4 v217, s[8:11], s88 offen offset:1024 lds
    buffer_load_dwordx4 v218, s[8:11], s88 offen offset:2048 lds
    buffer_load_dwordx4 v219, s[8:11], s88 offen offset:3072 lds
    s_add_u32 m0, s57, 61440
    s_nop 0
    buffer_load_dwordx4 v226, s[12:15], s89 offen offset:0 lds
    buffer_load_dwordx4 v227, s[12:15], s89 offen offset:1024 lds
    buffer_load_dwordx4 v228, s[12:15], s89 offen offset:2048 lds
    buffer_load_dwordx4 v229, s[12:15], s89 offen offset:3072 lds
    s_waitcnt vmcnt(8)
    s_branch L_g1b
.p2align 12
L_g1b:
L_walka_0:
    s_cbranch_execz L_walkeda
    s_nop 0
    s_barrier
    s_add_u32 m0, s57, 65536
    s_nop 0
    buffer_load_dwordx4 v230, s[12:15], s89 offen offset:0 lds
    buffer_load_dwordx4 v231, s[12:15], s89 offen offset:1024 lds
    buffer_load_dwordx4 v232, s[12:15], s89 offen offset:2048 lds
    s_add_u32 s59, s59, 1
    s_and_b32 s59, s59, 15
    s_lshl_b32 s88, s59, 7
    s_add_u32 m0, s56, 90112
    s_mul_i32 s89, s59, 458752
    buffer_load_dwordx4 v216, s[8:11], s88 offen offset:0 lds
    buffer_load_dwordx4 v217, s[8:11], s88 offen offset:1024 lds
    buffer_load_dwordx4 v218, s[8:11], s88 offen offset:2048 lds
    buffer_load_dwordx4 v219, s[8:11], s88 offen offset:3072 lds
    s_add_u32 m0, s57, 106496
    s_nop 0
    buffer_load_dwordx4 v226, s[12:15], s89 offen offset:0 lds
    buffer_load_dwordx4 v227, s[12:15], s89 offen offset:1024 lds
    buffer_load_dwordx4 v228, s[12:15], s89 offen offset:2048 lds
    buffer_load_dwordx4 v229, s[12:15], s89 offen offset:3072 lds
    s_waitcnt vmcnt(8)
    s_barrier
    s_add_u32 m0, s57, 110592
    s_nop 0
    buffer_load_dwordx4 v230, s[12:15], s89 offen offset:0 lds
    buffer_load_dwordx4 v231, s[12:15], s89 offen offset:1024 lds
    buffer_load_dwordx4 v232, s[12:15], s89 offen offset:2048 lds
    s_add_u32 s59, s59, 1
    s_and_b32 s59, s59, 15
    s_lshl_b32 s88, s59, 7
    s_add_u32 m0, s56, 0
    s_mul_i32 s89, s59, 458752
    buffer_load_dwordx4 v216, s[8:11], s88 offen offset:0 lds
    buffer_load_dwordx4 v217, s[8:11], s88 offen offset:1024 lds
    buffer_load_dwordx4 v218, s[8:11], s88 offen offset:2048 lds
    buffer_load_dwordx4 v219, s[8:11], s88 offen offset:3072 lds
    s_add_u32 m0, s57, 16384
    s_nop 0
    buffer_load_dwordx4 v226, s[12:15], s89 offen offset:0 lds
    buffer_load_dwordx4 v227, s[12:15], s89 offen offset:1024 lds
    buffer_load_dwordx4 v228, s[12:15], s89 offen offset:2048 lds
    buffer_load_dwordx4 v229, s[12:15], s89 offen offset:3072 lds
    s_waitcnt vmcnt(8)
    s_barrier
    s_add_u32 m0, s57, 20480
    s_nop 0
    buffer_load_dwordx4 v230, s[12:15], s89 offen offset:0 lds
    buffer_load_dwordx4 v231, s[12:15], s89 offen offset:1024 lds
    buffer_load_dwordx4 v232, s[12:15], s89 offen offset:2048 lds
    s_add_u32 s59, s59, 1
    s_and_b32 s59, s59, 15
    s_lshl_b32 s88, s59, 7
    s_add_u32 m0, s56, 45056
    s_mul_i32 s89, s59, 458752
    buffer_load_dwordx4 v216, s[8:11], s88 offen offset:0 lds
    buffer_load_dwordx4 v217, s[8:11], s88 offen offset:1024 lds
    buffer_load_dwordx4 v218, s[8:11], s88 offen offset:2048 lds
    buffer_load_dwordx4 v219, s[8:11], s88 offen offset:3072 lds
    s_add_u32 m0, s57, 61440
    s_nop 0
    buffer_load_dwordx4 v226, s[12:15], s89 offen offset:0 lds
    buffer_load_dwordx4 v227, s[12:15], s89 offen offset:1024 lds
    buffer_load_dwordx4 v228, s[12:15], s89 offen offset:2048 lds
    buffer_load_dwordx4 v229, s[12:15], s89 offen offset:3072 lds
    s_waitcnt vmcnt(8)
    s_barrier
    s_add_u32 m0, s57, 65536
    s_nop 0
    buffer_load_dwordx4 v230, s[12:15], s89 offen offset:0 lds
    buffer_load_dwordx4 v231, s[12:15], s89 offen offset:1024 lds
    buffer_load_dwordx4 v232, s[12:15], s89 offen offset:2048 lds
    s_add_u32 s59, s59, 1
    s_and_b32 s59, s59, 15
    s_lshl_b32 s88, s59, 7
    s_add_u32 m0, s56, 90112
    s_mul_i32 s89, s59, 458752
    buffer_load_dwordx4 v216, s[8:11], s88 offen offset:0 lds
    buffer_load_dwordx4 v217, s[8:11], s88 offen offset:1024 lds
    buffer_load_dwordx4 v218, s[8:11], s88 offen offset:2048 lds
    buffer_load_dwordx4 v219, s[8:11], s88 offen offset:3072 lds
    s_add_u32 m0, s57, 106496
    s_nop 0
    buffer_load_dwordx4 v226, s[12:15], s89 offen offset:0 lds
    buffer_load_dwordx4 v227, s[12:15], s89 offen offset:1024 lds
    buffer_load_dwordx4 v228, s[12:15], s89 offen offset:2048 lds
    buffer_load_dwordx4 v229, s[12:15], s89 offen offset:3072 lds
    buffer_load_dwordx4 v[176:179], v249, s[48:51], 0 offen offset:0
    buffer_load_dwordx4 v[180:183], v249, s[48:51], 0 offen offset:1024
    s_waitcnt vmcnt(10)
    s_barrier
    s_add_u32 m0, s57, 110592
    s_nop 0
    buffer_load_dwordx4 v230, s[12:15], s89 offen offset:0 lds
    ds_read_b128 v[88:91], v239 offset:45056
    buffer_load_dwordx4 v231, s[12:15], s89 offen offset:1024 lds
    ds_read_b128 v[92:95], v240 offset:45056
    buffer_load_dwordx4 v232, s[12:15], s89 offen offset:2048 lds
    s_add_u32 s59, s59, 1
    s_and_b32 s59, s59, 15
    s_lshl_b32 s88, s59, 7
    s_add_u32 m0, s56, 0
    s_mul_i32 s89, s59, 458752
    buffer_load_dwordx4 v216, s[8:11], s88 offen offset:0 lds
    ds_read_b128 v[96:99], v239 offset:47104
    buffer_load_dwordx4 v217, s[8:11], s88 offen offset:1024 lds
    ds_read_b128 v[100:103], v240 offset:47104
    buffer_load_dwordx4 v218, s[8:11], s88 offen offset:2048 lds
    buffer_load_dwordx4 v219, s[8:11], s88 offen offset:3072 lds
    ds_read_b128 v[104:107], v239 offset:49152
    s_add_u32 m0, s57, 16384
    s_nop 0
    buffer_load_dwordx4 v226, s[12:15], s89 offen offset:0 lds
    buffer_load_dwordx4 v227, s[12:15], s89 offen offset:1024 lds
    ds_read_b128 v[108:111], v240 offset:49152
    buffer_load_dwordx4 v228, s[12:15], s89 offen offset:2048 lds
    ds_read_b128 v[4:7], v239 offset:51200
    buffer_load_dwordx4 v229, s[12:15], s89 offen offset:3072 lds
    ds_read_b128 v[244:247], v240 offset:51200
    buffer_load_dwordx4 v[160:163], v185, s[8:11], 0 offen offset:0
    buffer_load_dwordx4 v[164:167], v185, s[8:11], 0 offen offset:1024
    s_waitcnt vmcnt(10) lgkmcnt(0)
    s_barrier
    s_add_u32 m0, s57, 20480
    s_nop 0
    buffer_load_dwordx4 v230, s[12:15], s89 offen offset:0 lds
    v_add_u32 v2, 90112, v239
    v_add_u32 v3, 90112, v240
    buffer_load_dwordx4 v231, s[12:15], s89 offen offset:1024 lds
    ds_read_b128 v[112:115], v2 offset:0
    buffer_load_dwordx4 v232, s[12:15], s89 offen offset:2048 lds
    ds_read_b128 v[116:119], v3 offset:0
    s_add_u32 s59, s59, 1
    s_and_b32 s59, s59, 15
    s_lshl_b32 s88, s59, 7
    s_add_u32 m0, s56, 45056
    s_mul_i32 s89, s59, 458752
    buffer_load_dwordx4 v216, s[8:11], s88 offen offset:0 lds
    buffer_load_dwordx4 v217, s[8:11], s88 offen offset:1024 lds
    ds_read_b128 v[8:11], v2 offset:2048
    buffer_load_dwordx4 v218, s[8:11], s88 offen offset:2048 lds
    ds_read_b128 v[120:123], v3 offset:2048
    buffer_load_dwordx4 v219, s[8:11], s88 offen offset:3072 lds
    s_add_u32 m0, s57, 61440
    s_nop 0
    buffer_load_dwordx4 v226, s[12:15], s89 offen offset:0 lds
    ds_read_b128 v[208:211], v2 offset:4096
    buffer_load_dwordx4 v227, s[12:15], s89 offen offset:1024 lds
    ds_read_b128 v[212:215], v3 offset:4096
    buffer_load_dwordx4 v228, s[12:15], s89 offen offset:2048 lds
    buffer_load_dwordx4 v229, s[12:15], s89 offen offset:3072 lds
    ds_read_b128 v[250:253], v2 offset:6144
    ds_read_b128 v[234:237], v3 offset:6144
    buffer_load_dwordx4 v[168:171], v185, s[8:11], 0 offen offset:2048
    buffer_load_dwordx4 v[172:175], v185, s[8:11], 0 offen offset:3072
    s_waitcnt vmcnt(10) lgkmcnt(0)
    s_barrier
    s_add_u32 m0, s57, 65536
    s_nop 0
    buffer_load_dwordx4 v230, s[12:15], s89 offen offset:0 lds
    ds_read_b128 v[128:131], v239 offset:0
    buffer_load_dwordx4 v231, s[12:15], s89 offen offset:1024 lds
    ds_read_b128 v[132:135], v240 offset:0
    buffer_load_dwordx4 v232, s[12:15], s89 offen offset:2048 lds
    s_add_u32 s59, s59, 1
    s_and_b32 s59, s59, 15
    s_lshl_b32 s88, s59, 7
    s_add_u32 m0, s56, 90112
    s_mul_i32 s89, s59, 458752
    buffer_load_dwordx4 v216, s[8:11], s88 offen offset:0 lds
    ds_read_b128 v[136:139], v239 offset:2048
    buffer_load_dwordx4 v217, s[8:11], s88 offen offset:1024 lds
    ds_read_b128 v[140:143], v240 offset:2048
    buffer_load_dwordx4 v218, s[8:11], s88 offen offset:2048 lds
    buffer_load_dwordx4 v219, s[8:11], s88 offen offset:3072 lds
    ds_read_b128 v[144:147], v239 offset:4096
    s_add_u32 m0, s57, 106496
    s_nop 0
    buffer_load_dwordx4 v226, s[12:15], s89 offen offset:0 lds
    buffer_load_dwordx4 v227, s[12:15], s89 offen offset:1024 lds
    ds_read_b128 v[148:151], v240 offset:4096
    buffer_load_dwordx4 v228, s[12:15], s89 offen offset:2048 lds
    ds_read_b128 v[152:155], v239 offset:6144
    buffer_load_dwordx4 v229, s[12:15], s89 offen offset:3072 lds
    ds_read_b128 v[156:159], v240 offset:6144
    s_cmp_lg_u32 s4, 0
    s_cbranch_scc1 L_w0_1
    s_lshl_b32 s91, s55, 7
    s_add_u32 s91, s91, 27697152
    v_lshlrev_b32 v192, 15, v0
    v_cmp_gt_u32 vcc, 7, v0
    v_mov_b32 v193, 0
    v_mov_b32 v194, 1073741824
    v_cndmask_b32 v192, v194, v192, vcc
    buffer_store_dword v193, v192, s[28:31], s91 offen sc1
L_w0_1:
    s_waitcnt vmcnt(8) lgkmcnt(0)
    s_barrier
    s_add_u32 m0, s57, 110592
    s_nop 0
    buffer_load_dwordx4 v230, s[12:15], s89 offen offset:0 lds
    v_mov_b32 v186, 0
    v_mov_b32 v187, 0
    v_lshlrev_b32 v188, 16, v176
    v_and_b32 v189, 0xffff0000, v176
    v_lshlrev_b32_e64 v190, 16, v160
    v_and_b32 v191, 0xffff0000, v160
    buffer_load_dwordx4 v231, s[12:15], s89 offen offset:1024 lds
    v_fmac_f32 v186, v188, v190
    v_fmac_f32 v186, v189, v191
    v_lshlrev_b32_e64 v190, 16, v168
    v_and_b32 v191, 0xffff0000, v168
    buffer_load_dwordx4 v232, s[12:15], s89 offen offset:2048 lds
    v_fmac_f32 v187, v188, v190
    v_fmac_f32 v187, v189, v191
    v_lshlrev_b32_e64 v188, 16, v177
    v_and_b32 v189, 0xffff0000, v177
    s_add_u32 s59, s59, 1
    s_and_b32 s59, s59, 15
    s_lshl_b32 s88, s59, 7
    s_add_u32 m0, s56, 0
    s_mul_i32 s89, s59, 458752
    buffer_load_dwordx4 v216, s[8:11], s88 offen offset:0 lds
    v_lshlrev_b32_e64 v190, 16, v161
    v_and_b32 v191, 0xffff0000, v161
    v_fmac_f32 v186, v188, v190
    v_fmac_f32 v186, v189, v191
    buffer_load_dwordx4 v217, s[8:11], s88 offen offset:1024 lds
    v_lshlrev_b32_e64 v190, 16, v169
    v_and_b32 v191, 0xffff0000, v169
    v_fmac_f32 v187, v188, v190
    v_fmac_f32 v187, v189, v191
    buffer_load_dwordx4 v218, s[8:11], s88 offen offset:2048 lds
    v_lshlrev_b32_e64 v188, 16, v178
    v_and_b32 v189, 0xffff0000, v178
    v_lshlrev_b32_e64 v190, 16, v162
    v_and_b32 v191, 0xffff0000, v162
    buffer_load_dwordx4 v219, s[8:11], s88 offen offset:3072 lds
    v_fmac_f32 v186, v188, v190
    v_fmac_f32 v186, v189, v191
    v_lshlrev_b32_e64 v190, 16, v170
    v_and_b32 v191, 0xffff0000, v170
    v_fmac_f32 v187, v188, v190
    v_fmac_f32 v187, v189, v191
    s_add_u32 m0, s57, 16384
    s_nop 0
    buffer_load_dwordx4 v226, s[12:15], s89 offen offset:0 lds
    v_lshlrev_b32 v188, 16, v179
    v_and_b32 v189, 0xffff0000, v179
    v_lshlrev_b32_e64 v190, 16, v163
    v_and_b32 v191, 0xffff0000, v163
    buffer_load_dwordx4 v227, s[12:15], s89 offen offset:1024 lds
    v_fmac_f32 v186, v188, v190
    v_fmac_f32 v186, v189, v191
    v_lshlrev_b32_e64 v190, 16, v171
    v_and_b32 v191, 0xffff0000, v171
    buffer_load_dwordx4 v228, s[12:15], s89 offen offset:2048 lds
    v_fmac_f32 v187, v188, v190
    v_fmac_f32 v187, v189, v191
    v_lshlrev_b32_e64 v188, 16, v180
    v_and_b32 v189, 0xffff0000, v180
    buffer_load_dwordx4 v229, s[12:15], s89 offen offset:3072 lds
    v_lshlrev_b32_e64 v190, 16, v164
    v_and_b32 v191, 0xffff0000, v164
    v_fmac_f32 v186, v188, v190
    v_fmac_f32 v186, v189, v191
    v_lshlrev_b32_e64 v190, 16, v172
    v_and_b32 v191, 0xffff0000, v172
    v_fmac_f32 v187, v188, v190
    v_fmac_f32 v187, v189, v191
    v_lshlrev_b32_e64 v188, 16, v181
    v_and_b32 v189, 0xffff0000, v181
    v_lshlrev_b32_e64 v190, 16, v165
    v_and_b32 v191, 0xffff0000, v165
    s_waitcnt vmcnt(8)
    s_barrier
    s_add_u32 m0, s57, 20480
    s_nop 0
    buffer_load_dwordx4 v230, s[12:15], s89 offen offset:0 lds
    v_fmac_f32 v186, v188, v190
    v_fmac_f32 v186, v189, v191
    v_lshlrev_b32 v190, 16, v173
    v_and_b32 v191, 0xffff0000, v173
    v_fmac_f32 v187, v188, v190
    v_fmac_f32 v187, v189, v191
    buffer_load_dwordx4 v231, s[12:15], s89 offen offset:1024 lds
    v_lshlrev_b32_e64 v188, 16, v182
    v_and_b32 v189, 0xffff0000, v182
    v_lshlrev_b32_e64 v190, 16, v166
    v_and_b32 v191, 0xffff0000, v166
    buffer_load_dwordx4 v232, s[12:15], s89 offen offset:2048 lds
    v_fmac_f32 v186, v188, v190
    v_fmac_f32 v186, v189, v191
    v_lshlrev_b32_e64 v190, 16, v174
    v_and_b32 v191, 0xffff0000, v174
    s_add_u32 s59, s59, 11
    s_and_b32 s59, s59, 15
    s_lshl_b32 s88, s59, 7
    s_add_u32 m0, s58, 61440
    s_mul_i32 s89, s59, 393216
    buffer_load_dwordx4 v220, s[16:19], s89 offen offset:0 lds
    v_fmac_f32 v187, v188, v190
    v_fmac_f32 v187, v189, v191
    v_lshlrev_b32 v188, 16, v183
    v_and_b32 v189, 0xffff0000, v183
    buffer_load_dwordx4 v221, s[16:19], s89 offen offset:1024 lds
    v_lshlrev_b32_e64 v190, 16, v167
    v_and_b32 v191, 0xffff0000, v167
    v_fmac_f32 v186, v188, v190
    v_fmac_f32 v186, v189, v191
    buffer_load_dwordx4 v222, s[16:19], s89 offen offset:2048 lds
    v_lshlrev_b32_e64 v190, 16, v175
    v_and_b32 v191, 0xffff0000, v175
    v_fmac_f32 v187, v188, v190
    v_fmac_f32 v187, v189, v191
    s_nop 1
    v_permlane32_swap_b32 v186, v187
    v_add_f32_e64 v186, v186, v187
    s_add_u32 m0, s58, 64512
    s_nop 0
    buffer_load_dwordx4 v223, s[16:19], s89 offen offset:0 lds
    v_mov_b32 v187, v186
    s_nop 1
    v_permlane16_swap_b32 v186, v187
    v_add_f32 v186, v186, v187
    s_nop 1
    v_add_f32_dpp v186, v186, v186 row_ror:8 row_mask:0xf bank_mask:0xf
    buffer_load_dwordx4 v224, s[16:19], s89 offen offset:1024 lds
    s_nop 0
    v_add_f32_dpp v186, v186, v186 row_ror:4 row_mask:0xf bank_mask:0xf
    s_nop 1
    v_add_f32_dpp v186, v186, v186 row_ror:2 row_mask:0xf bank_mask:0xf
    s_nop 1
    v_add_f32_dpp v186, v186, v186 row_ror:1 row_mask:0xf bank_mask:0xf
    v_mul_f32 v186, s97, v186
    buffer_load_dwordx4 v225, s[16:19], s89 offen offset:2048 lds
    v_exp_f32 v186, v186
    s_nop 0
    v_add_f32 v186, 1.0, v186
    v_rcp_f32_e64 v186, v186
    s_lshl_b32 s91, s55, 5
    s_lshl_b32 s92, s4, 3
    s_add_u32 s91, s91, s92
    s_add_u32 s91, s91, 27688960
    v_lshrrev_b32 v187, 3, v0
    v_and_b32 v188, 31, v0
    v_cmp_eq_u32 vcc, 0, v188
    v_mov_b32 v188, 1073741824
    s_nop 0
    v_cndmask_b32 v187, v188, v187, vcc
    buffer_store_dword v186, v187, s[28:31], s91 offen sc1
    s_waitcnt vmcnt(7)
    s_barrier
    s_add_u32 s59, s59, 1
    s_and_b32 s59, s59, 15
    s_lshl_b32 s88, s59, 7
    s_add_u32 m0, s58, 106496
    s_mul_i32 s89, s59, 393216
    buffer_load_dwordx4 v220, s[16:19], s89 offen offset:0 lds
    v_add_u32 v226, 90112, v239
    v_add_u32 v227, 90112, v240
    buffer_load_dwordx4 v221, s[16:19], s89 offen offset:1024 lds
    v_add_u32 v228, 90112, v241
    v_add_u32 v229, 90112, v242
    buffer_load_dwordx4 v222, s[16:19], s89 offen offset:2048 lds
    s_add_u32 m0, s58, 109568
    s_nop 0
    buffer_load_dwordx4 v223, s[16:19], s89 offen offset:0 lds
    s_cmp_eq_u32 s52, 0
    s_cselect_b32 s93, s6, s61
    s_lshl_b32 s93, s93, 1
    s_add_u32 s93, s93, s53
    s_lshl_b32 s93, s93, 11
    s_lshl_b32 s92, s53, 11
    s_add_u32 s92, s92, 40960
    v_lshrrev_b32 v1, 2, v0
    v_and_b32 v2, 3, v0
    buffer_load_dwordx4 v224, s[16:19], s89 offen offset:1024 lds
    v_lshlrev_b32_e64 v1, 6, v1
    v_lshl_add_u32 v1, v2, 3, v1
    buffer_load_dwordx4 v225, s[16:19], s89 offen offset:2048 lds
    v_add_u32_e64 v248, s92, v1
    s_mul_i32 s91, s52, 45056
    s_add_u32 s92, s92, s91
    s_waitcnt vmcnt(6)
    s_waitcnt lgkmcnt(0)
    s_setprio 0
    s_barrier
    ds_read_b64_tr_b16 v[160:161], v241 offset:45056
    ds_read_b64_tr_b16 v[162:163], v241 offset:45568
    ds_read_b64_tr_b16 v[164:165], v241 offset:57344
    ds_read_b64_tr_b16 v[166:167], v241 offset:57856
    ds_read_b64_tr_b16 v[168:169], v242 offset:45056
    ds_read_b64_tr_b16 v[170:171], v242 offset:45568
    ds_read_b64_tr_b16 v[172:173], v242 offset:57344
    ds_read_b64_tr_b16 v[174:175], v242 offset:57856
    ds_read_b64_tr_b16 v[176:177], v241 offset:46080
    ds_read_b64_tr_b16 v[178:179], v241 offset:46592
    ds_read_b64_tr_b16 v[180:181], v241 offset:58368
    ds_read_b64_tr_b16 v[182:183], v241 offset:58880
    ds_read_b64_tr_b16 v[184:185], v242 offset:46080
    ds_read_b64_tr_b16 v[186:187], v242 offset:46592
    ds_read_b64_tr_b16 v[188:189], v242 offset:58368
    ds_read_b64_tr_b16 v[190:191], v242 offset:58880
    ds_read_b64_tr_b16 v[192:193], v241 offset:47104
    ds_read_b64_tr_b16 v[194:195], v241 offset:47616
    ds_read_b64_tr_b16 v[196:197], v241 offset:59392
    ds_read_b64_tr_b16 v[198:199], v241 offset:59904
    ds_read_b64_tr_b16 v[200:201], v242 offset:47104
    ds_read_b64_tr_b16 v[202:203], v242 offset:47616
    ds_read_b64_tr_b16 v[204:205], v242 offset:59392
    ds_read_b64_tr_b16 v[206:207], v242 offset:59904
    s_add_u32 s59, s59, 1
    s_and_b32 s59, s59, 15
    s_lshl_b32 s88, s59, 7
    s_add_u32 m0, s58, 16384
    s_mul_i32 s89, s59, 393216
    buffer_load_dwordx4 v220, s[16:19], s89 offen offset:0 lds
    buffer_load_dwordx4 v221, s[16:19], s89 offen offset:1024 lds
    buffer_load_dwordx4 v222, s[16:19], s89 offen offset:2048 lds
    s_add_u32 m0, s58, 19456
    s_nop 0
    buffer_load_dwordx4 v223, s[16:19], s89 offen offset:0 lds
    s_waitcnt lgkmcnt(15)
    v_mfma_f32_16x16x32_bf16 v[16:19], v[160:163], v[88:91], 0
    v_mfma_f32_16x16x32_bf16 v[16:19], v[164:167], v[92:95], v[16:19]
    buffer_load_dwordx4 v224, s[16:19], s89 offen offset:1024 lds
    v_mfma_f32_16x16x32_bf16 v[20:23], v[168:171], v[88:91], 0
    v_mfma_f32_16x16x32_bf16 v[20:23], v[172:175], v[92:95], v[20:23]
    v_mfma_f32_16x16x32_bf16 v[28:31], v[168:171], v[96:99], 0
    v_mfma_f32_16x16x32_bf16 v[28:31], v[172:175], v[100:103], v[28:31]
    v_mfma_f32_16x16x32_bf16 v[24:27], v[160:163], v[96:99], 0
    v_mfma_f32_16x16x32_bf16 v[24:27], v[164:167], v[100:103], v[24:27]
    v_mfma_f32_16x16x32_bf16 v[32:35], v[160:163], v[104:107], 0
    v_mfma_f32_16x16x32_bf16 v[32:35], v[164:167], v[108:111], v[32:35]
    buffer_load_dwordx4 v225, s[16:19], s89 offen offset:2048 lds
    v_mfma_f32_16x16x32_bf16 v[36:39], v[168:171], v[104:107], 0
    v_mfma_f32_16x16x32_bf16 v[36:39], v[172:175], v[108:111], v[36:39]
    v_mfma_f32_16x16x32_bf16 v[44:47], v[168:171], v[4:7], 0
    s_add_u32 s59, s59, 4
    s_and_b32 s59, s59, 15
    v_mfma_f32_16x16x32_bf16 v[44:47], v[172:175], v[244:247], v[44:47]
    s_lshl_b32 s88, s59, 7
    s_add_u32 m0, s58, 61440
    v_mfma_f32_16x16x32_bf16 v[40:43], v[160:163], v[4:7], 0
    s_mul_i32 s89, s59, 393216
    v_mfma_f32_16x16x32_bf16 v[40:43], v[164:167], v[244:247], v[40:43]
    s_waitcnt vmcnt(6) lgkmcnt(0)
    s_barrier
    v_mfma_f32_16x16x32_bf16 v[48:51], v[176:179], v[88:91], 0
    ds_read_b64_tr_b16 v[160:161], v228 offset:0
    v_mfma_f32_16x16x32_bf16 v[48:51], v[180:183], v[92:95], v[48:51]
    buffer_load_dwordx4 v220, s[16:19], s89 offen offset:0 lds
    v_mfma_f32_16x16x32_bf16 v[56:59], v[176:179], v[96:99], 0
    ds_read_b64_tr_b16 v[162:163], v228 offset:512
    v_mfma_f32_16x16x32_bf16 v[56:59], v[180:183], v[100:103], v[56:59]
    ds_read_b64_tr_b16 v[164:165], v228 offset:12288
    v_mfma_f32_16x16x32_bf16 v[64:67], v[176:179], v[104:107], 0
    ds_read_b64_tr_b16 v[166:167], v228 offset:12800
    v_mfma_f32_16x16x32_bf16 v[64:67], v[180:183], v[108:111], v[64:67]
    ds_read_b64_tr_b16 v[168:169], v229 offset:0
    v_mfma_f32_16x16x32_bf16 v[72:75], v[176:179], v[4:7], 0
    ds_read_b64_tr_b16 v[170:171], v229 offset:512
    v_mfma_f32_16x16x32_bf16 v[72:75], v[180:183], v[244:247], v[72:75]
    buffer_load_dwordx4 v221, s[16:19], s89 offen offset:1024 lds
    v_mfma_f32_16x16x32_bf16 v[76:79], v[184:187], v[4:7], 0
    ds_read_b64_tr_b16 v[172:173], v229 offset:12288
    v_mfma_f32_16x16x32_bf16 v[76:79], v[188:191], v[244:247], v[76:79]
    ds_read_b64_tr_b16 v[174:175], v229 offset:12800
    v_mfma_f32_16x16x32_bf16 v[68:71], v[184:187], v[104:107], 0
    ds_read_b64_tr_b16 v[176:177], v228 offset:1024
    v_mfma_f32_16x16x32_bf16 v[68:71], v[188:191], v[108:111], v[68:71]
    ds_read_b64_tr_b16 v[178:179], v228 offset:1536
    v_mfma_f32_16x16x32_bf16 v[60:63], v[184:187], v[96:99], 0
    ds_read_b64_tr_b16 v[180:181], v228 offset:13312
    v_mfma_f32_16x16x32_bf16 v[60:63], v[188:191], v[100:103], v[60:63]
    buffer_load_dwordx4 v222, s[16:19], s89 offen offset:2048 lds
    v_mfma_f32_16x16x32_bf16 v[52:55], v[184:187], v[88:91], 0
    ds_read_b64_tr_b16 v[182:183], v228 offset:13824
    v_mfma_f32_16x16x32_bf16 v[52:55], v[188:191], v[92:95], v[52:55]
    ds_read_b64_tr_b16 v[184:185], v229 offset:1024
    v_mfma_f32_16x16x32_bf16 v[80:83], v[88:91], v[192:195], 0
    ds_read_b64_tr_b16 v[186:187], v229 offset:1536
    v_mfma_f32_16x16x32_bf16 v[80:83], v[92:95], v[196:199], v[80:83]
    ds_read_b64_tr_b16 v[188:189], v229 offset:13312
    v_mfma_f32_16x16x32_bf16 v[84:87], v[88:91], v[200:203], 0
    ds_read_b64_tr_b16 v[190:191], v229 offset:13824
    s_add_u32 m0, s58, 64512
    v_mfma_f32_16x16x32_bf16 v[84:87], v[92:95], v[204:207], v[84:87]
    buffer_load_dwordx4 v223, s[16:19], s89 offen offset:0 lds
    v_mfma_f32_16x16x32_bf16 v[92:95], v[96:99], v[200:203], 0
    v_mfma_f32_16x16x32_bf16 v[92:95], v[100:103], v[204:207], v[92:95]
    v_mfma_f32_16x16x32_bf16 v[88:91], v[96:99], v[192:195], 0
    v_mfma_f32_16x16x32_bf16 v[88:91], v[100:103], v[196:199], v[88:91]
    v_mfma_f32_16x16x32_bf16 v[96:99], v[104:107], v[192:195], 0
    v_mfma_f32_16x16x32_bf16 v[96:99], v[108:111], v[196:199], v[96:99]
    buffer_load_dwordx4 v224, s[16:19], s89 offen offset:1024 lds
    v_mfma_f32_16x16x32_bf16 v[100:103], v[104:107], v[200:203], 0
    v_mfma_f32_16x16x32_bf16 v[100:103], v[108:111], v[204:207], v[100:103]
    v_mfma_f32_16x16x32_bf16 v[108:111], v[4:7], v[200:203], 0
    ds_read_b64_tr_b16 v[200:201], v229 offset:2048
    v_mfma_f32_16x16x32_bf16 v[108:111], v[244:247], v[204:207], v[108:111]
    ds_read_b64_tr_b16 v[202:203], v229 offset:2560
    v_mfma_f32_16x16x32_bf16 v[104:107], v[4:7], v[192:195], 0
    ds_read_b64_tr_b16 v[204:205], v229 offset:14336
    v_mfma_f32_16x16x32_bf16 v[104:107], v[244:247], v[196:199], v[104:107]
    buffer_load_dwordx4 v225, s[16:19], s89 offen offset:2048 lds
    s_waitcnt lgkmcnt(3)
    v_mfma_f32_16x16x32_bf16 v[16:19], v[160:163], v[112:115], v[16:19]
    ds_read_b64_tr_b16 v[206:207], v229 offset:14848
    v_mfma_f32_16x16x32_bf16 v[16:19], v[164:167], v[116:119], v[16:19]
    ds_read_b64_tr_b16 v[192:193], v228 offset:2048
    v_mfma_f32_16x16x32_bf16 v[20:23], v[168:171], v[112:115], v[20:23]
    ds_read_b64_tr_b16 v[194:195], v228 offset:2560
    v_mfma_f32_16x16x32_bf16 v[20:23], v[172:175], v[116:119], v[20:23]
    ds_read_b64_tr_b16 v[196:197], v228 offset:14336
    v_mfma_f32_16x16x32_bf16 v[28:31], v[168:171], v[8:11], v[28:31]
    ds_read_b64_tr_b16 v[198:199], v228 offset:14848
    s_mov_b32 m0, s92
    v_mfma_f32_16x16x32_bf16 v[28:31], v[172:175], v[120:123], v[28:31]
    buffer_load_dwordx4 v249, s[40:43], s93 offen offset:0 lds
    v_mfma_f32_16x16x32_bf16 v[24:27], v[160:163], v[8:11], v[24:27]
    v_mfma_f32_16x16x32_bf16 v[24:27], v[164:167], v[120:123], v[24:27]
    v_mfma_f32_16x16x32_bf16 v[32:35], v[160:163], v[208:211], v[32:35]
    v_mfma_f32_16x16x32_bf16 v[32:35], v[164:167], v[212:215], v[32:35]
    v_mfma_f32_16x16x32_bf16 v[36:39], v[168:171], v[208:211], v[36:39]
    v_mfma_f32_16x16x32_bf16 v[36:39], v[172:175], v[212:215], v[36:39]
    buffer_load_dwordx4 v249, s[40:43], s93 offen offset:1024 lds
    v_mfma_f32_16x16x32_bf16 v[44:47], v[168:171], v[250:253], v[44:47]
    s_add_u32 s59, s59, 14
    s_and_b32 s59, s59, 15
    v_mfma_f32_16x16x32_bf16 v[44:47], v[172:175], v[234:237], v[44:47]
    s_lshl_b32 s88, s59, 7
    s_add_u32 m0, s58, 106496
    v_mfma_f32_16x16x32_bf16 v[40:43], v[160:163], v[250:253], v[40:43]
    s_mul_i32 s89, s59, 393216
    v_mfma_f32_16x16x32_bf16 v[40:43], v[164:167], v[234:237], v[40:43]
    s_waitcnt vmcnt(8) lgkmcnt(0)
    s_barrier
    v_mfma_f32_16x16x32_bf16 v[48:51], v[176:179], v[112:115], v[48:51]
    ds_read_b64_tr_b16 v[160:161], v241 offset:0
    v_mfma_f32_16x16x32_bf16 v[48:51], v[180:183], v[116:119], v[48:51]
    buffer_load_dwordx4 v220, s[16:19], s89 offen offset:0 lds
    v_mfma_f32_16x16x32_bf16 v[56:59], v[176:179], v[8:11], v[56:59]
    ds_read_b64_tr_b16 v[162:163], v241 offset:512
    v_mfma_f32_16x16x32_bf16 v[56:59], v[180:183], v[120:123], v[56:59]
    ds_read_b64_tr_b16 v[164:165], v241 offset:12288
    v_mfma_f32_16x16x32_bf16 v[64:67], v[176:179], v[208:211], v[64:67]
    ds_read_b64_tr_b16 v[166:167], v241 offset:12800
    v_mfma_f32_16x16x32_bf16 v[64:67], v[180:183], v[212:215], v[64:67]
    ds_read_b64_tr_b16 v[168:169], v242 offset:0
    v_mfma_f32_16x16x32_bf16 v[72:75], v[176:179], v[250:253], v[72:75]
    ds_read_b64_tr_b16 v[170:171], v242 offset:512
    v_mfma_f32_16x16x32_bf16 v[72:75], v[180:183], v[234:237], v[72:75]
    ds_read_b64_tr_b16 v[172:173], v242 offset:12288
    v_mfma_f32_16x16x32_bf16 v[76:79], v[184:187], v[250:253], v[76:79]
    ds_read_b64_tr_b16 v[174:175], v242 offset:12800
    v_mfma_f32_16x16x32_bf16 v[76:79], v[188:191], v[234:237], v[76:79]
    buffer_load_dwordx4 v221, s[16:19], s89 offen offset:1024 lds
    v_mfma_f32_16x16x32_bf16 v[68:71], v[184:187], v[208:211], v[68:71]
    ds_read_b64_tr_b16 v[176:177], v241 offset:1024
    v_mfma_f32_16x16x32_bf16 v[68:71], v[188:191], v[212:215], v[68:71]
    ds_read_b64_tr_b16 v[178:179], v241 offset:1536
    v_mfma_f32_16x16x32_bf16 v[60:63], v[184:187], v[8:11], v[60:63]
    ds_read_b64_tr_b16 v[180:181], v241 offset:13312
    v_mfma_f32_16x16x32_bf16 v[60:63], v[188:191], v[120:123], v[60:63]
    ds_read_b64_tr_b16 v[182:183], v241 offset:13824
    v_mfma_f32_16x16x32_bf16 v[52:55], v[184:187], v[112:115], v[52:55]
    ds_read_b64_tr_b16 v[184:185], v242 offset:1024
    v_mfma_f32_16x16x32_bf16 v[52:55], v[188:191], v[116:119], v[52:55]
    ds_read_b64_tr_b16 v[186:187], v242 offset:1536
    v_mfma_f32_16x16x32_bf16 v[80:83], v[112:115], v[192:195], v[80:83]
    ds_read_b64_tr_b16 v[188:189], v242 offset:13312
    v_mfma_f32_16x16x32_bf16 v[80:83], v[116:119], v[196:199], v[80:83]
    buffer_load_dwordx4 v222, s[16:19], s89 offen offset:2048 lds
    v_mfma_f32_16x16x32_bf16 v[84:87], v[112:115], v[200:203], v[84:87]
    ds_read_b64_tr_b16 v[190:191], v242 offset:13824
    v_mfma_f32_16x16x32_bf16 v[84:87], v[116:119], v[204:207], v[84:87]
    v_mfma_f32_16x16x32_bf16 v[92:95], v[8:11], v[200:203], v[92:95]
    v_mfma_f32_16x16x32_bf16 v[92:95], v[120:123], v[204:207], v[92:95]
    v_mfma_f32_16x16x32_bf16 v[88:91], v[8:11], v[192:195], v[88:91]
    v_mfma_f32_16x16x32_bf16 v[88:91], v[120:123], v[196:199], v[88:91]
    v_mfma_f32_16x16x32_bf16 v[96:99], v[208:211], v[192:195], v[96:99]
    s_add_u32 m0, s58, 109568
    v_mfma_f32_16x16x32_bf16 v[96:99], v[212:215], v[196:199], v[96:99]
    buffer_load_dwordx4 v223, s[16:19], s89 offen offset:0 lds
    v_mfma_f32_16x16x32_bf16 v[100:103], v[208:211], v[200:203], v[100:103]
    v_mfma_f32_16x16x32_bf16 v[100:103], v[212:215], v[204:207], v[100:103]
    v_mfma_f32_16x16x32_bf16 v[108:111], v[250:253], v[200:203], v[108:111]
    ds_read_b64_tr_b16 v[200:201], v242 offset:2048
    v_mfma_f32_16x16x32_bf16 v[108:111], v[234:237], v[204:207], v[108:111]
    ds_read_b64_tr_b16 v[202:203], v242 offset:2560
    v_mfma_f32_16x16x32_bf16 v[104:107], v[250:253], v[192:195], v[104:107]
    ds_read_b64_tr_b16 v[204:205], v242 offset:14336
    v_mfma_f32_16x16x32_bf16 v[104:107], v[234:237], v[196:199], v[104:107]
    ds_read_b64_tr_b16 v[206:207], v242 offset:14848
    s_waitcnt lgkmcnt(4)
    v_mfma_f32_16x16x32_bf16 v[16:19], v[160:163], v[128:131], v[16:19]
L_walka_1:
    s_cbranch_execz L_walkeda
    s_nop 0
    ds_read_b64_tr_b16 v[192:193], v241 offset:2048
    v_mfma_f32_16x16x32_bf16 v[16:19], v[164:167], v[132:135], v[16:19]
    buffer_load_dwordx4 v224, s[16:19], s89 offen offset:1024 lds
    v_mfma_f32_16x16x32_bf16 v[20:23], v[168:171], v[128:131], v[20:23]
    ds_read_b64_tr_b16 v[194:195], v241 offset:2560
    v_mfma_f32_16x16x32_bf16 v[20:23], v[172:175], v[132:135], v[20:23]
    ds_read_b64_tr_b16 v[196:197], v241 offset:14336
    v_mfma_f32_16x16x32_bf16 v[28:31], v[168:171], v[136:139], v[28:31]
    ds_read_b64_tr_b16 v[198:199], v241 offset:14848
    v_mfma_f32_16x16x32_bf16 v[28:31], v[172:175], v[140:143], v[28:31]
    v_mfma_f32_16x16x32_bf16 v[24:27], v[160:163], v[136:139], v[24:27]
    v_mfma_f32_16x16x32_bf16 v[24:27], v[164:167], v[140:143], v[24:27]
    v_mfma_f32_16x16x32_bf16 v[32:35], v[160:163], v[144:147], v[32:35]
    v_mfma_f32_16x16x32_bf16 v[32:35], v[164:167], v[148:151], v[32:35]
    buffer_load_dwordx4 v225, s[16:19], s89 offen offset:2048 lds
    v_mfma_f32_16x16x32_bf16 v[36:39], v[168:171], v[144:147], v[36:39]
    v_mfma_f32_16x16x32_bf16 v[36:39], v[172:175], v[148:151], v[36:39]
    v_mfma_f32_16x16x32_bf16 v[44:47], v[168:171], v[152:155], v[44:47]
    s_add_u32 s59, s59, 1
    s_and_b32 s59, s59, 15
    v_mfma_f32_16x16x32_bf16 v[44:47], v[172:175], v[156:159], v[44:47]
    s_lshl_b32 s88, s59, 7
    s_add_u32 m0, s58, 16384
    v_mfma_f32_16x16x32_bf16 v[40:43], v[160:163], v[152:155], v[40:43]
    s_mul_i32 s89, s59, 393216
    v_mfma_f32_16x16x32_bf16 v[40:43], v[164:167], v[156:159], v[40:43]
    s_waitcnt vmcnt(6) lgkmcnt(0)
    s_barrier
    v_mfma_f32_16x16x32_bf16 v[48:51], v[176:179], v[128:131], v[48:51]
    ds_read_b64_tr_b16 v[160:161], v241 offset:45056
    v_mfma_f32_16x16x32_bf16 v[48:51], v[180:183], v[132:135], v[48:51]
    buffer_load_dwordx4 v220, s[16:19], s89 offen offset:0 lds
    v_mfma_f32_16x16x32_bf16 v[56:59], v[176:179], v[136:139], v[56:59]
    ds_read_b64_tr_b16 v[162:163], v241 offset:45568
    v_mfma_f32_16x16x32_bf16 v[56:59], v[180:183], v[140:143], v[56:59]
    ds_read_b64_tr_b16 v[164:165], v241 offset:57344
    v_mfma_f32_16x16x32_bf16 v[64:67], v[176:179], v[144:147], v[64:67]
    ds_read_b64_tr_b16 v[166:167], v241 offset:57856
    v_mfma_f32_16x16x32_bf16 v[64:67], v[180:183], v[148:151], v[64:67]
    ds_read_b64_tr_b16 v[168:169], v242 offset:45056
    v_mfma_f32_16x16x32_bf16 v[72:75], v[176:179], v[152:155], v[72:75]
    ds_read_b64_tr_b16 v[170:171], v242 offset:45568
    v_mfma_f32_16x16x32_bf16 v[72:75], v[180:183], v[156:159], v[72:75]
    ds_read_b64_tr_b16 v[172:173], v242 offset:57344
    v_mfma_f32_16x16x32_bf16 v[76:79], v[184:187], v[152:155], v[76:79]
    ds_read_b64_tr_b16 v[174:175], v242 offset:57856
    v_mfma_f32_16x16x32_bf16 v[76:79], v[188:191], v[156:159], v[76:79]
    buffer_load_dwordx4 v221, s[16:19], s89 offen offset:1024 lds
    v_mfma_f32_16x16x32_bf16 v[68:71], v[184:187], v[144:147], v[68:71]
    ds_read_b64_tr_b16 v[176:177], v241 offset:46080
    v_mfma_f32_16x16x32_bf16 v[68:71], v[188:191], v[148:151], v[68:71]
    ds_read_b64_tr_b16 v[178:179], v241 offset:46592
    v_mfma_f32_16x16x32_bf16 v[60:63], v[184:187], v[136:139], v[60:63]
    ds_read_b64_tr_b16 v[180:181], v241 offset:58368
    v_mfma_f32_16x16x32_bf16 v[60:63], v[188:191], v[140:143], v[60:63]
    ds_read_b64_tr_b16 v[182:183], v241 offset:58880
    v_mfma_f32_16x16x32_bf16 v[52:55], v[184:187], v[128:131], v[52:55]
    ds_read_b64_tr_b16 v[184:185], v242 offset:46080
    v_mfma_f32_16x16x32_bf16 v[52:55], v[188:191], v[132:135], v[52:55]
    ds_read_b64_tr_b16 v[186:187], v242 offset:46592
    v_mfma_f32_16x16x32_bf16 v[80:83], v[128:131], v[192:195], v[80:83]
    ds_read_b64_tr_b16 v[188:189], v242 offset:58368
    v_mfma_f32_16x16x32_bf16 v[80:83], v[132:135], v[196:199], v[80:83]
    buffer_load_dwordx4 v222, s[16:19], s89 offen offset:2048 lds
    v_mfma_f32_16x16x32_bf16 v[84:87], v[128:131], v[200:203], v[84:87]
    ds_read_b128 v[128:131], v226 offset:57344
    v_mfma_f32_16x16x32_bf16 v[84:87], v[132:135], v[204:207], v[84:87]
    ds_read_b128 v[132:135], v227 offset:57344
    v_mfma_f32_16x16x32_bf16 v[92:95], v[136:139], v[200:203], v[92:95]
    ds_read_b64_tr_b16 v[190:191], v242 offset:58880
    v_mfma_f32_16x16x32_bf16 v[92:95], v[140:143], v[204:207], v[92:95]
    v_mfma_f32_16x16x32_bf16 v[88:91], v[136:139], v[192:195], v[88:91]
    ds_read_b128 v[136:139], v226 offset:59392
    v_mfma_f32_16x16x32_bf16 v[88:91], v[140:143], v[196:199], v[88:91]
    ds_read_b128 v[140:143], v227 offset:59392
    v_mfma_f32_16x16x32_bf16 v[96:99], v[144:147], v[192:195], v[96:99]
    s_add_u32 m0, s58, 19456
    v_mfma_f32_16x16x32_bf16 v[96:99], v[148:151], v[196:199], v[96:99]
    buffer_load_dwordx4 v223, s[16:19], s89 offen offset:0 lds
    v_mfma_f32_16x16x32_bf16 v[100:103], v[144:147], v[200:203], v[100:103]
    ds_read_b128 v[144:147], v226 offset:61440
    v_mfma_f32_16x16x32_bf16 v[100:103], v[148:151], v[204:207], v[100:103]
    ds_read_b128 v[148:151], v227 offset:61440
    v_mfma_f32_16x16x32_bf16 v[108:111], v[152:155], v[200:203], v[108:111]
    ds_read_b64_tr_b16 v[200:201], v242 offset:47104
    v_mfma_f32_16x16x32_bf16 v[108:111], v[156:159], v[204:207], v[108:111]
    ds_read_b64_tr_b16 v[202:203], v242 offset:47616
    v_mfma_f32_16x16x32_bf16 v[104:107], v[152:155], v[192:195], v[104:107]
    ds_read_b128 v[152:155], v226 offset:63488
    v_mfma_f32_16x16x32_bf16 v[104:107], v[156:159], v[196:199], v[104:107]
    ds_read_b128 v[156:159], v227 offset:63488
    s_waitcnt lgkmcnt(4)
    v_mfma_f32_16x16x32_bf16 v[16:19], v[160:163], v[128:131], v[16:19]
    ds_read_b64_tr_b16 v[204:205], v242 offset:59392
    v_mfma_f32_16x16x32_bf16 v[16:19], v[164:167], v[132:135], v[16:19]
    buffer_load_dwordx4 v224, s[16:19], s89 offen offset:1024 lds
    v_mfma_f32_16x16x32_bf16 v[20:23], v[168:171], v[128:131], v[20:23]
    ds_read_b64_tr_b16 v[206:207], v242 offset:59904
    v_mfma_f32_16x16x32_bf16 v[20:23], v[172:175], v[132:135], v[20:23]
    ds_read_b64_tr_b16 v[192:193], v241 offset:47104
    v_mfma_f32_16x16x32_bf16 v[28:31], v[168:171], v[136:139], v[28:31]
    ds_read_b64_tr_b16 v[194:195], v241 offset:47616
    v_mfma_f32_16x16x32_bf16 v[28:31], v[172:175], v[140:143], v[28:31]
    ds_read_b64_tr_b16 v[196:197], v241 offset:59392
    v_mfma_f32_16x16x32_bf16 v[24:27], v[160:163], v[136:139], v[24:27]
    ds_read_b64_tr_b16 v[198:199], v241 offset:59904
    v_mfma_f32_16x16x32_bf16 v[24:27], v[164:167], v[140:143], v[24:27]
    v_mfma_f32_16x16x32_bf16 v[32:35], v[160:163], v[144:147], v[32:35]
    v_mfma_f32_16x16x32_bf16 v[32:35], v[164:167], v[148:151], v[32:35]
    buffer_load_dwordx4 v225, s[16:19], s89 offen offset:2048 lds
    v_mfma_f32_16x16x32_bf16 v[36:39], v[168:171], v[144:147], v[36:39]
    v_mfma_f32_16x16x32_bf16 v[36:39], v[172:175], v[148:151], v[36:39]
    s_waitcnt lgkmcnt(0)
    v_mfma_f32_16x16x32_bf16 v[44:47], v[168:171], v[152:155], v[44:47]
    s_add_u32 s59, s59, 14
    s_and_b32 s59, s59, 15
    v_mfma_f32_16x16x32_bf16 v[44:47], v[172:175], v[156:159], v[44:47]
    s_lshl_b32 s88, s59, 7
    s_add_u32 m0, s58, 61440
    v_mfma_f32_16x16x32_bf16 v[40:43], v[160:163], v[152:155], v[40:43]
    s_mul_i32 s89, s59, 393216
    v_mfma_f32_16x16x32_bf16 v[40:43], v[164:167], v[156:159], v[40:43]
    s_waitcnt vmcnt(6) lgkmcnt(0)
    s_barrier
    v_mfma_f32_16x16x32_bf16 v[48:51], v[176:179], v[128:131], v[48:51]
    ds_read_b64_tr_b16 v[160:161], v228 offset:0
    v_mfma_f32_16x16x32_bf16 v[48:51], v[180:183], v[132:135], v[48:51]
    buffer_load_dwordx4 v220, s[16:19], s89 offen offset:0 lds
    v_mfma_f32_16x16x32_bf16 v[56:59], v[176:179], v[136:139], v[56:59]
    ds_read_b64_tr_b16 v[162:163], v228 offset:512
    v_mfma_f32_16x16x32_bf16 v[56:59], v[180:183], v[140:143], v[56:59]
    ds_read_b64_tr_b16 v[164:165], v228 offset:12288
    v_mfma_f32_16x16x32_bf16 v[64:67], v[176:179], v[144:147], v[64:67]
    ds_read_b64_tr_b16 v[166:167], v228 offset:12800
    v_mfma_f32_16x16x32_bf16 v[64:67], v[180:183], v[148:151], v[64:67]
    ds_read_b64_tr_b16 v[168:169], v229 offset:0
    v_mfma_f32_16x16x32_bf16 v[72:75], v[176:179], v[152:155], v[72:75]
    ds_read_b64_tr_b16 v[170:171], v229 offset:512
    v_mfma_f32_16x16x32_bf16 v[72:75], v[180:183], v[156:159], v[72:75]
    ds_read_b64_tr_b16 v[172:173], v229 offset:12288
    v_mfma_f32_16x16x32_bf16 v[76:79], v[184:187], v[152:155], v[76:79]
    ds_read_b64_tr_b16 v[174:175], v229 offset:12800
    v_mfma_f32_16x16x32_bf16 v[76:79], v[188:191], v[156:159], v[76:79]
    buffer_load_dwordx4 v221, s[16:19], s89 offen offset:1024 lds
    v_mfma_f32_16x16x32_bf16 v[68:71], v[184:187], v[144:147], v[68:71]
    ds_read_b64_tr_b16 v[176:177], v228 offset:1024
    v_mfma_f32_16x16x32_bf16 v[68:71], v[188:191], v[148:151], v[68:71]
    ds_read_b64_tr_b16 v[178:179], v228 offset:1536
    v_mfma_f32_16x16x32_bf16 v[60:63], v[184:187], v[136:139], v[60:63]
    ds_read_b64_tr_b16 v[180:181], v228 offset:13312
    v_mfma_f32_16x16x32_bf16 v[60:63], v[188:191], v[140:143], v[60:63]
    ds_read_b64_tr_b16 v[182:183], v228 offset:13824
    v_mfma_f32_16x16x32_bf16 v[52:55], v[184:187], v[128:131], v[52:55]
    ds_read_b64_tr_b16 v[184:185], v229 offset:1024
    v_mfma_f32_16x16x32_bf16 v[52:55], v[188:191], v[132:135], v[52:55]
    ds_read_b64_tr_b16 v[186:187], v229 offset:1536
    v_mfma_f32_16x16x32_bf16 v[80:83], v[128:131], v[192:195], v[80:83]
    ds_read_b64_tr_b16 v[188:189], v229 offset:13312
    v_mfma_f32_16x16x32_bf16 v[80:83], v[132:135], v[196:199], v[80:83]
    buffer_load_dwordx4 v222, s[16:19], s89 offen offset:2048 lds
    v_mfma_f32_16x16x32_bf16 v[84:87], v[128:131], v[200:203], v[84:87]
    ds_read_b128 v[128:131], v226 offset:0
    v_mfma_f32_16x16x32_bf16 v[84:87], v[132:135], v[204:207], v[84:87]
    ds_read_b128 v[132:135], v227 offset:0
    v_mfma_f32_16x16x32_bf16 v[92:95], v[136:139], v[200:203], v[92:95]
    ds_read_b64_tr_b16 v[190:191], v229 offset:13824
    v_mfma_f32_16x16x32_bf16 v[92:95], v[140:143], v[204:207], v[92:95]
    v_mfma_f32_16x16x32_bf16 v[88:91], v[136:139], v[192:195], v[88:91]
    ds_read_b128 v[136:139], v226 offset:2048
    v_mfma_f32_16x16x32_bf16 v[88:91], v[140:143], v[196:199], v[88:91]
    ds_read_b128 v[140:143], v227 offset:2048
    v_mfma_f32_16x16x32_bf16 v[96:99], v[144:147], v[192:195], v[96:99]
    s_add_u32 m0, s58, 64512
    v_mfma_f32_16x16x32_bf16 v[96:99], v[148:151], v[196:199], v[96:99]
    buffer_load_dwordx4 v223, s[16:19], s89 offen offset:0 lds
    v_mfma_f32_16x16x32_bf16 v[100:103], v[144:147], v[200:203], v[100:103]
    ds_read_b128 v[144:147], v226 offset:4096
    v_mfma_f32_16x16x32_bf16 v[100:103], v[148:151], v[204:207], v[100:103]
    ds_read_b128 v[148:151], v227 offset:4096
    v_mfma_f32_16x16x32_bf16 v[108:111], v[152:155], v[200:203], v[108:111]
    ds_read_b64_tr_b16 v[200:201], v229 offset:2048
    v_mfma_f32_16x16x32_bf16 v[108:111], v[156:159], v[204:207], v[108:111]
    ds_read_b64_tr_b16 v[202:203], v229 offset:2560
    v_mfma_f32_16x16x32_bf16 v[104:107], v[152:155], v[192:195], v[104:107]
    ds_read_b128 v[152:155], v226 offset:6144
    v_mfma_f32_16x16x32_bf16 v[104:107], v[156:159], v[196:199], v[104:107]
    ds_read_b128 v[156:159], v227 offset:6144
    s_waitcnt lgkmcnt(4)
    v_mfma_f32_16x16x32_bf16 v[16:19], v[160:163], v[128:131], v[16:19]
    ds_read_b64_tr_b16 v[204:205], v229 offset:14336
    v_mfma_f32_16x16x32_bf16 v[16:19], v[164:167], v[132:135], v[16:19]
    buffer_load_dwordx4 v224, s[16:19], s89 offen offset:1024 lds
    v_mfma_f32_16x16x32_bf16 v[20:23], v[168:171], v[128:131], v[20:23]
    ds_read_b64_tr_b16 v[206:207], v229 offset:14848
    v_mfma_f32_16x16x32_bf16 v[20:23], v[172:175], v[132:135], v[20:23]
    ds_read_b64_tr_b16 v[192:193], v228 offset:2048
    v_mfma_f32_16x16x32_bf16 v[28:31], v[168:171], v[136:139], v[28:31]
    ds_read_b64_tr_b16 v[194:195], v228 offset:2560
    v_mfma_f32_16x16x32_bf16 v[28:31], v[172:175], v[140:143], v[28:31]
    ds_read_b64_tr_b16 v[196:197], v228 offset:14336
    v_mfma_f32_16x16x32_bf16 v[24:27], v[160:163], v[136:139], v[24:27]
    ds_read_b64_tr_b16 v[198:199], v228 offset:14848
    v_mfma_f32_16x16x32_bf16 v[24:27], v[164:167], v[140:143], v[24:27]
    v_mfma_f32_16x16x32_bf16 v[32:35], v[160:163], v[144:147], v[32:35]
    v_mfma_f32_16x16x32_bf16 v[32:35], v[164:167], v[148:151], v[32:35]
    buffer_load_dwordx4 v225, s[16:19], s89 offen offset:2048 lds
    v_mfma_f32_16x16x32_bf16 v[36:39], v[168:171], v[144:147], v[36:39]
    v_mfma_f32_16x16x32_bf16 v[36:39], v[172:175], v[148:151], v[36:39]
    s_waitcnt lgkmcnt(0)
    v_mfma_f32_16x16x32_bf16 v[44:47], v[168:171], v[152:155], v[44:47]
    s_add_u32 s59, s59, 12
    s_and_b32 s59, s59, 15
    v_mfma_f32_16x16x32_bf16 v[44:47], v[172:175], v[156:159], v[44:47]
    s_lshl_b32 s88, s59, 7
    s_add_u32 m0, s56, 90112
    v_mfma_f32_16x16x32_bf16 v[40:43], v[160:163], v[152:155], v[40:43]
    s_mul_i32 s89, s59, 393216
    v_mfma_f32_16x16x32_bf16 v[40:43], v[164:167], v[156:159], v[40:43]
    s_waitcnt vmcnt(6) lgkmcnt(0)
    s_mov_b32 s67, 3
.p2align 3
L_loop_2:
    s_barrier
    v_mfma_f32_16x16x32_bf16 v[48:51], v[176:179], v[128:131], v[48:51]
    ds_read_b64_tr_b16 v[160:161], v241 offset:0
    v_mfma_f32_16x16x32_bf16 v[48:51], v[180:183], v[132:135], v[48:51]
    buffer_load_dwordx4 v216, s[8:11], s88 offen offset:0 lds
    v_mfma_f32_16x16x32_bf16 v[56:59], v[176:179], v[136:139], v[56:59]
    ds_read_b64_tr_b16 v[162:163], v241 offset:512
    s_sub_u32 s67, s67, 1
    v_mfma_f32_16x16x32_bf16 v[56:59], v[180:183], v[140:143], v[56:59]
    ds_read_b64_tr_b16 v[164:165], v241 offset:12288
    v_mfma_f32_16x16x32_bf16 v[64:67], v[176:179], v[144:147], v[64:67]
    ds_read_b64_tr_b16 v[166:167], v241 offset:12800
    v_mfma_f32_16x16x32_bf16 v[64:67], v[180:183], v[148:151], v[64:67]
    buffer_load_dwordx4 v217, s[8:11], s88 offen offset:1024 lds
    v_mfma_f32_16x16x32_bf16 v[72:75], v[176:179], v[152:155], v[72:75]
    ds_read_b64_tr_b16 v[168:169], v242 offset:0
    v_mfma_f32_16x16x32_bf16 v[72:75], v[180:183], v[156:159], v[72:75]
    ds_read_b64_tr_b16 v[170:171], v242 offset:512
    v_mfma_f32_16x16x32_bf16 v[76:79], v[184:187], v[152:155], v[76:79]
    ds_read_b64_tr_b16 v[172:173], v242 offset:12288
    v_mfma_f32_16x16x32_bf16 v[76:79], v[188:191], v[156:159], v[76:79]
    buffer_load_dwordx4 v218, s[8:11], s88 offen offset:2048 lds
    v_mfma_f32_16x16x32_bf16 v[68:71], v[184:187], v[144:147], v[68:71]
    ds_read_b64_tr_b16 v[174:175], v242 offset:12800
    v_mfma_f32_16x16x32_bf16 v[68:71], v[188:191], v[148:151], v[68:71]
    ds_read_b64_tr_b16 v[176:177], v241 offset:1024
    v_mfma_f32_16x16x32_bf16 v[60:63], v[184:187], v[136:139], v[60:63]
    ds_read_b64_tr_b16 v[178:179], v241 offset:1536
    v_mfma_f32_16x16x32_bf16 v[60:63], v[188:191], v[140:143], v[60:63]
    ds_read_b64_tr_b16 v[180:181], v241 offset:13312
    v_mfma_f32_16x16x32_bf16 v[52:55], v[184:187], v[128:131], v[52:55]
    ds_read_b64_tr_b16 v[182:183], v241 offset:13824
    v_mfma_f32_16x16x32_bf16 v[52:55], v[188:191], v[132:135], v[52:55]
    buffer_load_dwordx4 v219, s[8:11], s88 offen offset:3072 lds
    v_mfma_f32_16x16x32_bf16 v[80:83], v[128:131], v[192:195], v[80:83]
    ds_read_b64_tr_b16 v[184:185], v242 offset:1024
    v_mfma_f32_16x16x32_bf16 v[80:83], v[132:135], v[196:199], v[80:83]
    ds_read_b64_tr_b16 v[186:187], v242 offset:1536
    v_mfma_f32_16x16x32_bf16 v[84:87], v[128:131], v[200:203], v[84:87]
    ds_read_b128 v[128:131], v239 offset:0
    s_add_u32 m0, s58, 106496
    v_mfma_f32_16x16x32_bf16 v[84:87], v[132:135], v[204:207], v[84:87]
    buffer_load_dwordx4 v220, s[16:19], s89 offen offset:0 lds
    v_mfma_f32_16x16x32_bf16 v[92:95], v[136:139], v[200:203], v[92:95]
    ds_read_b128 v[132:135], v240 offset:0
    v_mfma_f32_16x16x32_bf16 v[92:95], v[140:143], v[204:207], v[92:95]
    ds_read_b64_tr_b16 v[188:189], v242 offset:13312
    v_mfma_f32_16x16x32_bf16 v[88:91], v[136:139], v[192:195], v[88:91]
    ds_read_b128 v[136:139], v239 offset:2048
    v_mfma_f32_16x16x32_bf16 v[88:91], v[140:143], v[196:199], v[88:91]
    ds_read_b128 v[140:143], v240 offset:2048
    v_mfma_f32_16x16x32_bf16 v[96:99], v[144:147], v[192:195], v[96:99]
    ds_read_b64_tr_b16 v[190:191], v242 offset:13824
    v_mfma_f32_16x16x32_bf16 v[96:99], v[148:151], v[196:199], v[96:99]
    buffer_load_dwordx4 v221, s[16:19], s89 offen offset:1024 lds
    v_mfma_f32_16x16x32_bf16 v[100:103], v[144:147], v[200:203], v[100:103]
    ds_read_b128 v[144:147], v239 offset:4096
    v_mfma_f32_16x16x32_bf16 v[100:103], v[148:151], v[204:207], v[100:103]
    ds_read_b128 v[148:151], v240 offset:4096
    v_mfma_f32_16x16x32_bf16 v[108:111], v[152:155], v[200:203], v[108:111]
    ds_read_b64_tr_b16 v[200:201], v242 offset:2048
    v_mfma_f32_16x16x32_bf16 v[108:111], v[156:159], v[204:207], v[108:111]
    buffer_load_dwordx4 v222, s[16:19], s89 offen offset:2048 lds
    v_mfma_f32_16x16x32_bf16 v[104:107], v[152:155], v[192:195], v[104:107]
    ds_read_b128 v[152:155], v239 offset:6144
    v_mfma_f32_16x16x32_bf16 v[104:107], v[156:159], v[196:199], v[104:107]
    ds_read_b128 v[156:159], v240 offset:6144
    s_waitcnt lgkmcnt(3)
    v_mfma_f32_16x16x32_bf16 v[16:19], v[160:163], v[128:131], v[16:19]
    ds_read_b64_tr_b16 v[202:203], v242 offset:2560
    s_add_u32 m0, s58, 109568
    v_mfma_f32_16x16x32_bf16 v[16:19], v[164:167], v[132:135], v[16:19]
    buffer_load_dwordx4 v223, s[16:19], s89 offen offset:0 lds
    v_mfma_f32_16x16x32_bf16 v[20:23], v[168:171], v[128:131], v[20:23]
    ds_read_b64_tr_b16 v[204:205], v242 offset:14336
    v_mfma_f32_16x16x32_bf16 v[20:23], v[172:175], v[132:135], v[20:23]
    ds_read_b64_tr_b16 v[206:207], v242 offset:14848
    v_mfma_f32_16x16x32_bf16 v[28:31], v[168:171], v[136:139], v[28:31]
    ds_read_b64_tr_b16 v[192:193], v241 offset:2048
    v_mfma_f32_16x16x32_bf16 v[28:31], v[172:175], v[140:143], v[28:31]
    ds_read_b64_tr_b16 v[194:195], v241 offset:2560
    v_mfma_f32_16x16x32_bf16 v[24:27], v[160:163], v[136:139], v[24:27]
    ds_read_b64_tr_b16 v[196:197], v241 offset:14336
    v_mfma_f32_16x16x32_bf16 v[24:27], v[164:167], v[140:143], v[24:27]
    buffer_load_dwordx4 v224, s[16:19], s89 offen offset:1024 lds
    v_mfma_f32_16x16x32_bf16 v[32:35], v[160:163], v[144:147], v[32:35]
    ds_read_b64_tr_b16 v[198:199], v241 offset:14848
    v_mfma_f32_16x16x32_bf16 v[32:35], v[164:167], v[148:151], v[32:35]
    v_mfma_f32_16x16x32_bf16 v[36:39], v[168:171], v[144:147], v[36:39]
    v_mfma_f32_16x16x32_bf16 v[36:39], v[172:175], v[148:151], v[36:39]
    buffer_load_dwordx4 v225, s[16:19], s89 offen offset:2048 lds
    s_waitcnt lgkmcnt(1)
    v_mfma_f32_16x16x32_bf16 v[44:47], v[168:171], v[152:155], v[44:47]
    s_add_u32 s59, s59, 15
    s_and_b32 s59, s59, 15
    v_mfma_f32_16x16x32_bf16 v[44:47], v[172:175], v[156:159], v[44:47]
    s_lshl_b32 s88, s59, 7
    s_add_u32 m0, s56, 0
    v_mfma_f32_16x16x32_bf16 v[40:43], v[160:163], v[152:155], v[40:43]
    s_mul_i32 s89, s59, 393216
    v_mfma_f32_16x16x32_bf16 v[40:43], v[164:167], v[156:159], v[40:43]
    s_waitcnt vmcnt(10) lgkmcnt(0)
    s_barrier
    v_mfma_f32_16x16x32_bf16 v[48:51], v[176:179], v[128:131], v[48:51]
    ds_read_b64_tr_b16 v[160:161], v241 offset:45056
    v_mfma_f32_16x16x32_bf16 v[48:51], v[180:183], v[132:135], v[48:51]
    buffer_load_dwordx4 v216, s[8:11], s88 offen offset:0 lds
    v_mfma_f32_16x16x32_bf16 v[56:59], v[176:179], v[136:139], v[56:59]
    ds_read_b64_tr_b16 v[162:163], v241 offset:45568
    v_mfma_f32_16x16x32_bf16 v[56:59], v[180:183], v[140:143], v[56:59]
    ds_read_b64_tr_b16 v[164:165], v241 offset:57344
    v_mfma_f32_16x16x32_bf16 v[64:67], v[176:179], v[144:147], v[64:67]
    ds_read_b64_tr_b16 v[166:167], v241 offset:57856
    v_mfma_f32_16x16x32_bf16 v[64:67], v[180:183], v[148:151], v[64:67]
    buffer_load_dwordx4 v217, s[8:11], s88 offen offset:1024 lds
    v_mfma_f32_16x16x32_bf16 v[72:75], v[176:179], v[152:155], v[72:75]
    ds_read_b64_tr_b16 v[168:169], v242 offset:45056
    v_mfma_f32_16x16x32_bf16 v[72:75], v[180:183], v[156:159], v[72:75]
    ds_read_b64_tr_b16 v[170:171], v242 offset:45568
    v_mfma_f32_16x16x32_bf16 v[76:79], v[184:187], v[152:155], v[76:79]
    ds_read_b64_tr_b16 v[172:173], v242 offset:57344
    v_mfma_f32_16x16x32_bf16 v[76:79], v[188:191], v[156:159], v[76:79]
    buffer_load_dwordx4 v218, s[8:11], s88 offen offset:2048 lds
    v_mfma_f32_16x16x32_bf16 v[68:71], v[184:187], v[144:147], v[68:71]
    ds_read_b64_tr_b16 v[174:175], v242 offset:57856
    v_mfma_f32_16x16x32_bf16 v[68:71], v[188:191], v[148:151], v[68:71]
    ds_read_b64_tr_b16 v[176:177], v241 offset:46080
    v_mfma_f32_16x16x32_bf16 v[60:63], v[184:187], v[136:139], v[60:63]
    ds_read_b64_tr_b16 v[178:179], v241 offset:46592
    v_mfma_f32_16x16x32_bf16 v[60:63], v[188:191], v[140:143], v[60:63]
    ds_read_b64_tr_b16 v[180:181], v241 offset:58368
    v_mfma_f32_16x16x32_bf16 v[52:55], v[184:187], v[128:131], v[52:55]
    ds_read_b64_tr_b16 v[182:183], v241 offset:58880
    v_mfma_f32_16x16x32_bf16 v[52:55], v[188:191], v[132:135], v[52:55]
    buffer_load_dwordx4 v219, s[8:11], s88 offen offset:3072 lds
    v_mfma_f32_16x16x32_bf16 v[80:83], v[128:131], v[192:195], v[80:83]
    ds_read_b64_tr_b16 v[184:185], v242 offset:46080
    v_mfma_f32_16x16x32_bf16 v[80:83], v[132:135], v[196:199], v[80:83]
    ds_read_b64_tr_b16 v[186:187], v242 offset:46592
    v_mfma_f32_16x16x32_bf16 v[84:87], v[128:131], v[200:203], v[84:87]
    ds_read_b128 v[128:131], v239 offset:45056
    s_add_u32 m0, s58, 16384
    v_mfma_f32_16x16x32_bf16 v[84:87], v[132:135], v[204:207], v[84:87]
    buffer_load_dwordx4 v220, s[16:19], s89 offen offset:0 lds
    v_mfma_f32_16x16x32_bf16 v[92:95], v[136:139], v[200:203], v[92:95]
    ds_read_b128 v[132:135], v240 offset:45056
    v_mfma_f32_16x16x32_bf16 v[92:95], v[140:143], v[204:207], v[92:95]
    ds_read_b64_tr_b16 v[188:189], v242 offset:58368
    v_mfma_f32_16x16x32_bf16 v[88:91], v[136:139], v[192:195], v[88:91]
    ds_read_b128 v[136:139], v239 offset:47104
    v_mfma_f32_16x16x32_bf16 v[88:91], v[140:143], v[196:199], v[88:91]
    ds_read_b128 v[140:143], v240 offset:47104
    v_mfma_f32_16x16x32_bf16 v[96:99], v[144:147], v[192:195], v[96:99]
    ds_read_b64_tr_b16 v[190:191], v242 offset:58880
    v_mfma_f32_16x16x32_bf16 v[96:99], v[148:151], v[196:199], v[96:99]
    buffer_load_dwordx4 v221, s[16:19], s89 offen offset:1024 lds
    v_mfma_f32_16x16x32_bf16 v[100:103], v[144:147], v[200:203], v[100:103]
    ds_read_b128 v[144:147], v239 offset:49152
    v_mfma_f32_16x16x32_bf16 v[100:103], v[148:151], v[204:207], v[100:103]
    ds_read_b128 v[148:151], v240 offset:49152
    v_mfma_f32_16x16x32_bf16 v[108:111], v[152:155], v[200:203], v[108:111]
    ds_read_b64_tr_b16 v[200:201], v242 offset:47104
    v_mfma_f32_16x16x32_bf16 v[108:111], v[156:159], v[204:207], v[108:111]
    buffer_load_dwordx4 v222, s[16:19], s89 offen offset:2048 lds
    v_mfma_f32_16x16x32_bf16 v[104:107], v[152:155], v[192:195], v[104:107]
    ds_read_b128 v[152:155], v239 offset:51200
    v_mfma_f32_16x16x32_bf16 v[104:107], v[156:159], v[196:199], v[104:107]
    ds_read_b128 v[156:159], v240 offset:51200
    s_waitcnt lgkmcnt(3)
    v_mfma_f32_16x16x32_bf16 v[16:19], v[160:163], v[128:131], v[16:19]
    ds_read_b64_tr_b16 v[202:203], v242 offset:47616
    s_add_u32 m0, s58, 19456
    v_mfma_f32_16x16x32_bf16 v[16:19], v[164:167], v[132:135], v[16:19]
    buffer_load_dwordx4 v223, s[16:19], s89 offen offset:0 lds
    v_mfma_f32_16x16x32_bf16 v[20:23], v[168:171], v[128:131], v[20:23]
    ds_read_b64_tr_b16 v[204:205], v242 offset:59392
    v_mfma_f32_16x16x32_bf16 v[20:23], v[172:175], v[132:135], v[20:23]
    ds_read_b64_tr_b16 v[206:207], v242 offset:59904
    v_mfma_f32_16x16x32_bf16 v[28:31], v[168:171], v[136:139], v[28:31]
    ds_read_b64_tr_b16 v[192:193], v241 offset:47104
    v_mfma_f32_16x16x32_bf16 v[28:31], v[172:175], v[140:143], v[28:31]
    ds_read_b64_tr_b16 v[194:195], v241 offset:47616
    v_mfma_f32_16x16x32_bf16 v[24:27], v[160:163], v[136:139], v[24:27]
    ds_read_b64_tr_b16 v[196:197], v241 offset:59392
    v_mfma_f32_16x16x32_bf16 v[24:27], v[164:167], v[140:143], v[24:27]
    buffer_load_dwordx4 v224, s[16:19], s89 offen offset:1024 lds
    v_mfma_f32_16x16x32_bf16 v[32:35], v[160:163], v[144:147], v[32:35]
    ds_read_b64_tr_b16 v[198:199], v241 offset:59904
    v_mfma_f32_16x16x32_bf16 v[32:35], v[164:167], v[148:151], v[32:35]
    v_mfma_f32_16x16x32_bf16 v[36:39], v[168:171], v[144:147], v[36:39]
    v_mfma_f32_16x16x32_bf16 v[36:39], v[172:175], v[148:151], v[36:39]
    buffer_load_dwordx4 v225, s[16:19], s89 offen offset:2048 lds
    s_waitcnt lgkmcnt(1)
    v_mfma_f32_16x16x32_bf16 v[44:47], v[168:171], v[152:155], v[44:47]
    s_add_u32 s59, s59, 15
    s_and_b32 s59, s59, 15
    v_mfma_f32_16x16x32_bf16 v[44:47], v[172:175], v[156:159], v[44:47]
    s_lshl_b32 s88, s59, 7
    s_add_u32 m0, s56, 45056
    v_mfma_f32_16x16x32_bf16 v[40:43], v[160:163], v[152:155], v[40:43]
    s_mul_i32 s89, s59, 393216
    v_mfma_f32_16x16x32_bf16 v[40:43], v[164:167], v[156:159], v[40:43]
    s_waitcnt vmcnt(10) lgkmcnt(0)
    s_barrier
    v_mfma_f32_16x16x32_bf16 v[48:51], v[176:179], v[128:131], v[48:51]
    ds_read_b64_tr_b16 v[160:161], v228 offset:0
    v_mfma_f32_16x16x32_bf16 v[48:51], v[180:183], v[132:135], v[48:51]
    buffer_load_dwordx4 v216, s[8:11], s88 offen offset:0 lds
    v_mfma_f32_16x16x32_bf16 v[56:59], v[176:179], v[136:139], v[56:59]
    ds_read_b64_tr_b16 v[162:163], v228 offset:512
    v_mfma_f32_16x16x32_bf16 v[56:59], v[180:183], v[140:143], v[56:59]
    ds_read_b64_tr_b16 v[164:165], v228 offset:12288
    v_mfma_f32_16x16x32_bf16 v[64:67], v[176:179], v[144:147], v[64:67]
    ds_read_b64_tr_b16 v[166:167], v228 offset:12800
    v_mfma_f32_16x16x32_bf16 v[64:67], v[180:183], v[148:151], v[64:67]
    buffer_load_dwordx4 v217, s[8:11], s88 offen offset:1024 lds
    v_mfma_f32_16x16x32_bf16 v[72:75], v[176:179], v[152:155], v[72:75]
    ds_read_b64_tr_b16 v[168:169], v229 offset:0
    v_mfma_f32_16x16x32_bf16 v[72:75], v[180:183], v[156:159], v[72:75]
    ds_read_b64_tr_b16 v[170:171], v229 offset:512
    v_mfma_f32_16x16x32_bf16 v[76:79], v[184:187], v[152:155], v[76:79]
    ds_read_b64_tr_b16 v[172:173], v229 offset:12288
    v_mfma_f32_16x16x32_bf16 v[76:79], v[188:191], v[156:159], v[76:79]
    buffer_load_dwordx4 v218, s[8:11], s88 offen offset:2048 lds
    v_mfma_f32_16x16x32_bf16 v[68:71], v[184:187], v[144:147], v[68:71]
    ds_read_b64_tr_b16 v[174:175], v229 offset:12800
    v_mfma_f32_16x16x32_bf16 v[68:71], v[188:191], v[148:151], v[68:71]
    ds_read_b64_tr_b16 v[176:177], v228 offset:1024
    v_mfma_f32_16x16x32_bf16 v[60:63], v[184:187], v[136:139], v[60:63]
    ds_read_b64_tr_b16 v[178:179], v228 offset:1536
    v_mfma_f32_16x16x32_bf16 v[60:63], v[188:191], v[140:143], v[60:63]
    ds_read_b64_tr_b16 v[180:181], v228 offset:13312
    v_mfma_f32_16x16x32_bf16 v[52:55], v[184:187], v[128:131], v[52:55]
    ds_read_b64_tr_b16 v[182:183], v228 offset:13824
    v_mfma_f32_16x16x32_bf16 v[52:55], v[188:191], v[132:135], v[52:55]
    buffer_load_dwordx4 v219, s[8:11], s88 offen offset:3072 lds
    v_mfma_f32_16x16x32_bf16 v[80:83], v[128:131], v[192:195], v[80:83]
    ds_read_b64_tr_b16 v[184:185], v229 offset:1024
    v_mfma_f32_16x16x32_bf16 v[80:83], v[132:135], v[196:199], v[80:83]
    ds_read_b64_tr_b16 v[186:187], v229 offset:1536
    v_mfma_f32_16x16x32_bf16 v[84:87], v[128:131], v[200:203], v[84:87]
    ds_read_b128 v[128:131], v226 offset:0
    s_add_u32 m0, s58, 61440
    v_mfma_f32_16x16x32_bf16 v[84:87], v[132:135], v[204:207], v[84:87]
    buffer_load_dwordx4 v220, s[16:19], s89 offen offset:0 lds
    v_mfma_f32_16x16x32_bf16 v[92:95], v[136:139], v[200:203], v[92:95]
    ds_read_b128 v[132:135], v227 offset:0
    v_mfma_f32_16x16x32_bf16 v[92:95], v[140:143], v[204:207], v[92:95]
    ds_read_b64_tr_b16 v[188:189], v229 offset:13312
    v_mfma_f32_16x16x32_bf16 v[88:91], v[136:139], v[192:195], v[88:91]
    ds_read_b128 v[136:139], v226 offset:2048
    v_mfma_f32_16x16x32_bf16 v[88:91], v[140:143], v[196:199], v[88:91]
    ds_read_b128 v[140:143], v227 offset:2048
    v_mfma_f32_16x16x32_bf16 v[96:99], v[144:147], v[192:195], v[96:99]
    ds_read_b64_tr_b16 v[190:191], v229 offset:13824
    v_mfma_f32_16x16x32_bf16 v[96:99], v[148:151], v[196:199], v[96:99]
    buffer_load_dwordx4 v221, s[16:19], s89 offen offset:1024 lds
    v_mfma_f32_16x16x32_bf16 v[100:103], v[144:147], v[200:203], v[100:103]
    ds_read_b128 v[144:147], v226 offset:4096
    v_mfma_f32_16x16x32_bf16 v[100:103], v[148:151], v[204:207], v[100:103]
    ds_read_b128 v[148:151], v227 offset:4096
    v_mfma_f32_16x16x32_bf16 v[108:111], v[152:155], v[200:203], v[108:111]
    ds_read_b64_tr_b16 v[200:201], v229 offset:2048
    v_mfma_f32_16x16x32_bf16 v[108:111], v[156:159], v[204:207], v[108:111]
    buffer_load_dwordx4 v222, s[16:19], s89 offen offset:2048 lds
    v_mfma_f32_16x16x32_bf16 v[104:107], v[152:155], v[192:195], v[104:107]
    ds_read_b128 v[152:155], v226 offset:6144
    v_mfma_f32_16x16x32_bf16 v[104:107], v[156:159], v[196:199], v[104:107]
    ds_read_b128 v[156:159], v227 offset:6144
    s_waitcnt lgkmcnt(3)
    v_mfma_f32_16x16x32_bf16 v[16:19], v[160:163], v[128:131], v[16:19]
    ds_read_b64_tr_b16 v[202:203], v229 offset:2560
    s_add_u32 m0, s58, 64512
    v_mfma_f32_16x16x32_bf16 v[16:19], v[164:167], v[132:135], v[16:19]
    buffer_load_dwordx4 v223, s[16:19], s89 offen offset:0 lds
    v_mfma_f32_16x16x32_bf16 v[20:23], v[168:171], v[128:131], v[20:23]
    ds_read_b64_tr_b16 v[204:205], v229 offset:14336
    v_mfma_f32_16x16x32_bf16 v[20:23], v[172:175], v[132:135], v[20:23]
    ds_read_b64_tr_b16 v[206:207], v229 offset:14848
    v_mfma_f32_16x16x32_bf16 v[28:31], v[168:171], v[136:139], v[28:31]
    ds_read_b64_tr_b16 v[192:193], v228 offset:2048
    v_mfma_f32_16x16x32_bf16 v[28:31], v[172:175], v[140:143], v[28:31]
    ds_read_b64_tr_b16 v[194:195], v228 offset:2560
    v_mfma_f32_16x16x32_bf16 v[24:27], v[160:163], v[136:139], v[24:27]
    ds_read_b64_tr_b16 v[196:197], v228 offset:14336
    v_mfma_f32_16x16x32_bf16 v[24:27], v[164:167], v[140:143], v[24:27]
    buffer_load_dwordx4 v224, s[16:19], s89 offen offset:1024 lds
    v_mfma_f32_16x16x32_bf16 v[32:35], v[160:163], v[144:147], v[32:35]
    ds_read_b64_tr_b16 v[198:199], v228 offset:14848
    v_mfma_f32_16x16x32_bf16 v[32:35], v[164:167], v[148:151], v[32:35]
    v_mfma_f32_16x16x32_bf16 v[36:39], v[168:171], v[144:147], v[36:39]
    v_mfma_f32_16x16x32_bf16 v[36:39], v[172:175], v[148:151], v[36:39]
    buffer_load_dwordx4 v225, s[16:19], s89 offen offset:2048 lds
    s_waitcnt lgkmcnt(1)
    v_mfma_f32_16x16x32_bf16 v[44:47], v[168:171], v[152:155], v[44:47]
    s_add_u32 s59, s59, 15
    s_and_b32 s59, s59, 15
    v_mfma_f32_16x16x32_bf16 v[44:47], v[172:175], v[156:159], v[44:47]
    s_lshl_b32 s88, s59, 7
    s_add_u32 m0, s56, 90112
    v_mfma_f32_16x16x32_bf16 v[40:43], v[160:163], v[152:155], v[40:43]
    s_mul_i32 s89, s59, 393216
    s_cmp_lg_u32 s67, 0
    v_mfma_f32_16x16x32_bf16 v[40:43], v[164:167], v[156:159], v[40:43]
    s_waitcnt vmcnt(10) lgkmcnt(0)
    s_cbranch_scc1 L_loop_2
    s_barrier
    v_mfma_f32_16x16x32_bf16 v[48:51], v[176:179], v[128:131], v[48:51]
    ds_read_b64_tr_b16 v[160:161], v241 offset:0
    v_mfma_f32_16x16x32_bf16 v[48:51], v[180:183], v[132:135], v[48:51]
    ds_read_b64_tr_b16 v[162:163], v241 offset:512
    v_and_b32_e64 v1, 1, v0
    v_mfma_f32_16x16x32_bf16 v[56:59], v[176:179], v[136:139], v[56:59]
L_walkb_0:
    s_cbranch_execz L_walkedb
    s_nop 0
    ds_read_b64_tr_b16 v[164:165], v241 offset:12288
    v_cmp_eq_u32_e64 vcc, 0, v1
    v_mfma_f32_16x16x32_bf16 v[56:59], v[180:183], v[140:143], v[56:59]
    ds_read_b64_tr_b16 v[166:167], v241 offset:12800
    v_mov_b32 v2, 0x3f803f80
    v_mfma_f32_16x16x32_bf16 v[64:67], v[176:179], v[144:147], v[64:67]
    ds_read_b64_tr_b16 v[168:169], v242 offset:0
    v_cndmask_b32_e64 v208, 0, v2, vcc
    v_mfma_f32_16x16x32_bf16 v[64:67], v[180:183], v[148:151], v[64:67]
    ds_read_b64_tr_b16 v[170:171], v242 offset:512
    v_cndmask_b32_e64 v209, 0, v2, vcc
    v_mfma_f32_16x16x32_bf16 v[72:75], v[176:179], v[152:155], v[72:75]
    ds_read_b64_tr_b16 v[172:173], v242 offset:12288
    v_cndmask_b32_e64 v210, 0, v2, vcc
    v_mfma_f32_16x16x32_bf16 v[72:75], v[180:183], v[156:159], v[72:75]
    ds_read_b64_tr_b16 v[174:175], v242 offset:12800
    v_cndmask_b32_e64 v211, 0, v2, vcc
    v_mfma_f32_16x16x32_bf16 v[76:79], v[184:187], v[152:155], v[76:79]
    ds_read_b64_tr_b16 v[112:113], v248 offset:0
    v_sub_u32_e64 v212, v2, v208
    v_mfma_f32_16x16x32_bf16 v[76:79], v[188:191], v[156:159], v[76:79]
    ds_read_b64_tr_b16 v[114:115], v248 offset:1024
    v_sub_u32_e64 v213, v2, v208
    v_mfma_f32_16x16x32_bf16 v[68:71], v[184:187], v[144:147], v[68:71]
    ds_read_b64_tr_b16 v[116:117], v248 offset:32
    v_sub_u32_e64 v214, v2, v208
    v_mfma_f32_16x16x32_bf16 v[68:71], v[188:191], v[148:151], v[68:71]
    ds_read_b64_tr_b16 v[118:119], v248 offset:1056
    v_sub_u32_e64 v215, v2, v208
    v_mfma_f32_16x16x32_bf16 v[60:63], v[184:187], v[136:139], v[60:63]
    ds_read_b64_tr_b16 v[250:251], v248 offset:45056
    v_mfma_f32_16x16x32_bf16 v[60:63], v[188:191], v[140:143], v[60:63]
    ds_read_b64_tr_b16 v[252:253], v248 offset:46080
    v_mfma_f32_16x16x32_bf16 v[52:55], v[184:187], v[128:131], v[52:55]
    ds_read_b64_tr_b16 v[234:235], v248 offset:45088
    v_mfma_f32_16x16x32_bf16 v[52:55], v[188:191], v[132:135], v[52:55]
    ds_read_b64_tr_b16 v[236:237], v248 offset:46112
    v_mfma_f32_16x16x32_bf16 v[80:83], v[128:131], v[192:195], v[80:83]
    ds_read_b64_tr_b16 v[176:177], v241 offset:1024
    v_mfma_f32_16x16x32_bf16 v[80:83], v[132:135], v[196:199], v[80:83]
    ds_read_b64_tr_b16 v[178:179], v241 offset:1536
    v_mfma_f32_16x16x32_bf16 v[84:87], v[128:131], v[200:203], v[84:87]
    ds_read_b128 v[128:131], v239 offset:0
    v_mfma_f32_16x16x32_bf16 v[84:87], v[132:135], v[204:207], v[84:87]
    ds_read_b128 v[132:135], v240 offset:0
    v_mfma_f32_16x16x32_bf16 v[92:95], v[136:139], v[200:203], v[92:95]
    ds_read_b64_tr_b16 v[180:181], v241 offset:13312
    v_mfma_f32_16x16x32_bf16 v[92:95], v[140:143], v[204:207], v[92:95]
    ds_read_b64_tr_b16 v[182:183], v241 offset:13824
    v_mfma_f32_16x16x32_bf16 v[88:91], v[136:139], v[192:195], v[88:91]
    ds_read_b128 v[136:139], v239 offset:2048
    v_mfma_f32_16x16x32_bf16 v[88:91], v[140:143], v[196:199], v[88:91]
    ds_read_b128 v[140:143], v240 offset:2048
    v_mfma_f32_16x16x32_bf16 v[96:99], v[144:147], v[192:195], v[96:99]
    ds_read_b64_tr_b16 v[184:185], v242 offset:1024
    v_mfma_f32_16x16x32_bf16 v[96:99], v[148:151], v[196:199], v[96:99]
    ds_read_b64_tr_b16 v[186:187], v242 offset:1536
    v_mfma_f32_16x16x32_bf16 v[100:103], v[144:147], v[200:203], v[100:103]
    ds_read_b128 v[144:147], v239 offset:4096
    v_mfma_f32_16x16x32_bf16 v[100:103], v[148:151], v[204:207], v[100:103]
    ds_read_b128 v[148:151], v240 offset:4096
    v_mfma_f32_16x16x32_bf16 v[108:111], v[152:155], v[200:203], v[108:111]
    ds_read_b64_tr_b16 v[188:189], v242 offset:13312
    v_mfma_f32_16x16x32_bf16 v[108:111], v[156:159], v[204:207], v[108:111]
    ds_read_b64_tr_b16 v[190:191], v242 offset:13824
    v_mfma_f32_16x16x32_bf16 v[104:107], v[152:155], v[192:195], v[104:107]
    ds_read_b128 v[152:155], v239 offset:6144
    v_mfma_f32_16x16x32_bf16 v[104:107], v[156:159], v[196:199], v[104:107]
    ds_read_b128 v[156:159], v240 offset:6144
    s_waitcnt lgkmcnt(4)
    v_mfma_f32_16x16x32_bf16 v[16:19], v[160:163], v[128:131], v[16:19]
    ds_read_b64_tr_b16 v[200:201], v242 offset:2048
    v_mfma_f32_16x16x32_bf16 v[16:19], v[164:167], v[132:135], v[16:19]
    ds_read_b64_tr_b16 v[202:203], v242 offset:2560
    v_mfma_f32_16x16x32_bf16 v[20:23], v[168:171], v[128:131], v[20:23]
    ds_read_b64_tr_b16 v[204:205], v242 offset:14336
    v_mfma_f32_16x16x32_bf16 v[20:23], v[172:175], v[132:135], v[20:23]
    ds_read_b64_tr_b16 v[206:207], v242 offset:14848
    v_mfma_f32_16x16x32_bf16 v[28:31], v[168:171], v[136:139], v[28:31]
    ds_read_b64_tr_b16 v[192:193], v241 offset:2048
    v_mfma_f32_16x16x32_bf16 v[28:31], v[172:175], v[140:143], v[28:31]
    ds_read_b64_tr_b16 v[194:195], v241 offset:2560
    v_mfma_f32_16x16x32_bf16 v[24:27], v[160:163], v[136:139], v[24:27]
    ds_read_b64_tr_b16 v[196:197], v241 offset:14336
    v_mfma_f32_16x16x32_bf16 v[24:27], v[164:167], v[140:143], v[24:27]
    ds_read_b64_tr_b16 v[198:199], v241 offset:14848
    v_mfma_f32_16x16x32_bf16 v[32:35], v[160:163], v[144:147], v[32:35]
    v_mfma_f32_16x16x32_bf16 v[32:35], v[164:167], v[148:151], v[32:35]
    v_mfma_f32_16x16x32_bf16 v[36:39], v[168:171], v[144:147], v[36:39]
    v_mfma_f32_16x16x32_bf16 v[36:39], v[172:175], v[148:151], v[36:39]
    s_waitcnt lgkmcnt(0)
    v_mfma_f32_16x16x32_bf16 v[44:47], v[168:171], v[152:155], v[44:47]
    v_mfma_f32_16x16x32_bf16 v[44:47], v[172:175], v[156:159], v[44:47]
    v_mfma_f32_16x16x32_bf16 v[40:43], v[160:163], v[152:155], v[40:43]
    v_mfma_f32_16x16x32_bf16 v[40:43], v[164:167], v[156:159], v[40:43]
    s_waitcnt vmcnt(0) lgkmcnt(0)
    s_barrier
    v_mfma_f32_16x16x32_bf16 v[48:51], v[176:179], v[128:131], v[48:51]
    ds_read_b64_tr_b16 v[160:161], v241 offset:45056
    v_mfma_f32_16x16x32_bf16 v[48:51], v[180:183], v[132:135], v[48:51]
    ds_read_b64_tr_b16 v[162:163], v241 offset:45568
    v_bfe_u32 v1, v0, 2, 2
    v_mfma_f32_16x16x32_bf16 v[56:59], v[176:179], v[136:139], v[56:59]
    ds_read_b64_tr_b16 v[164:165], v241 offset:57344
    v_lshrrev_b32_e64 v2, 4, v0
    v_mfma_f32_16x16x32_bf16 v[56:59], v[180:183], v[140:143], v[56:59]
    ds_read_b64_tr_b16 v[166:167], v241 offset:57856
    v_cmp_eq_u32_e64 vcc, v1, v2
    v_mfma_f32_16x16x32_bf16 v[64:67], v[176:179], v[144:147], v[64:67]
    ds_read_b64_tr_b16 v[168:169], v242 offset:45056
    v_and_b32_e64 v1, 1, v0
    v_mfma_f32_16x16x32_bf16 v[64:67], v[180:183], v[148:151], v[64:67]
    ds_read_b64_tr_b16 v[170:171], v242 offset:45568
    v_lshlrev_b32_e64 v1, 4, v1
    v_mfma_f32_16x16x32_bf16 v[72:75], v[176:179], v[152:155], v[72:75]
    ds_read_b64_tr_b16 v[172:173], v242 offset:57344
    v_mov_b32 v2, 0x3f80
    v_mfma_f32_16x16x32_bf16 v[72:75], v[180:183], v[156:159], v[72:75]
    ds_read_b64_tr_b16 v[174:175], v242 offset:57856
    v_lshlrev_b32_e64 v1, v1, v2
    v_mfma_f32_16x16x32_bf16 v[76:79], v[184:187], v[152:155], v[76:79]
    ds_read_b64_tr_b16 v[176:177], v241 offset:46080
    v_cndmask_b32_e64 v1, 0, v1, vcc
    v_mfma_f32_16x16x32_bf16 v[76:79], v[188:191], v[156:159], v[76:79]
    ds_read_b64_tr_b16 v[178:179], v241 offset:46592
    v_and_b32_e64 v2, 2, v0
    v_mfma_f32_16x16x32_bf16 v[68:71], v[184:187], v[144:147], v[68:71]
    ds_read_b64_tr_b16 v[180:181], v241 offset:58368
    v_cmp_eq_u32_e64 vcc, 0, v2
    v_mfma_f32_16x16x32_bf16 v[68:71], v[188:191], v[148:151], v[68:71]
    ds_read_b64_tr_b16 v[182:183], v241 offset:58880
    v_mov_b32_e64 v10, 0
    v_mfma_f32_16x16x32_bf16 v[60:63], v[184:187], v[136:139], v[60:63]
    v_mov_b32_e64 v11, 0
    v_mfma_f32_16x16x32_bf16 v[60:63], v[188:191], v[140:143], v[60:63]
    v_cndmask_b32_e64 v8, 0, v1, vcc
    v_mfma_f32_16x16x32_bf16 v[52:55], v[184:187], v[128:131], v[52:55]
    ds_read_b64_tr_b16 v[184:185], v242 offset:46080
    v_mov_b32_e64 v120, 0
    v_mfma_f32_16x16x32_bf16 v[52:55], v[188:191], v[132:135], v[52:55]
    ds_read_b64_tr_b16 v[186:187], v242 offset:46592
    v_mov_b32_e64 v121, 0
    v_mfma_f32_16x16x32_bf16 v[80:83], v[128:131], v[192:195], v[80:83]
    ds_read_b64_tr_b16 v[188:189], v242 offset:58368
    v_sub_u32_e64 v9, v1, v8
    v_mfma_f32_16x16x32_bf16 v[80:83], v[132:135], v[196:199], v[80:83]
    ds_read_b64_tr_b16 v[190:191], v242 offset:58880
    v_mov_b32_e64 v122, v8
    v_mfma_f32_16x16x32_bf16 v[84:87], v[128:131], v[200:203], v[84:87]
    ds_read_b128 v[128:131], v239 offset:45056
    v_mov_b32_e64 v123, v9
    v_mfma_f32_16x16x32_bf16 v[84:87], v[132:135], v[204:207], v[84:87]
    ds_read_b128 v[132:135], v240 offset:45056
    v_mfma_f32_16x16x32_bf16 v[92:95], v[136:139], v[200:203], v[92:95]
    v_mfma_f32_16x16x32_bf16 v[92:95], v[140:143], v[204:207], v[92:95]
    v_mfma_f32_16x16x32_bf16 v[88:91], v[136:139], v[192:195], v[88:91]
    ds_read_b128 v[136:139], v239 offset:47104
    v_mfma_f32_16x16x32_bf16 v[88:91], v[140:143], v[196:199], v[88:91]
    ds_read_b128 v[140:143], v240 offset:47104
    v_mfma_f32_16x16x32_bf16 v[96:99], v[144:147], v[192:195], v[96:99]
    v_mfma_f32_16x16x32_bf16 v[96:99], v[148:151], v[196:199], v[96:99]
    v_mfma_f32_16x16x32_bf16 v[100:103], v[144:147], v[200:203], v[100:103]
    ds_read_b128 v[144:147], v239 offset:49152
    v_mfma_f32_16x16x32_bf16 v[100:103], v[148:151], v[204:207], v[100:103]
    ds_read_b128 v[148:151], v240 offset:49152
    v_mfma_f32_16x16x32_bf16 v[108:111], v[152:155], v[200:203], v[108:111]
    ds_read_b64_tr_b16 v[200:201], v242 offset:47104
    v_mfma_f32_16x16x32_bf16 v[108:111], v[156:159], v[204:207], v[108:111]
    ds_read_b64_tr_b16 v[202:203], v242 offset:47616
    v_mfma_f32_16x16x32_bf16 v[104:107], v[152:155], v[192:195], v[104:107]
    ds_read_b128 v[152:155], v239 offset:51200
    v_mfma_f32_16x16x32_bf16 v[104:107], v[156:159], v[196:199], v[104:107]
    ds_read_b128 v[156:159], v240 offset:51200
    s_waitcnt lgkmcnt(4)
    v_mfma_f32_16x16x32_bf16 v[16:19], v[160:163], v[128:131], v[16:19]
    ds_read_b64_tr_b16 v[204:205], v242 offset:59392
    v_mfma_f32_16x16x32_bf16 v[16:19], v[164:167], v[132:135], v[16:19]
    ds_read_b64_tr_b16 v[206:207], v242 offset:59904
    v_mfma_f32_16x16x32_bf16 v[20:23], v[168:171], v[128:131], v[20:23]
    ds_read_b64_tr_b16 v[192:193], v241 offset:47104
    v_mfma_f32_16x16x32_bf16 v[20:23], v[172:175], v[132:135], v[20:23]
    ds_read_b64_tr_b16 v[194:195], v241 offset:47616
    v_mfma_f32_16x16x32_bf16 v[28:31], v[168:171], v[136:139], v[28:31]
    ds_read_b64_tr_b16 v[196:197], v241 offset:59392
    v_mfma_f32_16x16x32_bf16 v[28:31], v[172:175], v[140:143], v[28:31]
    ds_read_b64_tr_b16 v[198:199], v241 offset:59904
    v_mfma_f32_16x16x32_bf16 v[24:27], v[160:163], v[136:139], v[24:27]
    v_mfma_f32_16x16x32_bf16 v[24:27], v[164:167], v[140:143], v[24:27]
    v_mfma_f32_16x16x32_bf16 v[32:35], v[160:163], v[144:147], v[32:35]
    v_mfma_f32_16x16x32_bf16 v[32:35], v[164:167], v[148:151], v[32:35]
    v_mfma_f32_16x16x32_bf16 v[36:39], v[168:171], v[144:147], v[36:39]
    v_mfma_f32_16x16x32_bf16 v[36:39], v[172:175], v[148:151], v[36:39]
    s_waitcnt lgkmcnt(0)
    v_mfma_f32_16x16x32_bf16 v[44:47], v[168:171], v[152:155], v[44:47]
    v_mfma_f32_16x16x32_bf16 v[44:47], v[172:175], v[156:159], v[44:47]
    v_mfma_f32_16x16x32_bf16 v[40:43], v[160:163], v[152:155], v[40:43]
    v_mfma_f32_16x16x32_bf16 v[40:43], v[164:167], v[156:159], v[40:43]
    s_waitcnt lgkmcnt(0)
    s_setprio 1
    s_barrier
    v_mfma_f32_16x16x32_bf16 v[48:51], v[176:179], v[128:131], v[48:51]
    v_mfma_f32_16x16x32_bf16 v[48:51], v[180:183], v[132:135], v[48:51]
    v_mfma_f32_16x16x32_bf16 v[56:59], v[176:179], v[136:139], v[56:59]
    v_mfma_f32_16x16x32_bf16 v[56:59], v[180:183], v[140:143], v[56:59]
    v_mfma_f32_16x16x32_bf16 v[64:67], v[176:179], v[144:147], v[64:67]
    v_mfma_f32_16x16x32_bf16 v[64:67], v[180:183], v[148:151], v[64:67]
    v_mfma_f32_16x16x32_bf16 v[72:75], v[176:179], v[152:155], v[72:75]
    v_mfma_f32_16x16x32_bf16 v[72:75], v[180:183], v[156:159], v[72:75]
    v_mfma_f32_16x16x32_bf16 v[76:79], v[184:187], v[152:155], v[76:79]
    v_mfma_f32_16x16x32_bf16 v[76:79], v[188:191], v[156:159], v[76:79]
    v_mfma_f32_16x16x32_bf16 v[68:71], v[184:187], v[144:147], v[68:71]
    v_mfma_f32_16x16x32_bf16 v[68:71], v[188:191], v[148:151], v[68:71]
    v_mfma_f32_16x16x32_bf16 v[60:63], v[184:187], v[136:139], v[60:63]
    v_mfma_f32_16x16x32_bf16 v[60:63], v[188:191], v[140:143], v[60:63]
    v_mfma_f32_16x16x32_bf16 v[52:55], v[184:187], v[128:131], v[52:55]
    v_mfma_f32_16x16x32_bf16 v[52:55], v[188:191], v[132:135], v[52:55]
    v_mfma_f32_16x16x32_bf16 v[80:83], v[128:131], v[192:195], v[80:83]
    v_mfma_f32_16x16x32_bf16 v[80:83], v[132:135], v[196:199], v[80:83]
    v_mfma_f32_16x16x32_bf16 v[84:87], v[128:131], v[200:203], v[84:87]
    v_mfma_f32_16x16x32_bf16 v[84:87], v[132:135], v[204:207], v[84:87]
    v_mfma_f32_16x16x32_bf16 v[92:95], v[136:139], v[200:203], v[92:95]
    v_mfma_f32_16x16x32_bf16 v[92:95], v[140:143], v[204:207], v[92:95]
    v_mfma_f32_16x16x32_bf16 v[88:91], v[136:139], v[192:195], v[88:91]
    v_mfma_f32_16x16x32_bf16 v[88:91], v[140:143], v[196:199], v[88:91]
    v_mfma_f32_16x16x32_bf16 v[96:99], v[144:147], v[192:195], v[96:99]
    v_mfma_f32_16x16x32_bf16 v[96:99], v[148:151], v[196:199], v[96:99]
    v_mfma_f32_16x16x32_bf16 v[100:103], v[144:147], v[200:203], v[100:103]
    v_mfma_f32_16x16x32_bf16 v[100:103], v[148:151], v[204:207], v[100:103]
    v_mfma_f32_16x16x32_bf16 v[108:111], v[152:155], v[200:203], v[108:111]
    v_mfma_f32_16x16x32_bf16 v[108:111], v[156:159], v[204:207], v[108:111]
    v_mfma_f32_16x16x32_bf16 v[104:107], v[152:155], v[192:195], v[104:107]
    v_mfma_f32_16x16x32_bf16 v[104:107], v[156:159], v[196:199], v[104:107]
    v_cvt_pk_bf16_f32 v144, v48, v49
    v_cvt_pk_bf16_f32 v145, v50, v51
    v_cvt_pk_bf16_f32 v146, v52, v53
    v_cvt_pk_bf16_f32 v147, v54, v55
    v_cvt_pk_bf16_f32 v148, v56, v57
    v_cvt_pk_bf16_f32 v149, v58, v59
    v_cvt_pk_bf16_f32 v150, v60, v61
    v_cvt_pk_bf16_f32 v151, v62, v63
    v_mfma_f32_16x16x32_bf16 v[48:51], v[112:115], v[144:147], 0
    v_mfma_f32_16x16x32_bf16 v[52:55], v[116:119], v[144:147], 0
    v_mfma_f32_16x16x32_bf16 v[56:59], v[112:115], v[148:151], 0
    v_mfma_f32_16x16x32_bf16 v[60:63], v[116:119], v[148:151], 0
    s_nop 4
    v_max3_f32 v152, v48, v49, v50
    v_max3_f32 v153, -v48, -v49, -v50
    v_max3_f32 v154, v56, v57, v58
    v_max3_f32 v155, -v56, -v57, -v58
    s_barrier
    v_max3_f32 v152, v152, v51, v52
    v_max3_f32 v153, v153, -v51, -v52
    v_max3_f32 v154, v154, v59, v60
    v_max3_f32 v155, v155, -v59, -v60
    v_max3_f32 v152, v152, v53, v54
    v_max3_f32 v153, v153, -v53, -v54
    v_max3_f32 v154, v154, v61, v62
    v_max3_f32 v155, v155, -v61, -v62
    v_max_f32_e64 v152, v152, v55
    v_max_f32_e64 v153, v153, -v55
    v_max_f32_e64 v154, v154, v63
    v_max_f32_e64 v155, v155, -v63
    s_nop 0
    v_permlane32_swap_b32 v152, v154
    v_permlane32_swap_b32 v153, v155
    v_max_f32 v152, v152, v154
    v_max_f32 v153, v153, v155
    s_nop 1
    v_permlane16_swap_b32 v152, v153
    v_max_f32 v152, v152, v153
    v_mul_f32 v152, s97, v152
    v_mov_b32 v153, v152
    s_nop 1
    v_permlane16_swap_b32 v152, v153
    v_mov_b32 v154, v152
    v_mov_b32 v155, v153
    s_nop 0
    v_permlane32_swap_b32 v152, v154
    v_permlane32_swap_b32 v153, v155
    v_fma_f32 v128, v48, s97, v153
    v_fma_f32 v129, v49, s97, v153
    v_fma_f32 v130, v50, s97, v153
    v_fma_f32 v131, v51, s97, v153
    v_fma_f32 v132, v52, s97, v153
    v_fma_f32 v133, v53, s97, v153
    v_fma_f32 v134, v54, s97, v153
    v_fma_f32 v135, v55, s97, v153
    v_fma_f32 v48, v48, s96, v152
    v_fma_f32 v49, v49, s96, v152
    v_fma_f32 v50, v50, s96, v152
    v_fma_f32 v51, v51, s96, v152
    v_fma_f32 v52, v52, s96, v152
    v_fma_f32 v53, v53, s96, v152
    v_fma_f32 v54, v54, s96, v152
    v_fma_f32 v55, v55, s96, v152
    v_exp_f32 v128, v128
    v_exp_f32 v129, v129
    v_exp_f32 v130, v130
    v_exp_f32 v131, v131
    v_exp_f32 v132, v132
    v_exp_f32 v133, v133
    v_exp_f32 v134, v134
    v_exp_f32 v135, v135
    v_exp_f32 v48, v48
    v_exp_f32 v49, v49
    v_exp_f32 v50, v50
    v_exp_f32 v51, v51
    v_exp_f32 v52, v52
    v_exp_f32 v53, v53
    v_exp_f32 v54, v54
    v_exp_f32 v55, v55
    v_fma_f32 v136, v56, s97, v155
    v_fma_f32 v137, v57, s97, v155
    v_fma_f32 v138, v58, s97, v155
    v_fma_f32 v139, v59, s97, v155
    v_fma_f32 v140, v60, s97, v155
    v_fma_f32 v141, v61, s97, v155
    v_fma_f32 v142, v62, s97, v155
    v_fma_f32 v143, v63, s97, v155
    v_fma_f32 v56, v56, s96, v154
    v_fma_f32 v57, v57, s96, v154
    v_fma_f32 v58, v58, s96, v154
    s_barrier
    v_fma_f32 v59, v59, s96, v154
    v_fma_f32 v60, v60, s96, v154
    v_fma_f32 v61, v61, s96, v154
    v_fma_f32 v62, v62, s96, v154
    v_fma_f32 v63, v63, s96, v154
    v_exp_f32 v136, v136
    v_exp_f32 v137, v137
    v_exp_f32 v138, v138
    v_exp_f32 v139, v139
    v_exp_f32 v140, v140
    v_exp_f32 v141, v141
    v_exp_f32 v142, v142
    v_exp_f32 v143, v143
    v_exp_f32 v56, v56
    v_exp_f32 v57, v57
    v_exp_f32 v58, v58
    v_exp_f32 v59, v59
    v_exp_f32 v60, v60
    v_exp_f32 v61, v61
    v_exp_f32 v62, v62
    v_exp_f32 v63, v63
    v_add_f32 v152, v48, v49
    v_add_f32 v153, v128, v129
    v_add_f32 v154, v56, v57
    v_add_f32 v155, v136, v137
    v_add_f32 v152, v152, v50
    v_add_f32 v153, v153, v130
    v_add_f32 v154, v154, v58
    v_add_f32 v155, v155, v138
    v_add_f32 v152, v152, v51
    v_add_f32 v153, v153, v131
    v_add_f32 v154, v154, v59
    v_add_f32 v155, v155, v139
    v_add_f32 v152, v152, v52
    v_add_f32 v153, v153, v132
    v_add_f32 v154, v154, v60
    v_add_f32 v155, v155, v140
    v_add_f32 v152, v152, v53
    v_add_f32 v153, v153, v133
    v_add_f32 v154, v154, v61
    v_add_f32 v155, v155, v141
    v_add_f32 v152, v152, v54
    v_add_f32 v153, v153, v134
    v_add_f32 v154, v154, v62
    v_add_f32 v155, v155, v142
    v_add_f32 v152, v152, v55
    v_add_f32 v153, v153, v135
    v_add_f32 v154, v154, v63
    v_add_f32 v155, v155, v143
    s_nop 0
    v_permlane32_swap_b32 v152, v154
    v_permlane32_swap_b32 v153, v155
    v_add_f32 v152, v152, v154
    v_add_f32 v153, v153, v155
    s_nop 1
    v_permlane16_swap_b32 v152, v153
    v_add_f32 v152, v152, v153
    v_rcp_f32 v152, v152
    s_nop 0
    v_mov_b32 v153, v152
    s_nop 1
    v_permlane16_swap_b32 v152, v153
    v_mov_b32 v154, v152
    v_mov_b32 v155, v153
    s_nop 0
    v_permlane32_swap_b32 v152, v154
    v_permlane32_swap_b32 v153, v155
    v_mul_f32 v48, v152, v48
    v_mul_f32 v49, v152, v49
    v_mul_f32 v50, v152, v50
    v_mul_f32 v51, v152, v51
    v_mul_f32 v52, v152, v52
    s_barrier
    v_mul_f32 v53, v152, v53
    v_mul_f32 v54, v152, v54
    v_mul_f32 v55, v152, v55
    v_mul_f32 v128, v153, v128
    v_mul_f32 v129, v153, v129
    v_mul_f32 v130, v153, v130
    v_mul_f32 v131, v153, v131
    v_mul_f32 v132, v153, v132
    v_mul_f32 v133, v153, v133
    v_mul_f32 v134, v153, v134
    v_mul_f32 v135, v153, v135
    v_mul_f32 v56, v154, v56
    v_mul_f32 v57, v154, v57
    v_mul_f32 v58, v154, v58
    v_mul_f32 v59, v154, v59
    v_mul_f32 v60, v154, v60
    v_mul_f32 v61, v154, v61
    v_mul_f32 v62, v154, v62
    v_mul_f32 v63, v154, v63
    v_mul_f32 v136, v155, v136
    v_mul_f32 v137, v155, v137
    v_mul_f32 v138, v155, v138
    v_mul_f32 v139, v155, v139
    v_mul_f32 v140, v155, v140
    v_mul_f32 v141, v155, v141
    v_mul_f32 v142, v155, v142
    v_mul_f32 v143, v155, v143
    v_cvt_pk_bf16_f32 v48, v48, v49
    v_cvt_pk_bf16_f32 v49, v50, v51
    v_cvt_pk_bf16_f32 v50, v52, v53
    v_cvt_pk_bf16_f32 v51, v54, v55
    v_cvt_pk_bf16_f32 v52, v128, v129
    v_cvt_pk_bf16_f32 v53, v130, v131
    v_cvt_pk_bf16_f32 v54, v132, v133
    v_cvt_pk_bf16_f32 v55, v134, v135
    v_cvt_pk_bf16_f32 v56, v56, v57
    v_cvt_pk_bf16_f32 v57, v58, v59
    v_cvt_pk_bf16_f32 v58, v60, v61
    v_cvt_pk_bf16_f32 v59, v62, v63
    v_cvt_pk_bf16_f32 v60, v136, v137
    v_cvt_pk_bf16_f32 v61, v138, v139
    v_cvt_pk_bf16_f32 v62, v140, v141
    v_cvt_pk_bf16_f32 v63, v142, v143
    v_cvt_pk_bf16_f32 v144, v64, v65
    v_cvt_pk_bf16_f32 v145, v66, v67
    v_cvt_pk_bf16_f32 v146, v68, v69
    v_cvt_pk_bf16_f32 v147, v70, v71
    v_cvt_pk_bf16_f32 v148, v72, v73
    v_cvt_pk_bf16_f32 v149, v74, v75
    v_cvt_pk_bf16_f32 v150, v76, v77
    v_cvt_pk_bf16_f32 v151, v78, v79
    v_mfma_f32_16x16x32_bf16 v[64:67], v[112:115], v[144:147], 0
    v_mfma_f32_16x16x32_bf16 v[68:71], v[116:119], v[144:147], 0
    v_mfma_f32_16x16x32_bf16 v[72:75], v[112:115], v[148:151], 0
    v_mfma_f32_16x16x32_bf16 v[76:79], v[116:119], v[148:151], 0
    s_nop 4
    v_max3_f32 v152, v64, v65, v66
    v_max3_f32 v153, -v64, -v65, -v66
    v_mfma_f32_16x16x32_bf16 v[216:219], v[48:51], v[8:11], 0
    v_max3_f32 v154, v72, v73, v74
    v_max3_f32 v155, -v72, -v73, -v74
    v_max3_f32 v152, v152, v67, v68
    v_max3_f32 v153, v153, -v67, -v68
    v_max3_f32 v154, v154, v75, v76
    v_max3_f32 v155, v155, -v75, -v76
    v_max3_f32 v152, v152, v69, v70
    v_max3_f32 v153, v153, -v69, -v70
    v_max3_f32 v154, v154, v77, v78
    v_max3_f32 v155, v155, -v77, -v78
    v_max_f32_e64 v152, v152, v71
    v_max_f32_e64 v153, v153, -v71
    v_mfma_f32_16x16x32_bf16 v[220:223], v[56:59], v[8:11], 0
    v_max_f32_e64 v154, v154, v79
    v_max_f32_e64 v155, v155, -v79
    s_nop 0
    v_permlane32_swap_b32 v152, v154
    v_permlane32_swap_b32 v153, v155
    v_max_f32 v152, v152, v154
    v_max_f32 v153, v153, v155
    s_nop 1
    v_permlane16_swap_b32 v152, v153
    s_barrier
    v_max_f32 v152, v152, v153
    v_mul_f32 v152, s97, v152
    v_mov_b32 v153, v152
    v_mfma_f32_16x16x32_bf16 v[224:227], v[48:51], v[120:123], 0
    s_nop 0
    v_permlane16_swap_b32 v152, v153
    v_mov_b32 v154, v152
    v_mov_b32 v155, v153
    s_nop 0
    v_permlane32_swap_b32 v152, v154
    s_nop 0
    v_permlane32_swap_b32 v153, v155
    v_fma_f32 v128, v64, s97, v153
    v_fma_f32 v129, v65, s97, v153
    v_fma_f32 v130, v66, s97, v153
    v_fma_f32 v131, v67, s97, v153
    v_fma_f32 v132, v68, s97, v153
    v_mfma_f32_16x16x32_bf16 v[228:231], v[56:59], v[120:123], 0
    v_fma_f32 v133, v69, s97, v153
    v_fma_f32 v134, v70, s97, v153
    v_cvt_pk_bf16_f32 v80, v80, v81
    v_cvt_pk_bf16_f32 v81, v82, v83
    v_cvt_pk_bf16_f32 v82, v88, v89
    v_cvt_pk_bf16_f32 v83, v90, v91
    v_cvt_pk_bf16_f32 v84, v84, v85
    v_cvt_pk_bf16_f32 v85, v86, v87
    v_cvt_pk_bf16_f32 v86, v92, v93
    v_cvt_pk_bf16_f32 v87, v94, v95
    v_cvt_pk_bf16_f32 v88, v216, v217
    v_cvt_pk_bf16_f32 v89, v218, v219
    v_cvt_pk_bf16_f32 v90, v220, v221
    v_cvt_pk_bf16_f32 v91, v222, v223
    v_cvt_pk_bf16_f32 v92, v224, v225
    v_cvt_pk_bf16_f32 v93, v226, v227
    v_cvt_pk_bf16_f32 v94, v228, v229
    v_cvt_pk_bf16_f32 v95, v230, v231
    v_fma_f32 v135, v71, s97, v153
    v_fma_f32 v64, v64, s96, v152
    v_fma_f32 v65, v65, s96, v152
    v_fma_f32 v66, v66, s96, v152
    v_fma_f32 v67, v67, s96, v152
    v_fma_f32 v68, v68, s96, v152
    v_fma_f32 v69, v69, s96, v152
    v_fma_f32 v70, v70, s96, v152
    v_fma_f32 v71, v71, s96, v152
    v_exp_f32 v128, v128
    v_exp_f32 v129, v129
    v_exp_f32 v130, v130
    v_exp_f32 v131, v131
    v_exp_f32 v132, v132
    v_exp_f32 v133, v133
    v_exp_f32 v134, v134
    v_exp_f32 v135, v135
    v_exp_f32 v64, v64
    v_exp_f32 v65, v65
    v_exp_f32 v66, v66
    v_exp_f32 v67, v67
    v_exp_f32 v68, v68
    v_exp_f32 v69, v69
    v_exp_f32 v70, v70
    v_exp_f32 v71, v71
    v_fma_f32 v136, v72, s97, v155
    v_mfma_f32_16x16x32_bf16 v[216:219], v[52:55], v[8:11], 0
    v_mfma_f32_16x16x32_bf16 v[220:223], v[60:63], v[8:11], 0
    v_mfma_f32_16x16x32_bf16 v[224:227], v[52:55], v[120:123], 0
    v_mfma_f32_16x16x32_bf16 v[228:231], v[60:63], v[120:123], 0
    s_barrier
    v_fma_f32 v137, v73, s97, v155
    v_fma_f32 v138, v74, s97, v155
    v_fma_f32 v139, v75, s97, v155
    v_fma_f32 v140, v76, s97, v155
    v_fma_f32 v141, v77, s97, v155
    v_fma_f32 v142, v78, s97, v155
    v_fma_f32 v143, v79, s97, v155
    v_fma_f32 v72, v72, s96, v154
    v_fma_f32 v73, v73, s96, v154
    v_fma_f32 v74, v74, s96, v154
    v_mfma_f32_16x16x32_bf16 v[168:171], v[88:91], v[80:83], 0
    v_fma_f32 v75, v75, s96, v154
    v_fma_f32 v76, v76, s96, v154
    v_fma_f32 v77, v77, s96, v154
    v_fma_f32 v78, v78, s96, v154
    v_fma_f32 v79, v79, s96, v154
    v_exp_f32 v136, v136
    v_exp_f32 v137, v137
    v_exp_f32 v138, v138
    v_exp_f32 v139, v139
    v_exp_f32 v140, v140
    v_exp_f32 v141, v141
    v_exp_f32 v142, v142
    v_exp_f32 v143, v143
    v_exp_f32 v72, v72
    v_exp_f32 v73, v73
    v_exp_f32 v74, v74
    v_exp_f32 v75, v75
    v_exp_f32 v76, v76
    v_exp_f32 v77, v77
    v_exp_f32 v78, v78
    v_exp_f32 v79, v79
    v_add_f32 v152, v64, v65
    v_mfma_f32_16x16x32_bf16 v[176:179], v[88:91], v[84:87], 0
    v_mfma_f32_16x16x32_bf16 v[200:203], v[88:91], v[208:211], 0
    v_mfma_f32_16x16x32_bf16 v[172:175], v[92:95], v[80:83], 0
    v_add_f32 v153, v128, v129
    v_add_f32 v154, v72, v73
    v_add_f32 v155, v136, v137
    v_add_f32 v152, v152, v66
    v_mfma_f32_16x16x32_bf16 v[180:183], v[92:95], v[84:87], 0
    v_add_f32 v153, v153, v130
    v_add_f32 v154, v154, v74
    v_add_f32 v155, v155, v138
    v_add_f32 v152, v152, v67
    v_add_f32 v153, v153, v131
    v_add_f32 v154, v154, v75
    v_add_f32 v155, v155, v139
    v_add_f32 v152, v152, v68
    v_add_f32 v153, v153, v132
    v_add_f32 v154, v154, v76
    v_add_f32 v155, v155, v140
    v_add_f32 v152, v152, v69
    v_mfma_f32_16x16x32_bf16 v[200:203], v[92:95], v[212:215], v[200:203]
    v_add_f32 v153, v153, v133
    v_add_f32 v154, v154, v77
    v_cvt_pk_bf16_f32 v160, v216, v217
    v_cvt_pk_bf16_f32 v161, v218, v219
    v_cvt_pk_bf16_f32 v162, v220, v221
    v_cvt_pk_bf16_f32 v163, v222, v223
    v_cvt_pk_bf16_f32 v164, v224, v225
    v_cvt_pk_bf16_f32 v165, v226, v227
    s_barrier
    v_cvt_pk_bf16_f32 v166, v228, v229
    v_cvt_pk_bf16_f32 v167, v230, v231
    v_add_f32 v155, v155, v141
    v_add_f32 v152, v152, v70
    v_add_f32 v153, v153, v134
    v_add_f32 v154, v154, v78
    v_add_f32 v155, v155, v142
    v_add_f32 v152, v152, v71
    v_add_f32 v153, v153, v135
    v_add_f32_e64 v154, v154, v79
    v_mfma_f32_16x16x32_bf16 v[184:187], v[160:163], v[80:83], 0
    v_add_f32 v155, v155, v143
    v_permlane32_swap_b32 v152, v154
    s_nop 0
    v_permlane32_swap_b32 v153, v155
L_walkb_1:
    s_cbranch_execz L_walkedb
    s_nop 0
    v_add_f32 v152, v152, v154
    v_add_f32 v153, v153, v155
    s_nop 1
    v_permlane16_swap_b32 v152, v153
    v_add_f32 v152, v152, v153
    v_rcp_f32 v152, v152
    s_nop 0
    v_mov_b32 v153, v152
    v_mfma_f32_16x16x32_bf16 v[192:195], v[160:163], v[84:87], 0
    s_nop 0
    v_permlane16_swap_b32 v152, v153
    v_mov_b32 v154, v152
    v_mov_b32 v155, v153
    s_nop 0
    v_permlane32_swap_b32 v152, v154
    v_permlane32_swap_b32 v153, v155
    v_mul_f32 v64, v152, v64
    v_mul_f32 v65, v152, v65
    v_mul_f32 v66, v152, v66
    v_mul_f32 v67, v152, v67
    v_mul_f32 v68, v152, v68
    v_mul_f32 v69, v152, v69
    v_mul_f32 v70, v152, v70
    v_mfma_f32_16x16x32_bf16 v[204:207], v[160:163], v[208:211], 0
    v_mul_f32 v71, v152, v71
    v_mul_f32 v128, v153, v128
    v_mul_f32 v129, v153, v129
    v_mul_f32 v130, v153, v130
    v_mul_f32 v131, v153, v131
    v_mul_f32 v132, v153, v132
    v_mul_f32 v133, v153, v133
    v_mul_f32 v134, v153, v134
    v_mul_f32 v135, v153, v135
    v_mul_f32 v72, v154, v72
    v_mfma_f32_16x16x32_bf16 v[188:191], v[164:167], v[80:83], 0
    v_mul_f32 v73, v154, v73
    v_mul_f32 v74, v154, v74
    v_mul_f32 v75, v154, v75
    v_mul_f32 v76, v154, v76
    v_mul_f32 v77, v154, v77
    v_mul_f32 v78, v154, v78
    v_mul_f32 v79, v154, v79
    v_mul_f32 v136, v155, v136
    v_mul_f32 v137, v155, v137
    v_mul_f32 v138, v155, v138
    v_mfma_f32_16x16x32_bf16 v[196:199], v[164:167], v[84:87], 0
    v_mul_f32 v139, v155, v139
    v_mul_f32 v140, v155, v140
    v_mul_f32 v141, v155, v141
    v_mul_f32 v142, v155, v142
    v_mul_f32_e64 v143, v155, v143
    v_cvt_pk_bf16_f32 v64, v64, v65
    v_cvt_pk_bf16_f32 v65, v66, v67
    v_cvt_pk_bf16_f32 v66, v68, v69
    v_cvt_pk_bf16_f32 v67, v70, v71
    v_cvt_pk_bf16_f32 v68, v128, v129
    v_cvt_pk_bf16_f32 v69, v130, v131
    v_cvt_pk_bf16_f32 v70, v132, v133
    v_mfma_f32_16x16x32_bf16 v[204:207], v[164:167], v[212:215], v[204:207]
    v_cvt_pk_bf16_f32 v71, v134, v135
    v_cvt_pk_bf16_f32 v72, v72, v73
    v_cvt_pk_bf16_f32 v73, v74, v75
    v_cvt_pk_bf16_f32 v74, v76, v77
    v_cvt_pk_bf16_f32 v75, v78, v79
    v_cvt_pk_bf16_f32 v76, v136, v137
    v_cvt_pk_bf16_f32 v77, v138, v139
    v_cvt_pk_bf16_f32 v78, v140, v141
    s_barrier
    v_cvt_pk_bf16_f32 v79, v142, v143
    v_mfma_f32_16x16x32_bf16 v[128:131], v[64:67], v[8:11], 0
    v_mfma_f32_16x16x32_bf16 v[132:135], v[72:75], v[8:11], 0
    v_mfma_f32_16x16x32_bf16 v[136:139], v[64:67], v[120:123], 0
    v_mfma_f32_16x16x32_bf16 v[140:143], v[72:75], v[120:123], 0
    v_cvt_pk_bf16_f32 v96, v96, v97
    v_cvt_pk_bf16_f32 v97, v98, v99
    v_cvt_pk_bf16_f32 v98, v104, v105
    v_cvt_pk_bf16_f32 v99, v106, v107
    v_mfma_f32_16x16x32_bf16 v[216:219], v[68:71], v[8:11], 0
    v_mfma_f32_16x16x32_bf16 v[220:223], v[76:79], v[8:11], 0
    v_mfma_f32_16x16x32_bf16 v[224:227], v[68:71], v[120:123], 0
    v_mfma_f32_16x16x32_bf16 v[228:231], v[76:79], v[120:123], 0
    v_cvt_pk_bf16_f32 v100, v100, v101
    v_cvt_pk_bf16_f32 v101, v102, v103
    v_cvt_pk_bf16_f32 v102, v108, v109
    v_cvt_pk_bf16_f32 v103, v110, v111
    v_cvt_pk_bf16_f32 v144, v128, v129
    v_cvt_pk_bf16_f32 v145, v130, v131
    v_cvt_pk_bf16_f32 v146, v132, v133
    v_cvt_pk_bf16_f32 v147, v134, v135
    v_cvt_pk_bf16_f32 v148, v136, v137
    v_cvt_pk_bf16_f32 v149, v138, v139
    v_cvt_pk_bf16_f32 v150, v140, v141
    v_cvt_pk_bf16_f32 v151, v142, v143
    v_cvt_pk_bf16_f32 v160, v216, v217
    v_cvt_pk_bf16_f32 v161, v218, v219
    v_cvt_pk_bf16_f32 v162, v220, v221
    v_cvt_pk_bf16_f32 v163, v222, v223
    v_cvt_pk_bf16_f32 v164, v224, v225
    v_cvt_pk_bf16_f32 v165, v226, v227
    v_cvt_pk_bf16_f32 v166, v228, v229
    v_cvt_pk_bf16_f32 v167, v230, v231
    v_mfma_f32_16x16x32_bf16 v[168:171], v[144:147], v[96:99], v[168:171]
    v_mfma_f32_16x16x32_bf16 v[176:179], v[144:147], v[100:103], v[176:179]
    v_mfma_f32_16x16x32_bf16 v[200:203], v[144:147], v[208:211], v[200:203]
    v_mfma_f32_16x16x32_bf16 v[172:175], v[148:151], v[96:99], v[172:175]
    v_mfma_f32_16x16x32_bf16 v[180:183], v[148:151], v[100:103], v[180:183]
    v_mfma_f32_16x16x32_bf16 v[200:203], v[148:151], v[212:215], v[200:203]
    v_mfma_f32_16x16x32_bf16 v[184:187], v[160:163], v[96:99], v[184:187]
    v_mfma_f32_16x16x32_bf16 v[192:195], v[160:163], v[100:103], v[192:195]
    v_mfma_f32_16x16x32_bf16 v[204:207], v[160:163], v[208:211], v[204:207]
    v_mfma_f32_16x16x32_bf16 v[188:191], v[164:167], v[96:99], v[188:191]
    v_mfma_f32_16x16x32_bf16 v[196:199], v[164:167], v[100:103], v[196:199]
    v_mfma_f32_16x16x32_bf16 v[204:207], v[164:167], v[212:215], v[204:207]
    v_cvt_pk_bf16_f32 v144, v16, v17
    v_cvt_pk_bf16_f32 v145, v18, v19
    v_cvt_pk_bf16_f32 v146, v20, v21
    v_cvt_pk_bf16_f32 v147, v22, v23
    v_cvt_pk_bf16_f32 v148, v24, v25
    v_cvt_pk_bf16_f32 v149, v26, v27
    v_cvt_pk_bf16_f32 v150, v28, v29
    v_cvt_pk_bf16_f32 v151, v30, v31
    v_cvt_pk_bf16_f32 v168, v168, v169
    v_cvt_pk_bf16_f32 v169, v170, v171
    v_cvt_pk_bf16_f32 v170, v172, v173
    v_cvt_pk_bf16_f32 v171, v174, v175
    s_mov_b32 s91, 0
    buffer_store_dwordx4 v[168:171], v124, s[28:31], s91 offen sc1
    v_cvt_pk_bf16_f32 v176, v176, v177
    v_cvt_pk_bf16_f32 v177, v178, v179
    v_cvt_pk_bf16_f32 v178, v180, v181
    v_cvt_pk_bf16_f32 v179, v182, v183
    s_mov_b32 s91, 32768
    buffer_store_dwordx4 v[176:179], v124, s[28:31], s91 offen sc1
    v_cvt_pk_bf16_f32 v184, v184, v185
    v_cvt_pk_bf16_f32 v185, v186, v187
    v_cvt_pk_bf16_f32 v186, v188, v189
    s_barrier
    s_and_b32 s64, s55, -8
    s_lshl_b32 s65, s4, 1
    s_add_u32 s64, s64, s65
    s_lshl_b32 s64, s64, 7
    s_add_u32 s64, s64, 27729920
    s_load_dword s74, s[86:87], s64 glc
    s_add_u32 s64, s64, 128
    s_load_dword s75, s[86:87], s64 glc
    v_cvt_pk_bf16_f32 v187, v190, v191
    s_mov_b32 s91, 65536
    buffer_store_dwordx4 v[184:187], v124, s[28:31], s91 offen sc1
    v_cvt_pk_bf16_f32 v192, v192, v193
    v_cvt_pk_bf16_f32 v193, v194, v195
    v_cvt_pk_bf16_f32 v194, v196, v197
    v_cvt_pk_bf16_f32 v195, v198, v199
    s_mov_b32 s91, 98304
    buffer_store_dwordx4 v[192:195], v124, s[28:31], s91 offen sc1
    v_and_b32 v1, 2, v0
    v_cmp_eq_u32 vcc, 0, v1
    s_nop 1
    v_cndmask_b32 v200, v204, v200, vcc
    v_cndmask_b32 v201, v205, v201, vcc
    v_cndmask_b32 v202, v206, v202, vcc
    v_cndmask_b32 v203, v207, v203, vcc
    buffer_store_dwordx4 v[200:203], v125, s[28:31], 0 offen sc1
    v_and_b32 v1, 1, v0
    v_lshlrev_b32 v1, 4, v1
    v_mov_b32 v2, 0x3f80
    v_lshlrev_b32_e64 v1, v1, v2
    v_bfe_u32 v2, v0, 1, 3
    v_mov_b32 v156, 0x3f803f80
    v_cmp_eq_u32 vcc, 0, v2
    s_nop 1
    v_cndmask_b32 v164, 0, v1, vcc
    v_cmp_eq_u32 vcc, 1, v2
    s_nop 1
    v_cndmask_b32 v165, 0, v1, vcc
    v_cmp_eq_u32 vcc, 2, v2
    s_nop 1
    v_cndmask_b32 v166, 0, v1, vcc
    v_cmp_eq_u32 vcc, 3, v2
    s_nop 1
    v_cndmask_b32 v167, 0, v1, vcc
    v_mfma_f32_16x16x32_bf16 v[16:19], v[250:253], v[144:147], 0
    v_mfma_f32_16x16x32_bf16 v[20:23], v[234:237], v[144:147], 0
    v_mfma_f32_16x16x32_bf16 v[24:27], v[250:253], v[148:151], 0
    v_mfma_f32_16x16x32_bf16 v[28:31], v[234:237], v[148:151], 0
    s_nop 4
    v_max3_f32 v152, v16, v17, v18
    v_max3_f32 v153, -v16, -v17, -v18
    v_max3_f32 v154, v24, v25, v26
    s_nop 3
    v_max3_f32 v155, -v24, -v25, -v26
    v_max3_f32 v152, v152, v19, v20
    v_max3_f32 v153, v153, -v19, -v20
    v_max3_f32 v154, v154, v27, v28
    v_max3_f32 v155, v155, -v27, -v28
    v_max3_f32 v152, v152, v21, v22
    v_max3_f32 v153, v153, -v21, -v22
    v_max3_f32 v154, v154, v29, v30
    v_max3_f32 v155, v155, -v29, -v30
    v_max_f32_e64 v152, v152, v23
    v_max_f32_e64 v153, v153, -v23
    v_max_f32_e64 v154, v154, v31
    v_max_f32_e64 v155, v155, -v31
    s_nop 0
    v_permlane32_swap_b32 v152, v154
    v_permlane32_swap_b32 v153, v155
    v_max_f32 v152, v152, v154
    v_max_f32 v153, v153, v155
    s_nop 1
    v_permlane16_swap_b32 v152, v153
    v_max_f32 v152, v152, v153
    v_mul_f32 v152, s97, v152
    v_mov_b32 v153, v152
    s_nop 1
    v_permlane16_swap_b32 v152, v153
    v_mov_b32 v154, v152
    v_mov_b32 v155, v153
    s_nop 0
    v_permlane32_swap_b32 v152, v154
    v_permlane32_swap_b32_e64 v153, v155
    v_fma_f32 v128, v16, s97, v153
    v_fma_f32 v129, v17, s97, v153
    v_fma_f32 v130, v18, s97, v153
    v_fma_f32 v131, v19, s97, v153
    v_fma_f32 v132, v20, s97, v153
    v_fma_f32 v133, v21, s97, v153
    v_fma_f32 v134, v22, s97, v153
    v_fma_f32 v135, v23, s97, v153
    v_fma_f32 v16, v16, s96, v152
    v_fma_f32 v17, v17, s96, v152
    v_fma_f32 v18, v18, s96, v152
    v_fma_f32 v19, v19, s96, v152
    s_mov_b32 s94, 0
L_spin_16:
    s_waitcnt lgkmcnt(0)
    s_min_u32 s74, s74, s75
    s_cmp_ge_u32 s74, 1
    s_cbranch_scc1 L_ok_15
    s_add_u32 s94, s94, 1
    s_cmp_gt_u32 s94, 0x80000
    s_cbranch_scc1 L_ok_15
    s_sleep 2
    s_and_b32 s64, s55, -8
    s_lshl_b32 s65, s4, 1
    s_add_u32 s64, s64, s65
    s_lshl_b32 s64, s64, 7
    s_add_u32 s64, s64, 27729920
    s_load_dword s74, s[86:87], s64 glc
    s_add_u32 s64, s64, 128
    s_load_dword s75, s[86:87], s64 glc
    s_branch L_spin_16
L_ok_15:
    s_barrier
    s_cmp_lg_u32 s4, 0
    s_cbranch_scc1 L_w0_12
    s_lshl_b32 s64, s55, 7
    s_add_u32 s64, s64, 27893760
    s_mov_b32 s66, 1
    s_atomic_add s66, s[86:87], s64
L_w0_12:
    v_fma_f32 v20, v20, s96, v152
    v_fma_f32 v21, v21, s96, v152
    v_fma_f32 v22, v22, s96, v152
    v_fma_f32 v23, v23, s96, v152
    v_exp_f32 v128, v128
    v_exp_f32 v129, v129
    v_exp_f32 v130, v130
    v_exp_f32 v131, v131
    v_exp_f32 v132, v132
    v_exp_f32 v133, v133
    v_exp_f32 v134, v134
    v_exp_f32 v135, v135
    v_exp_f32 v16, v16
    v_exp_f32 v17, v17
    v_exp_f32 v18, v18
    v_exp_f32 v19, v19
    v_exp_f32 v20, v20
    v_exp_f32 v21, v21
    v_exp_f32 v22, v22
    v_exp_f32 v23, v23
    v_fma_f32 v136, v24, s97, v155
    s_waitcnt vmcnt(0)
    s_lshl_b32 s64, s55, 7
    s_add_u32 s64, s64, 27828224
    s_mov_b32 s66, 1
    s_atomic_add s66, s[86:87], s64
    v_fma_f32 v137, v25, s97, v155
    v_fma_f32 v138, v26, s97, v155
    v_fma_f32 v139, v27, s97, v155
    v_fma_f32 v140, v28, s97, v155
    v_fma_f32 v141, v29, s97, v155
    v_fma_f32 v142, v30, s97, v155
    v_fma_f32 v143, v31, s97, v155
    v_fma_f32 v24, v24, s96, v154
    v_fma_f32 v25, v25, s96, v154
    v_fma_f32 v26, v26, s96, v154
    v_fma_f32 v27, v27, s96, v154
    v_fma_f32 v28, v28, s96, v154
    v_fma_f32 v29, v29, s96, v154
    v_fma_f32 v30, v30, s96, v154
    v_fma_f32 v31, v31, s96, v154
    v_exp_f32 v136, v136
    v_exp_f32 v137, v137
    v_exp_f32 v138, v138
    v_exp_f32 v139, v139
    v_exp_f32 v140, v140
    v_exp_f32 v141, v141
    v_exp_f32 v142, v142
    v_exp_f32 v143, v143
    v_exp_f32 v24, v24
    v_exp_f32 v25, v25
    v_exp_f32 v26, v26
    s_barrier
    v_exp_f32 v27, v27
    v_exp_f32 v28, v28
    v_exp_f32 v29, v29
    v_exp_f32 v30, v30
    v_exp_f32 v31, v31
    v_cvt_pk_bf16_f32 v16, v16, v17
    v_cvt_pk_bf16_f32 v17, v18, v19
    v_cvt_pk_bf16_f32 v18, v20, v21
    v_cvt_pk_bf16_f32 v19, v22, v23
    v_cvt_pk_bf16_f32 v20, v128, v129
    v_cvt_pk_bf16_f32 v21, v130, v131
    v_cvt_pk_bf16_f32 v22, v132, v133
    v_cvt_pk_bf16_f32 v23, v134, v135
    v_cvt_pk_bf16_f32 v24, v24, v25
    v_cvt_pk_bf16_f32 v25, v26, v27
    v_cvt_pk_bf16_f32 v26, v28, v29
    v_cvt_pk_bf16_f32 v27, v30, v31
    v_cvt_pk_bf16_f32 v28, v136, v137
    v_cvt_pk_bf16_f32 v29, v138, v139
    v_cvt_pk_bf16_f32 v30, v140, v141
    v_cvt_pk_bf16_f32 v31, v142, v143
    v_cvt_pk_bf16_f32 v144, v32, v33
    v_cvt_pk_bf16_f32 v145, v34, v35
    v_cvt_pk_bf16_f32 v146, v36, v37
    v_cvt_pk_bf16_f32 v147, v38, v39
    v_cvt_pk_bf16_f32 v148, v40, v41
    v_cvt_pk_bf16_f32 v149, v42, v43
    v_cvt_pk_bf16_f32 v150, v44, v45
    v_cvt_pk_bf16_f32 v151, v46, v47
    v_mfma_f32_16x16x32_bf16 v[32:35], v[250:253], v[144:147], 0
    v_mfma_f32_16x16x32_bf16 v[36:39], v[234:237], v[144:147], 0
    v_mfma_f32_16x16x32_bf16 v[40:43], v[250:253], v[148:151], 0
    v_mfma_f32_16x16x32_bf16 v[44:47], v[234:237], v[148:151], 0
    s_nop 4
    v_max3_f32 v152, v32, v33, v34
    v_max3_f32 v153, -v32, -v33, -v34
    v_max3_f32 v154, v40, v41, v42
    v_max3_f32 v155, -v40, -v41, -v42
    v_max3_f32 v152, v152, v35, v36
    v_max3_f32 v153, v153, -v35, -v36
    v_max3_f32 v154, v154, v43, v44
    v_max3_f32 v155, v155, -v43, -v44
    v_max3_f32 v152, v152, v37, v38
    v_max3_f32 v153, v153, -v37, -v38
    v_max3_f32 v154, v154, v45, v46
    v_max3_f32 v155, v155, -v45, -v46
    v_max_f32_e64 v152, v152, v39
    v_max_f32_e64 v153, v153, -v39
    v_max_f32_e64 v154, v154, v47
    v_max_f32_e64 v155, v155, -v47
    s_nop 0
    v_permlane32_swap_b32 v152, v154
    v_permlane32_swap_b32 v153, v155
    v_max_f32 v152, v152, v154
    v_max_f32 v153, v153, v155
    s_nop 1
    v_permlane16_swap_b32 v152, v153
    v_max_f32 v152, v152, v153
    v_mul_f32 v152, s97, v152
    v_mov_b32 v153, v152
    s_nop 1
    v_permlane16_swap_b32 v152, v153
    v_mov_b32 v154, v152
    v_mov_b32 v155, v153
    s_nop 0
    v_permlane32_swap_b32 v152, v154
    v_permlane32_swap_b32 v153, v155
    v_fma_f32 v128, v32, s97, v153
    v_fma_f32 v129, v33, s97, v153
    v_fma_f32 v130, v34, s97, v153
    s_barrier
    s_lshl_b32 s65, s4, 6
    s_add_u32 s64, s6, s65
    s_lshl_b32 s64, s64, 7
    s_add_u32 s64, s64, 27828224
    s_load_dword s74, s[86:87], s64 glc
    s_add_u32 s64, s64, 2048
    s_load_dword s75, s[86:87], s64 glc
    s_add_u32 s64, s64, 2048
    s_load_dword s76, s[86:87], s64 glc
    s_add_u32 s64, s64, 2048
    s_load_dword s77, s[86:87], s64 glc
    v_fma_f32 v131, v35, s97, v153
    v_fma_f32 v132, v36, s97, v153
    v_fma_f32 v133, v37, s97, v153
    v_fma_f32 v134, v38, s97, v153
    v_fma_f32 v135, v39, s97, v153
    v_fma_f32 v32, v32, s96, v152
    v_fma_f32 v33, v33, s96, v152
    v_fma_f32 v34, v34, s96, v152
    v_fma_f32 v35, v35, s96, v152
    v_fma_f32 v36, v36, s96, v152
    v_fma_f32 v37, v37, s96, v152
    v_fma_f32 v38, v38, s96, v152
    v_fma_f32 v39, v39, s96, v152
    v_exp_f32 v128, v128
    v_exp_f32 v129, v129
    v_exp_f32 v130, v130
    v_exp_f32 v131, v131
    v_exp_f32 v132, v132
    v_exp_f32 v133, v133
    v_exp_f32 v134, v134
    v_exp_f32 v135, v135
    v_exp_f32 v32, v32
    v_exp_f32 v33, v33
    v_exp_f32 v34, v34
    v_exp_f32 v35, v35
    v_exp_f32 v36, v36
    v_exp_f32 v37, v37
    v_exp_f32 v38, v38
    v_exp_f32 v39, v39
    v_fma_f32 v136, v40, s97, v155
    v_fma_f32 v137, v41, s97, v155
    v_fma_f32 v138, v42, s97, v155
    v_fma_f32 v139, v43, s97, v155
    v_fma_f32 v140, v44, s97, v155
    v_fma_f32 v141, v45, s97, v155
    v_fma_f32 v142, v46, s97, v155
    v_fma_f32 v143, v47, s97, v155
    v_fma_f32 v40, v40, s96, v154
    v_fma_f32 v41, v41, s96, v154
    v_fma_f32 v42, v42, s96, v154
    v_fma_f32 v43, v43, s96, v154
    v_fma_f32 v44, v44, s96, v154
    v_fma_f32 v45, v45, s96, v154
    v_fma_f32 v46, v46, s96, v154
    v_fma_f32 v47, v47, s96, v154
    v_exp_f32 v136, v136
    v_exp_f32 v137, v137
    v_exp_f32 v138, v138
    v_exp_f32 v139, v139
    v_exp_f32 v140, v140
    v_exp_f32 v141, v141
    v_exp_f32_e64 v142, v142
    s_mov_b32 s94, 0
L_spin_4:
    s_waitcnt lgkmcnt(0)
    s_min_u32 s74, s74, s75
    s_min_u32 s74, s74, s76
    s_min_u32 s74, s74, s77
    s_cmp_ge_u32 s74, 4
    s_cbranch_scc1 L_ok_3
    s_add_u32 s94, s94, 1
    s_cmp_gt_u32 s94, 0x80000
    s_cbranch_scc1 L_ok_3
    s_sleep 2
    s_lshl_b32 s65, s4, 6
    s_add_u32 s64, s6, s65
    s_lshl_b32 s64, s64, 7
    s_add_u32 s64, s64, 27828224
    s_load_dword s74, s[86:87], s64 glc
    s_add_u32 s64, s64, 2048
    s_load_dword s75, s[86:87], s64 glc
    s_add_u32 s64, s64, 2048
    s_load_dword s76, s[86:87], s64 glc
    s_add_u32 s64, s64, 2048
    s_load_dword s77, s[86:87], s64 glc
    s_branch L_spin_4
L_ok_3:
    s_barrier
    s_mov_b32 s91, 0
    buffer_load_dwordx4 v[216:219], v12, s[28:31], s91 offen sc1
    s_mov_b32 s91, 4096
    buffer_load_dwordx4 v[220:223], v12, s[28:31], s91 offen sc1
    s_mov_b32 s91, 8192
    buffer_load_dwordx4 v[224:227], v12, s[28:31], s91 offen sc1
    s_mov_b32 s91, 12288
    buffer_load_dwordx4 v[228:231], v12, s[28:31], s91 offen sc1
    buffer_load_dwordx2 v[158:159], v13, s[28:31], 0 offen sc1
    v_exp_f32 v143, v143
    v_exp_f32 v40, v40
    v_exp_f32 v41, v41
    v_exp_f32 v42, v42
    v_exp_f32 v43, v43
    v_exp_f32 v44, v44
    v_exp_f32 v45, v45
    v_exp_f32 v46, v46
    v_exp_f32_e64 v47, v47
    v_cvt_pk_bf16_f32 v32, v32, v33
    v_cvt_pk_bf16_f32 v33, v34, v35
    v_cvt_pk_bf16_f32 v34, v36, v37
    v_cvt_pk_bf16_f32 v35, v38, v39
    v_cvt_pk_bf16_f32 v36, v128, v129
    v_cvt_pk_bf16_f32 v37, v130, v131
    v_cvt_pk_bf16_f32 v38, v132, v133
    v_cvt_pk_bf16_f32 v39, v134, v135
    v_cvt_pk_bf16_f32 v40, v40, v41
    v_cvt_pk_bf16_f32 v41, v42, v43
    v_cvt_pk_bf16_f32 v42, v44, v45
    v_cvt_pk_bf16_f32 v43, v46, v47
    v_cvt_pk_bf16_f32 v44, v136, v137
    v_cvt_pk_bf16_f32 v45, v138, v139
    v_cvt_pk_bf16_f32 v46, v140, v141
    v_cvt_pk_bf16_f32 v47, v142, v143
    s_barrier
    s_waitcnt vmcnt(0)
    v_mfma_f32_16x16x32_bf16 v[160:163], v[164:167], v[216:219], 0
    v_mfma_f32_16x16x32_bf16 v[160:163], v[164:167], v[220:223], v[160:163]
    v_mfma_f32_16x16x32_bf16 v[160:163], v[164:167], v[224:227], v[160:163]
    v_mfma_f32_16x16x32_bf16 v[160:163], v[164:167], v[228:231], v[160:163]
    v_permlane16_swap_b32 v158, v159
    v_add_f32_e64 v158, v158, v159
    s_nop 1
    v_add_f32_dpp v158, v158, v158 row_ror:8 row_mask:0xf bank_mask:0xf
    s_nop 1
    v_add_f32_dpp v158, v158, v158 row_ror:4 row_mask:0xf bank_mask:0xf
    s_nop 1
    v_add_f32_dpp v158, v158, v158 row_ror:2 row_mask:0xf bank_mask:0xf
    v_add_f32_dpp v160, v160, v160 row_ror:8 row_mask:0xf bank_mask:0xf
    v_add_f32_dpp v161, v161, v161 row_ror:8 row_mask:0xf bank_mask:0xf
    v_add_f32_dpp v158, v158, v158 row_ror:1 row_mask:0xf bank_mask:0xf
    v_add_f32_dpp v162, v162, v162 row_ror:8 row_mask:0xf bank_mask:0xf
    v_mov_b32_e64 v159, v158
    v_add_f32_dpp v163, v163, v163 row_ror:8 row_mask:0xf bank_mask:0xf
    v_cvt_pk_bf16_f32 v160, v160, v161
    v_permlane16_swap_b32_e64 v158, v159
    v_cvt_pk_bf16_f32 v161, v162, v163
    v_cvt_pk_bf16_f32 v158, v158, v159
    buffer_store_dwordx2 v[160:161], v126, s[28:31], 0 offen sc1
    buffer_store_dword v158, v127, s[28:31], 0 offen sc1
    v_and_b32 v1, 15, v0
    v_lshlrev_b32_e64 v13, 7, v1
    s_lshl_b32 s92, s53, 12
    s_add_u32 s92, s92, 147456
    v_add_u32 v12, s92, v249
    s_lshl_b32 s92, s53, 7
    s_add_u32 s92, s92, 155648
    v_and_b32 v1, 1, v0
    v_lshrrev_b32 v2, 4, v0
    v_lshl_add_u32 v2, v1, 2, v2
    v_lshlrev_b32 v2, 4, v2
    v_add_u32_e64 v14, s92, v2
    s_lshl_b32 s91, s5, 1
    s_add_u32 s91, s91, s52
    s_lshl_b32 s91, s91, 8
    v_lshl_add_u32 v1, v0, 2, s91
    s_mov_b32 s91, 27688960
    buffer_load_dword v245, v1, s[28:31], s91 offen sc1
    s_barrier
    s_waitcnt vmcnt(1)
    s_lshl_b32 s64, s55, 7
    s_add_u32 s64, s64, 27860992
    s_mov_b32 s66, 1
    s_atomic_add s66, s[86:87], s64
    s_barrier
    s_waitcnt vmcnt(0)
    v_mov_b32 v246, v245
    s_nop 1
    v_permlane16_swap_b32 v245, v246
    v_mov_b32 v247, v245
    v_mov_b32 v248, v246
    s_nop 0
    v_permlane32_swap_b32 v245, v247
    v_permlane32_swap_b32_e64 v246, v248
    s_mov_b64 exec, 0
    s_cmp_eq_u32 s4, 0
    s_cbranch_scc1 L_walkc_0
    s_cmp_eq_u32 s4, 1
    s_cbranch_scc1 L_walkc_1
    s_cmp_eq_u32 s4, 2
    s_cbranch_scc1 L_walkedc
    s_cmp_eq_u32 s4, 3
    s_cbranch_scc1 L_walkedc
L_walkedc:
    s_mov_b64 exec, -1
    s_barrier
    s_and_b32 s64, s55, -8
    s_lshl_b32 s65, s4, 1
    s_add_u32 s64, s64, s65
    s_lshl_b32 s64, s64, 7
    s_add_u32 s64, s64, 27893760
    s_load_dword s74, s[86:87], s64 glc
    s_add_u32 s64, s64, 128
    s_load_dword s75, s[86:87], s64 glc
    v_lshrrev_b32_e64 v1, 4, v0
    v_bfe_u32 v2, v0, 1, 3
    v_xor_b32 v2, v2, v1
    v_and_b32 v3, 1, v0
    v_lshlrev_b32_e64 v1, 11, v1
    v_lshl_add_u32 v1, v3, 4, v1
    s_lshl_b32 s92, s53, 15
    s_lshl_b32 s91, s54, 8
    s_add_u32 s92, s92, s91
    v_add_u32 v1, s92, v1
    v_lshl_add_u32 v233, v2, 5, v1
    v_xor_b32_e64 v2, 4, v2
    v_lshl_add_u32 v2, v2, 5, v1
    v_add_u32 v234, 7168, v2
    v_add_u32 v235, 14336, v233
    v_add_u32 v236, 14336, v234
    s_lshl_b32 s92, s53, 12
    s_mul_i32 s91, s5, 144
    s_mov_b32 s95, 112
    s_add_u32 s91, s91, s95
    s_lshl_b32 s91, s91, 13
    s_add_u32 s92, s92, s91
    v_add_u32 v237, s92, v249
    s_lshl_b32 s92, s7, 1
    s_add_u32 s92, s92, s53
    s_lshl_b32 s92, s92, 11
    s_lshl_b32 s95, s52, 13
    s_add_u32 s95, s95, s92
    s_mul_i32 s91, s5, 1179648
    s_add_u32 s92, s92, s91
    s_add_u32 s92, s92, 917504
    v_add_u32 v238, s92, v249
    s_mov_b32 s94, 0
L_spin_14:
    s_waitcnt lgkmcnt(0)
    s_min_u32 s74, s74, s75
    s_cmp_ge_u32 s74, 1
    s_cbranch_scc1 L_ok_13
    s_add_u32 s94, s94, 1
    s_cmp_gt_u32 s94, 0x80000
    s_cbranch_scc1 L_ok_13
    s_sleep 2
    s_and_b32 s64, s55, -8
    s_lshl_b32 s65, s4, 1
    s_add_u32 s64, s64, s65
    s_lshl_b32 s64, s64, 7
    s_add_u32 s64, s64, 27893760
    s_load_dword s74, s[86:87], s64 glc
    s_add_u32 s64, s64, 128
    s_load_dword s75, s[86:87], s64 glc
    s_branch L_spin_14
L_ok_13:
    s_barrier
    s_lshl_b32 s65, s4, 6
    s_add_u32 s64, s61, s65
    s_lshl_b32 s64, s64, 7
    s_add_u32 s64, s64, 27860992
    s_load_dword s74, s[86:87], s64 glc
    s_add_u32 s64, s64, 2048
    s_load_dword s75, s[86:87], s64 glc
    s_add_u32 s64, s64, 2048
    s_load_dword s76, s[86:87], s64 glc
    s_add_u32 s64, s64, 2048
    s_load_dword s77, s[86:87], s64 glc
    s_mov_b32 s94, 0
L_spin_6:
    s_waitcnt lgkmcnt(0)
    s_min_u32 s74, s74, s75
    s_min_u32 s74, s74, s76
    s_min_u32 s74, s74, s77
    s_cmp_ge_u32 s74, 4
    s_cbranch_scc1 L_ok_5
    s_add_u32 s94, s94, 1
    s_cmp_gt_u32 s94, 0x80000
    s_cbranch_scc1 L_ok_5
    s_sleep 2
    s_lshl_b32 s65, s4, 6
    s_add_u32 s64, s61, s65
    s_lshl_b32 s64, s64, 7
    s_add_u32 s64, s64, 27860992
    s_load_dword s74, s[86:87], s64 glc
    s_add_u32 s64, s64, 2048
    s_load_dword s75, s[86:87], s64 glc
    s_add_u32 s64, s64, 2048
    s_load_dword s76, s[86:87], s64 glc
    s_add_u32 s64, s64, 2048
    s_load_dword s77, s[86:87], s64 glc
L_walkc_0:
    s_cbranch_execz L_walkedc
    s_nop 0
    s_branch L_spin_6
L_ok_5:
    s_barrier
    s_cmp_lg_u32 s4, 0
    s_cbranch_scc1 L_w0_7
    s_mov_b32 m0, 155648
    s_lshl_b32 s91, s61, 11
    s_add_u32 s91, s91, 27656192
    buffer_load_dwordx4 v13, s[28:31], s91 offen sc1 lds
L_w0_7:
    s_lshr_b32 s92, s56, 1
    s_add_u32 m0, s92, 147456
    s_lshl_b32 s91, s61, 13
    s_add_u32 s91, s91, s92
    s_add_u32 s91, s91, 27525120
    buffer_load_dwordx4 v249, s[28:31], s91 offen offset:0 sc1 lds
    buffer_load_dwordx4 v249, s[28:31], s91 offen offset:1024 sc1 lds
    s_barrier
    s_waitcnt vmcnt(0)
    s_barrier
    s_mov_b32 s93, 0x358637bd
    ds_read_b128 v[188:191], v14
    ds_read_b128 v[172:175], v12 offset:0
    ds_read_b128 v[176:179], v12 offset:1024
    ds_read_b128 v[180:183], v12 offset:2048
    ds_read_b128 v[184:187], v12 offset:3072
    v_and_b32 v1, 2, v0
    v_cmp_eq_u32 vcc, 0, v1
    s_waitcnt lgkmcnt(0)
    s_nop 0
    v_cndmask_b32 v188, v156, v188, vcc
    v_cndmask_b32 v189, v156, v189, vcc
    v_cndmask_b32 v190, v156, v190, vcc
    v_cndmask_b32_e64 v191, v156, v191, vcc
    v_mfma_f32_16x16x32_bf16 v[48:51], v[172:175], v[16:19], 0
    v_mfma_f32_16x16x32_bf16 v[52:55], v[176:179], v[16:19], 0
    v_mfma_f32_16x16x32_bf16 v[80:83], v[180:183], v[20:23], 0
    v_mfma_f32_16x16x32_bf16 v[84:87], v[184:187], v[20:23], 0
    v_mfma_f32_16x16x32_bf16 v[128:131], v[188:191], v[16:19], 0
    v_mfma_f32_16x16x32_bf16 v[132:135], v[188:191], v[20:23], 0
    v_mfma_f32_16x16x32_bf16 v[136:139], v[188:191], v[24:27], 0
    v_mfma_f32_16x16x32_bf16 v[140:143], v[188:191], v[28:31], 0
    v_mfma_f32_16x16x32_bf16 v[216:219], v[188:191], v[32:35], 0
    v_mfma_f32_16x16x32_bf16 v[220:223], v[188:191], v[36:39], 0
    v_mfma_f32_16x16x32_bf16 v[224:227], v[188:191], v[40:43], 0
    v_mfma_f32_16x16x32_bf16 v[228:231], v[188:191], v[44:47], 0
    v_mfma_f32_16x16x32_bf16 v[56:59], v[172:175], v[24:27], 0
    v_mfma_f32_16x16x32_bf16 v[60:63], v[176:179], v[24:27], 0
    v_mfma_f32_16x16x32_bf16 v[88:91], v[180:183], v[28:31], 0
    v_mfma_f32_16x16x32_bf16 v[92:95], v[184:187], v[28:31], 0
    v_rcp_f32 v130, v130
    v_rcp_f32 v134, v134
    v_rcp_f32 v138, v138
    v_rcp_f32 v142, v142
    v_rcp_f32 v218, v218
    v_rcp_f32 v222, v222
    v_rcp_f32 v226, v226
    v_rcp_f32 v230, v230
    v_fma_f32 v128, v128, v130, s93
    v_fma_f32 v136, v136, v138, s93
    v_fma_f32 v216, v216, v218, s93
    v_fma_f32 v224, v224, v226, s93
    v_fma_f32 v128, v133, v134, v128
    v_fma_f32 v136, v141, v142, v136
    v_fma_f32 v216, v221, v222, v216
    v_fma_f32 v224, v229, v230, v224
    v_rcp_f32 v128, v128
    v_rcp_f32 v136, v136
    v_rcp_f32 v216, v216
    v_rcp_f32 v224, v224
    v_mul_f32 v128, v245, v128
    v_mul_f32 v136, v246, v136
    v_mul_f32 v216, v247, v216
    v_mul_f32 v224, v248, v224
    v_mul_f32 v130, v128, v130
    v_mul_f32 v134, v128, v134
    v_mul_f32 v138, v136, v138
    v_mul_f32 v142, v136, v142
    v_mul_f32 v218, v216, v218
    v_mul_f32 v222, v216, v222
    v_mul_f32 v226, v224, v226
    v_mul_f32 v230, v224, v230
    v_mfma_f32_16x16x32_bf16 v[64:67], v[172:175], v[32:35], 0
    v_mfma_f32_16x16x32_bf16 v[68:71], v[176:179], v[32:35], 0
    v_mfma_f32_16x16x32_bf16 v[96:99], v[180:183], v[36:39], 0
    v_mfma_f32_16x16x32_bf16 v[100:103], v[184:187], v[36:39], 0
    v_mul_f32 v48, v130, v48
    v_mul_f32 v49, v130, v49
    v_mul_f32 v50, v130, v50
    v_mul_f32 v51, v130, v51
    v_mul_f32 v52, v130, v52
    v_mul_f32 v53, v130, v53
    s_waitcnt lgkmcnt(0)
    s_barrier
    v_mul_f32 v54, v130, v54
    v_mul_f32 v55, v130, v55
    v_fmac_f32 v48, v134, v80
    v_fmac_f32 v49, v134, v81
    v_fmac_f32 v50, v134, v82
    v_fmac_f32 v51, v134, v83
    v_fmac_f32 v52, v134, v84
    v_fmac_f32 v53, v134, v85
    v_fmac_f32 v54, v134, v86
    v_fmac_f32 v55, v134, v87
    v_cvt_pk_bf16_f32 v48, v48, v49
    v_cvt_pk_bf16_f32 v49, v50, v51
    v_cvt_pk_bf16_f32 v50, v52, v53
    v_cvt_pk_bf16_f32 v51, v54, v55
    buffer_store_dwordx4 v[48:51], v15, s[28:31], 0 offen offset:0 sc1
    v_mfma_f32_16x16x32_bf16 v[72:75], v[172:175], v[40:43], 0
    v_mfma_f32_16x16x32_bf16 v[76:79], v[176:179], v[40:43], 0
    v_mfma_f32_16x16x32_bf16 v[104:107], v[180:183], v[44:47], 0
    v_mfma_f32_16x16x32_bf16 v[108:111], v[184:187], v[44:47], 0
    v_mul_f32 v56, v138, v56
    v_mul_f32 v57, v138, v57
    v_mul_f32 v58, v138, v58
    v_mul_f32 v59, v138, v59
    v_mul_f32 v60, v138, v60
    v_mul_f32 v61, v138, v61
    v_mul_f32 v62, v138, v62
    v_mul_f32 v63, v138, v63
    v_fmac_f32 v56, v142, v88
    v_fmac_f32 v57, v142, v89
    v_fmac_f32 v58, v142, v90
    v_fmac_f32 v59, v142, v91
    v_fmac_f32 v60, v142, v92
    v_fmac_f32 v61, v142, v93
    v_fmac_f32 v62, v142, v94
    v_fmac_f32 v63, v142, v95
    v_cvt_pk_bf16_f32 v56, v56, v57
    v_cvt_pk_bf16_f32 v57, v58, v59
    v_cvt_pk_bf16_f32 v58, v60, v61
    v_cvt_pk_bf16_f32 v59, v62, v63
    buffer_store_dwordx4 v[56:59], v15, s[28:31], 0 offen offset:1024 sc1
    v_mul_f32 v64, v218, v64
    v_mul_f32 v65, v218, v65
    v_mul_f32 v66, v218, v66
    v_mul_f32 v67, v218, v67
    v_mul_f32 v68, v218, v68
    v_mul_f32 v69, v218, v69
    v_mul_f32 v70, v218, v70
    v_mul_f32 v71, v218, v71
    v_fmac_f32 v64, v222, v96
    v_fmac_f32 v65, v222, v97
    v_fmac_f32 v66, v222, v98
    v_fmac_f32 v67, v222, v99
    v_fmac_f32 v68, v222, v100
    v_fmac_f32 v69, v222, v101
    v_fmac_f32 v70, v222, v102
    v_fmac_f32 v71, v222, v103
    v_cvt_pk_bf16_f32 v64, v64, v65
    v_cvt_pk_bf16_f32 v65, v66, v67
    v_cvt_pk_bf16_f32 v66, v68, v69
    v_cvt_pk_bf16_f32 v67, v70, v71
    buffer_store_dwordx4 v[64:67], v15, s[28:31], 0 offen offset:2048 sc1
    v_mul_f32 v72, v226, v72
    v_mul_f32 v73, v226, v73
    v_mul_f32 v74, v226, v74
    v_mul_f32 v75, v226, v75
    v_mul_f32 v76, v226, v76
    v_mul_f32 v77, v226, v77
    v_mul_f32 v78, v226, v78
    v_mul_f32 v79, v226, v79
    v_fmac_f32 v72, v230, v104
    v_fmac_f32 v73, v230, v105
    v_fmac_f32 v74, v230, v106
    v_fmac_f32 v75, v230, v107
    v_fmac_f32 v76, v230, v108
    v_fmac_f32 v77, v230, v109
    v_fmac_f32 v78, v230, v110
    v_fmac_f32 v79, v230, v111
    v_cvt_pk_bf16_f32 v72, v72, v73
    v_cvt_pk_bf16_f32 v73, v74, v75
    v_cvt_pk_bf16_f32 v74, v76, v77
    v_cvt_pk_bf16_f32 v75, v78, v79
    buffer_store_dwordx4 v[72:75], v15, s[28:31], 0 offen offset:3072 sc1
    s_barrier
    s_barrier
    s_waitcnt vmcnt(0)
    s_lshl_b32 s64, s55, 7
    s_add_u32 s64, s64, 27762688
    s_mov_b32 s66, 1
    s_atomic_add s66, s[86:87], s64
    s_barrier
    s_barrier
    s_lshl_b32 s64, s7, 2
    s_add_u32 s64, s64, s4
    s_add_u32 s64, s64, s5
    s_and_b32 s64, s64, 15
    s_xor_b32 s64, s64, 4
    s_and_b32 s65, s55, -16
    s_add_u32 s64, s64, s65
    s_lshl_b32 s64, s64, 7
    s_add_u32 s64, s64, 27762688
    s_load_dword s74, s[86:87], s64 glc
    s_mul_i32 s90, s7, 8
    s_add_u32 s90, s90, s62
    s_add_u32 s90, s90, 0
    s_and_b32 s90, s90, 31
    s_lshl_b32 s89, s90, 16
    s_add_u32 m0, s56, 81920
    s_lshl_b32 s88, s90, 13
    buffer_load_dwordx4 v233, s[24:27], s89 offen offset:0 lds
    buffer_load_dwordx4 v234, s[24:27], s89 offen offset:1024 lds
    buffer_load_dwordx4 v235, s[24:27], s89 offen offset:2048 lds
    buffer_load_dwordx4 v236, s[24:27], s89 offen offset:3072 lds
    s_mov_b32 s94, 0
L_spin_9:
    s_waitcnt lgkmcnt(0)
    s_cmp_ge_u32 s74, 4
    s_cbranch_scc1 L_ok_8
    s_add_u32 s94, s94, 1
    s_cmp_gt_u32 s94, 0x80000
    s_cbranch_scc1 L_ok_8
    s_sleep 2
    s_lshl_b32 s64, s7, 2
    s_add_u32 s64, s64, s4
    s_add_u32 s64, s64, s5
    s_and_b32 s64, s64, 15
    s_xor_b32 s64, s64, 4
    s_and_b32 s65, s55, -16
    s_add_u32 s64, s64, s65
    s_lshl_b32 s64, s64, 7
    s_add_u32 s64, s64, 27762688
    s_load_dword s74, s[86:87], s64 glc
    s_branch L_spin_9
L_ok_8:
    s_barrier
    s_add_u32 m0, s56, 65536
    s_nop 0
    buffer_load_dwordx4 v237, s[28:31], s88 offen offset:0 sc1 lds
    buffer_load_dwordx4 v237, s[28:31], s88 offen offset:1024 sc1 lds
    buffer_load_dwordx4 v237, s[28:31], s88 offen offset:2048 sc1 lds
    buffer_load_dwordx4 v237, s[28:31], s88 offen offset:3072 sc1 lds
    s_mul_i32 s90, s7, 8
    s_add_u32 s90, s90, s62
    s_add_u32 s90, s90, 2
    s_and_b32 s90, s90, 31
    s_lshl_b32 s89, s90, 16
    s_add_u32 m0, s56, 114688
    s_lshl_b32 s88, s90, 13
    buffer_load_dwordx4 v233, s[24:27], s89 offen offset:0 lds
    buffer_load_dwordx4 v234, s[24:27], s89 offen offset:1024 lds
    buffer_load_dwordx4 v235, s[24:27], s89 offen offset:2048 lds
    buffer_load_dwordx4 v236, s[24:27], s89 offen offset:3072 lds
    s_barrier
    s_add_u32 m0, s56, 98304
    s_nop 0
    buffer_load_dwordx4 v237, s[28:31], s88 offen offset:0 sc1 lds
    buffer_load_dwordx4 v237, s[28:31], s88 offen offset:1024 sc1 lds
    buffer_load_dwordx4 v237, s[28:31], s88 offen offset:2048 sc1 lds
    buffer_load_dwordx4 v237, s[28:31], s88 offen offset:3072 sc1 lds
    s_mul_i32 s90, s7, 8
    s_add_u32 s90, s90, s62
    s_add_u32 s90, s90, 4
    s_and_b32 s90, s90, 31
    s_lshl_b32 s89, s90, 16
    s_add_u32 m0, s56, 16384
    s_lshl_b32 s88, s90, 13
    buffer_load_dwordx4 v233, s[24:27], s89 offen offset:0 lds
    buffer_load_dwordx4 v234, s[24:27], s89 offen offset:1024 lds
    buffer_load_dwordx4 v235, s[24:27], s89 offen offset:2048 lds
    buffer_load_dwordx4 v236, s[24:27], s89 offen offset:3072 lds
    s_waitcnt vmcnt(12)
    s_barrier
    s_lshl_b32 s64, s4, 1
    s_add_u32 s64, s64, 8
    s_add_u32 s64, s64, s5
    s_and_b32 s64, s64, 15
    s_xor_b32 s64, s64, 4
    s_and_b32 s65, s55, -16
    s_add_u32 s64, s64, s65
    s_lshl_b32 s64, s64, 7
    s_add_u32 s64, s64, 27762688
    s_load_dword s74, s[86:87], s64 glc
    s_lshl_b32 s64, s4, 1
    s_add_u32 s64, s64, 9
    s_add_u32 s64, s64, s5
    s_and_b32 s64, s64, 15
    s_xor_b32 s64, s64, 4
    s_and_b32 s65, s55, -16
    s_add_u32 s64, s64, s65
    s_lshl_b32 s64, s64, 7
    s_add_u32 s64, s64, 27762688
    s_load_dword s75, s[86:87], s64 glc
    s_add_u32 m0, s56, 0
    s_nop 0
    buffer_load_dwordx4 v237, s[28:31], s88 offen offset:0 sc1 lds
    buffer_load_dwordx4 v237, s[28:31], s88 offen offset:1024 sc1 lds
    buffer_load_dwordx4 v237, s[28:31], s88 offen offset:2048 sc1 lds
    buffer_load_dwordx4 v237, s[28:31], s88 offen offset:3072 sc1 lds
    s_mul_i32 s90, s7, 8
    s_add_u32 s90, s90, s62
    s_add_u32 s90, s90, 6
    s_and_b32 s90, s90, 31
    s_lshl_b32 s89, s90, 16
    s_add_u32 m0, s56, 49152
    s_lshl_b32 s88, s90, 13
    buffer_load_dwordx4 v233, s[24:27], s89 offen offset:0 lds
    buffer_load_dwordx4 v234, s[24:27], s89 offen offset:1024 lds
    buffer_load_dwordx4 v235, s[24:27], s89 offen offset:2048 lds
    buffer_load_dwordx4 v236, s[24:27], s89 offen offset:3072 lds
    s_mov_b32 s94, 0
L_spin_11:
    s_waitcnt lgkmcnt(0)
    s_min_u32 s74, s74, s75
    s_cmp_ge_u32 s74, 4
    s_cbranch_scc1 L_ok_10
    s_add_u32 s94, s94, 1
    s_cmp_gt_u32 s94, 0x80000
    s_cbranch_scc1 L_ok_10
    s_sleep 2
    s_lshl_b32 s64, s4, 1
    s_add_u32 s64, s64, 8
    s_add_u32 s64, s64, s5
    s_and_b32 s64, s64, 15
    s_xor_b32 s64, s64, 4
    s_and_b32 s65, s55, -16
    s_add_u32 s64, s64, s65
    s_lshl_b32 s64, s64, 7
    s_add_u32 s64, s64, 27762688
    s_load_dword s74, s[86:87], s64 glc
    s_lshl_b32 s64, s4, 1
    s_add_u32 s64, s64, 9
    s_add_u32 s64, s64, s5
    s_and_b32 s64, s64, 15
    s_xor_b32 s64, s64, 4
    s_and_b32 s65, s55, -16
    s_add_u32 s64, s64, s65
    s_lshl_b32 s64, s64, 7
    s_add_u32 s64, s64, 27762688
    s_load_dword s75, s[86:87], s64 glc
    s_branch L_spin_11
L_ok_10:
    s_waitcnt vmcnt(12)
    s_barrier
    s_add_u32 m0, s56, 32768
    s_nop 0
    buffer_load_dwordx4 v237, s[28:31], s88 offen offset:0 sc1 lds
    buffer_load_dwordx4 v237, s[28:31], s88 offen offset:1024 sc1 lds
    buffer_load_dwordx4 v237, s[28:31], s88 offen offset:2048 sc1 lds
    buffer_load_dwordx4 v237, s[28:31], s88 offen offset:3072 sc1 lds
    s_add_u32 s90, s62, 16
    s_and_b32 s90, s90, 31
    s_lshl_b32 s89, s90, 16
    s_add_u32 m0, s56, 81920
    s_lshl_b32 s88, s90, 13
    buffer_load_dwordx4 v233, s[24:27], s89 offen offset:0 lds
    buffer_load_dwordx4 v234, s[24:27], s89 offen offset:1024 lds
    buffer_load_dwordx4 v235, s[24:27], s89 offen offset:2048 lds
    buffer_load_dwordx4 v236, s[24:27], s89 offen offset:3072 lds
    s_add_u32 m0, s95, 65536
    s_nop 0
    buffer_load_dwordx4 v238, s[28:31], s88 offen offset:0 sc1 lds
    buffer_load_dwordx4 v238, s[28:31], s88 offen offset:1024 sc1 lds
    s_waitcnt vmcnt(14)
    s_barrier
    s_add_u32 s90, s62, 18
    s_and_b32 s90, s90, 31
    s_lshl_b32 s89, s90, 16
    s_add_u32 m0, s56, 114688
    s_lshl_b32 s88, s90, 13
    buffer_load_dwordx4 v233, s[24:27], s89 offen offset:0 lds
    buffer_load_dwordx4 v234, s[24:27], s89 offen offset:1024 lds
    buffer_load_dwordx4 v235, s[24:27], s89 offen offset:2048 lds
    buffer_load_dwordx4 v236, s[24:27], s89 offen offset:3072 lds
    s_add_u32 m0, s95, 98304
    s_nop 0
    buffer_load_dwordx4 v238, s[28:31], s88 offen offset:0 sc1 lds
    buffer_load_dwordx4 v238, s[28:31], s88 offen offset:1024 sc1 lds
    s_waitcnt vmcnt(12)
    s_barrier
    s_add_u32 s90, s62, 20
    s_and_b32 s90, s90, 31
    s_lshl_b32 s89, s90, 16
    s_add_u32 m0, s56, 16384
    s_lshl_b32 s88, s90, 13
    buffer_load_dwordx4 v233, s[24:27], s89 offen offset:0 lds
    buffer_load_dwordx4 v234, s[24:27], s89 offen offset:1024 lds
    buffer_load_dwordx4 v235, s[24:27], s89 offen offset:2048 lds
    buffer_load_dwordx4 v236, s[24:27], s89 offen offset:3072 lds
    s_add_u32 m0, s95, 0
    s_nop 0
    buffer_load_dwordx4 v238, s[28:31], s88 offen offset:0 sc1 lds
    buffer_load_dwordx4 v238, s[28:31], s88 offen offset:1024 sc1 lds
    s_waitcnt vmcnt(12)
    s_barrier
    s_add_u32 s90, s62, 22
    s_and_b32 s90, s90, 31
    s_lshl_b32 s89, s90, 16
    s_add_u32 m0, s56, 49152
    s_lshl_b32 s88, s90, 13
    buffer_load_dwordx4 v233, s[24:27], s89 offen offset:0 lds
    buffer_load_dwordx4 v234, s[24:27], s89 offen offset:1024 lds
    buffer_load_dwordx4 v235, s[24:27], s89 offen offset:2048 lds
    buffer_load_dwordx4 v236, s[24:27], s89 offen offset:3072 lds
    s_add_u32 m0, s95, 32768
    s_nop 0
    buffer_load_dwordx4 v238, s[28:31], s88 offen offset:0 sc1 lds
    buffer_load_dwordx4 v238, s[28:31], s88 offen offset:1024 sc1 lds
    s_waitcnt vmcnt(12)
    s_barrier
    s_add_u32 s90, s62, 24
    s_and_b32 s90, s90, 31
    s_lshl_b32 s89, s90, 16
    s_add_u32 m0, s56, 81920
    s_lshl_b32 s88, s90, 13
    buffer_load_dwordx4 v233, s[24:27], s89 offen offset:0 lds
    buffer_load_dwordx4 v234, s[24:27], s89 offen offset:1024 lds
    buffer_load_dwordx4 v235, s[24:27], s89 offen offset:2048 lds
    buffer_load_dwordx4 v236, s[24:27], s89 offen offset:3072 lds
    s_add_u32 m0, s95, 65536
    s_nop 0
    buffer_load_dwordx4 v238, s[28:31], s88 offen offset:0 sc1 lds
    buffer_load_dwordx4 v238, s[28:31], s88 offen offset:1024 sc1 lds
    s_waitcnt vmcnt(12)
    s_barrier
    s_add_u32 s90, s62, 26
    s_and_b32 s90, s90, 31
    s_lshl_b32 s89, s90, 16
    s_add_u32 m0, s56, 114688
    s_lshl_b32 s88, s90, 13
    buffer_load_dwordx4 v233, s[24:27], s89 offen offset:0 lds
    buffer_load_dwordx4 v234, s[24:27], s89 offen offset:1024 lds
    buffer_load_dwordx4 v235, s[24:27], s89 offen offset:2048 lds
    buffer_load_dwordx4 v236, s[24:27], s89 offen offset:3072 lds
    s_add_u32 m0, s95, 98304
    s_nop 0
    buffer_load_dwordx4 v238, s[28:31], s88 offen offset:0 sc1 lds
    buffer_load_dwordx4 v238, s[28:31], s88 offen offset:1024 sc1 lds
    s_waitcnt vmcnt(12)
    s_barrier
    s_cmp_lg_u32 s4, 0
    s_cbranch_scc1 L_w0_17
    s_lshl_b32 s64, s55, 7
    s_add_u32 s64, s64, 27795456
    s_mov_b32 s66, 1
    s_atomic_add s66, s[86:87], s64
L_w0_17:
    s_add_u32 s90, s62, 28
    s_and_b32 s90, s90, 31
    s_lshl_b32 s89, s90, 16
    s_add_u32 m0, s56, 16384
    s_lshl_b32 s88, s90, 13
    buffer_load_dwordx4 v233, s[24:27], s89 offen offset:0 lds
    buffer_load_dwordx4 v234, s[24:27], s89 offen offset:1024 lds
    buffer_load_dwordx4 v235, s[24:27], s89 offen offset:2048 lds
    buffer_load_dwordx4 v236, s[24:27], s89 offen offset:3072 lds
    s_add_u32 m0, s95, 0
    s_nop 0
    buffer_load_dwordx4 v238, s[28:31], s88 offen offset:0 sc1 lds
    buffer_load_dwordx4 v238, s[28:31], s88 offen offset:1024 sc1 lds
    s_waitcnt vmcnt(12)
    s_barrier
    s_cmp_lg_u32 s4, 0
    s_cbranch_scc1 L_w0_18
    s_xor_b32 s64, s55, 8
    s_lshl_b32 s64, s64, 7
    s_add_u32 s64, s64, 27795456
    s_load_dword s74, s[86:87], s64 glc
L_w0_18:
    s_add_u32 s90, s62, 30
    s_and_b32 s90, s90, 31
    s_lshl_b32 s89, s90, 16
    s_add_u32 m0, s56, 49152
    s_lshl_b32 s88, s90, 13
    buffer_load_dwordx4 v233, s[24:27], s89 offen offset:0 lds
    buffer_load_dwordx4 v234, s[24:27], s89 offen offset:1024 lds
    buffer_load_dwordx4 v235, s[24:27], s89 offen offset:2048 lds
    buffer_load_dwordx4 v236, s[24:27], s89 offen offset:3072 lds
    s_add_u32 m0, s95, 32768
    s_nop 0
    buffer_load_dwordx4 v238, s[28:31], s88 offen offset:0 sc1 lds
    buffer_load_dwordx4 v238, s[28:31], s88 offen offset:1024 sc1 lds
    s_cmp_lg_u32 s4, 0
    s_cbranch_scc1 L_ok_19
    s_mov_b32 s94, 0
L_spin_20:
    s_waitcnt lgkmcnt(0)
    s_cmp_ge_u32 s74, 1
    s_cbranch_scc1 L_ok_19
    s_add_u32 s94, s94, 1
    s_cmp_gt_u32 s94, 0x80000
    s_cbranch_scc1 L_ok_19
    s_sleep 2
    s_xor_b32 s64, s55, 8
    s_lshl_b32 s64, s64, 7
    s_add_u32 s64, s64, 27795456
    s_load_dword s74, s[86:87], s64 glc
    s_branch L_spin_20
L_ok_19:
    s_waitcnt vmcnt(12)
    s_barrier
    s_waitcnt vmcnt(6)
    s_barrier
    s_waitcnt vmcnt(0)
    s_barrier
    s_endpgm
.p2align 12
L_g0:
    s_lshr_b32 s7, s6, 3
    s_and_b32 s54, s6, 7
    s_lshl_b32 s55, s5, 4
    s_add_u32 s55, s55, s6
    s_lshr_b32 s52, s4, 1
    s_and_b32 s53, s4, 1
    s_mul_i32 s58, s4, 6144
    s_and_b32 s60, s5, 7
    s_mul_i32 s60, s60, 7
    s_and_b32 s62, s5, 15
    s_mul_i32 s62, s62, 2
    s_add_u32 s62, s62, s52
    s_xor_b32 s61, s6, 4
    s_mov_b32 s96, 0x3fb8aa3b
    s_mov_b32 s97, 0xbfb8aa3b
    v_and_b32 v1, 15, v0
    v_lshrrev_b32 v2, 4, v0
    v_bfe_u32 v3, v0, 2, 2
    v_and_b32 v4, 3, v0
    v_lshrrev_b32 v5, 1, v1
    v_xor_b32 v5, v5, v2
    v_lshlrev_b32 v5, 4, v5
    v_lshl_add_u32 v5, v1, 7, v5
    s_lshl_b32 s92, s52, 13
    s_add_u32 s92, s92, 0
    v_add_u32 v239, s92, v5
    v_xor_b32 v5, 64, v5
    v_add_u32_e64 v240, s92, v5
    v_lshl_add_u32 v5, v2, 3, v3
    v_mul_u32_u24 v5, 448, v5
    v_lshl_add_u32 v5, v4, 3, v5
    v_add_u32 v5, 16384, v5
    v_and_b32 v6, 1, v2
    s_mul_i32 s92, s53, 6
    s_add_u32 s92, s92, 0
    v_xor_b32 v7, s92, v6
    v_lshl_add_u32 v241, v7, 5, v5
    s_mul_i32 s92, s53, 6
    s_add_u32 s92, s92, 1
    v_xor_b32_e64 v7, s92, v6
    v_lshl_add_u32 v242, v7, 5, v5
    s_add_u32 s92, s53, 12
    v_xor_b32 v7, s92, v6
    v_lshl_add_u32 v243, v7, 5, v5
    v_add_u32 v226, 90112, v239
    v_add_u32 v227, 90112, v240
    v_add_u32 v228, 90112, v241
    v_add_u32 v229, 90112, v242
    v_add_u32 v230, 90112, v243
    s_waitcnt lgkmcnt(0)
    s_mul_i32 s91, s7, 3670016
    s_add_u32 s20, s78, s91
    s_addc_u32 s21, s79, 0
    s_mov_b32 s22, 3670016
    s_mov_b32 s23, 0x20000
    s_mov_b32 s28, s86
    s_mov_b32 s29, s87
    s_mov_b32 s30, 28483584
    s_mov_b32 s31, 0x20000
    s_mov_b32 s32, s82
    s_mov_b32 s33, s83
    s_mov_b32 s34, 4194304
    s_mov_b32 s35, 0x20000
    v_lshrrev_b32 v1, 4, v0
    v_bfe_u32 v2, v0, 1, 3
    v_xor_b32 v2, v2, v1
    v_and_b32 v3, 1, v0
    v_lshlrev_b32_e64 v1, 11, v1
    v_lshl_add_u32 v1, v3, 4, v1
    s_lshl_b32 s92, s53, 15
    s_lshl_b32 s91, s54, 8
    s_add_u32 s92, s92, s91
    v_add_u32 v1, s92, v1
    v_lshl_add_u32 v233, v2, 5, v1
    v_xor_b32_e64 v2, 4, v2
    v_lshl_add_u32 v2, v2, 5, v1
    v_add_u32 v234, 7168, v2
    v_add_u32 v235, 14336, v233
    v_add_u32 v236, 14336, v234
    s_lshl_b32 s92, s53, 12
    s_mul_i32 s91, s5, 144
    s_mul_i32 s95, s7, 56
    s_add_u32 s91, s91, s95
    s_lshl_b32 s91, s91, 13
    s_add_u32 s92, s92, s91
    v_add_u32_e64 v237, s92, v249
    s_lshl_b32 s92, s7, 1
    s_add_u32 s92, s92, s53
    s_lshl_b32 s92, s92, 11
    s_lshl_b32 s95, s52, 13
    s_add_u32 s95, s95, s92
    s_mul_i32 s91, s5, 1179648
    s_add_u32 s92, s92, s91
    s_add_u32 s92, s92, 917504
    v_add_u32 v238, s92, v249
    v_bfe_u32 v1, v0, 2, 2
    v_lshrrev_b32 v2, 4, v0
    v_cmp_eq_u32 vcc, v1, v2
    v_and_b32 v1, 1, v0
    v_lshlrev_b32 v1, 4, v1
    v_mov_b32 v2, 0x3f80
    v_lshlrev_b32 v1, v1, v2
    v_cndmask_b32 v1, 0, v1, vcc
    v_and_b32 v2, 2, v0
    v_cmp_eq_u32 vcc, 0, v2
    v_mov_b32 v220, 0
    v_mov_b32 v221, 0
    v_cndmask_b32 v218, 0, v1, vcc
    v_mov_b32 v216, 0
    v_mov_b32 v217, 0
    v_sub_u32 v219, v1, v218
    s_mul_i32 s63, s2, 13108
    s_lshr_b32 s63, s63, 16
    s_mul_i32 s63, s63, 5
    s_sub_u32 s63, s2, s63
    s_cmp_eq_u32 s4, 0
    s_cselect_b32 s63, s63, 99
    s_lshl_b32 s78, s5, 2
    s_lshl_b32 s79, s7, 1
    s_add_u32 s78, s78, s79
    s_add_u32 s78, s78, s52
    s_lshl_b32 s78, s78, 16
    s_lshl_b32 s79, s54, 8
    s_add_u32 s78, s78, s79
    s_lshl_b32 s79, s53, 7
    s_add_u32 s78, s78, s79
    s_add_u32 s79, s78, 32768
    s_mul_i32 s93, s4, 4608
    s_add_u32 s93, s93, 98304
    v_and_b32 v9, 15, v0
    v_mul_u32_u24 v9, 144, v9
    v_and_b32_e64 v2, 16, v0
    v_lshl_add_u32 v9, v2, 1, v9
    v_lshrrev_b32_e64 v2, 5, v0
    v_lshl_add_u32 v9, v2, 4, v9
    v_add_u32 v9, s93, v9
    v_lshrrev_b32 v10, 3, v0
    v_mul_u32_u24 v11, 144, v10
    v_and_b32_e64 v2, 7, v0
    v_lshl_add_u32 v11, v2, 4, v11
    v_add_u32 v11, s93, v11
    v_lshlrev_b32 v10, 11, v10
    v_lshl_add_u32 v10, v2, 4, v10
    v_add_u32 v12, 16384, v10
    s_mov_b64 exec, 0
    s_cmp_eq_u32 s4, 0
    s_cbranch_scc1 L_walka_0
    s_cmp_eq_u32 s4, 1
    s_cbranch_scc1 L_walka_1
    s_cmp_eq_u32 s4, 2
    s_cbranch_scc1 L_walka_2
    s_cmp_eq_u32 s4, 3
    s_cbranch_scc1 L_walka_3
L_walkeda:
    s_mov_b64 exec, -1
    s_lshr_b32 s93, s56, 2
    s_add_u32 s93, s93, 143360
    s_mul_i32 s91, s53, 192
    s_lshl_b32 s92, s53, 5
    v_lshrrev_b32 v1, 4, v0
    v_lshlrev_b32 v1, 3, v1
    v_add_u32 v1, s93, v1
    v_add_u32 v14, s92, v1
    v_add_u32 v1, s91, v1
    s_barrier
    ds_read_b64 v[100:101], v1 offset:0
    ds_read_b64 v[102:103], v1 offset:32
    ds_read_b64 v[104:105], v1 offset:64
    ds_read_b64 v[106:107], v1 offset:96
    ds_read_b64 v[108:109], v1 offset:128
    ds_read_b64 v[110:111], v1 offset:160
    ds_read_b64 v[112:113], v14 offset:384
    s_waitcnt lgkmcnt(0)
    v_lshlrev_b32 v16, 16, v100
    v_and_b32 v17, 0xffff0000, v100
    v_lshlrev_b32_e64 v18, 16, v101
    v_and_b32 v19, 0xffff0000, v101
    v_lshlrev_b32_e64 v20, 16, v102
    v_and_b32 v21, 0xffff0000, v102
    v_lshlrev_b32_e64 v22, 16, v103
    v_and_b32 v23, 0xffff0000, v103
    v_lshlrev_b32_e64 v24, 16, v104
    v_and_b32 v25, 0xffff0000, v104
    v_lshlrev_b32_e64 v26, 16, v105
    v_and_b32 v27, 0xffff0000, v105
    v_lshlrev_b32_e64 v28, 16, v106
    v_and_b32 v29, 0xffff0000, v106
    v_lshlrev_b32_e64 v30, 16, v107
    v_and_b32 v31, 0xffff0000, v107
    v_lshlrev_b32_e64 v32, 16, v108
    v_and_b32 v33, 0xffff0000, v108
    v_lshlrev_b32_e64 v34, 16, v109
    v_and_b32 v35, 0xffff0000, v109
    v_lshlrev_b32_e64 v36, 16, v110
    v_and_b32 v37, 0xffff0000, v110
    v_lshlrev_b32_e64 v38, 16, v111
    v_and_b32 v39, 0xffff0000, v111
    v_lshlrev_b32_e64 v40, 16, v112
    v_and_b32 v41, 0xffff0000, v112
    v_lshlrev_b32_e64 v42, 16, v113
    v_and_b32 v43, 0xffff0000, v113
    v_pk_mov_b32 v[44:45], v[16:17], v[16:17] op_sel:[0,1]
    v_pk_mov_b32 v[46:47], v[18:19], v[18:19] op_sel:[0,1]
    v_pk_mov_b32 v[48:49], v[20:21], v[20:21] op_sel:[0,1]
    v_pk_mov_b32 v[50:51], v[22:23], v[22:23] op_sel:[0,1]
    v_pk_mov_b32 v[52:53], v[24:25], v[24:25] op_sel:[0,1]
    v_pk_mov_b32 v[54:55], v[26:27], v[26:27] op_sel:[0,1]
    v_pk_mov_b32 v[56:57], v[28:29], v[28:29] op_sel:[0,1]
    v_pk_mov_b32 v[58:59], v[30:31], v[30:31] op_sel:[0,1]
    v_pk_mov_b32 v[60:61], v[32:33], v[32:33] op_sel:[0,1]
    v_pk_mov_b32 v[62:63], v[34:35], v[34:35] op_sel:[0,1]
    v_pk_mov_b32 v[64:65], v[36:37], v[36:37] op_sel:[0,1]
    v_pk_mov_b32 v[66:67], v[38:39], v[38:39] op_sel:[0,1]
    v_pk_mov_b32 v[68:69], v[40:41], v[40:41] op_sel:[0,1]
    v_pk_mov_b32 v[70:71], v[42:43], v[42:43] op_sel:[0,1]
    v_pk_mov_b32 v[72:73], v[16:17], v[16:17] op_sel:[0,1]
    v_pk_mov_b32 v[74:75], v[18:19], v[18:19] op_sel:[0,1]
    v_pk_mov_b32 v[76:77], v[20:21], v[20:21] op_sel:[0,1]
    v_pk_mov_b32 v[78:79], v[22:23], v[22:23] op_sel:[0,1]
    v_pk_mov_b32 v[80:81], v[24:25], v[24:25] op_sel:[0,1]
    v_pk_mov_b32 v[82:83], v[26:27], v[26:27] op_sel:[0,1]
    v_pk_mov_b32 v[84:85], v[28:29], v[28:29] op_sel:[0,1]
    v_pk_mov_b32 v[86:87], v[30:31], v[30:31] op_sel:[0,1]
    v_pk_mov_b32 v[88:89], v[32:33], v[32:33] op_sel:[0,1]
    v_pk_mov_b32 v[90:91], v[34:35], v[34:35] op_sel:[0,1]
    v_pk_mov_b32 v[92:93], v[36:37], v[36:37] op_sel:[0,1]
    v_pk_mov_b32 v[94:95], v[38:39], v[38:39] op_sel:[0,1]
    v_pk_mov_b32 v[96:97], v[40:41], v[40:41] op_sel:[0,1]
    v_pk_mov_b32 v[98:99], v[42:43], v[42:43] op_sel:[0,1]
    v_pk_mov_b32 v[100:101], v[16:17], v[16:17] op_sel:[0,1]
    v_pk_mov_b32 v[102:103], v[18:19], v[18:19] op_sel:[0,1]
    v_pk_mov_b32 v[104:105], v[20:21], v[20:21] op_sel:[0,1]
    v_pk_mov_b32 v[106:107], v[22:23], v[22:23] op_sel:[0,1]
    v_pk_mov_b32 v[108:109], v[24:25], v[24:25] op_sel:[0,1]
    v_pk_mov_b32 v[110:111], v[26:27], v[26:27] op_sel:[0,1]
    v_pk_mov_b32 v[112:113], v[28:29], v[28:29] op_sel:[0,1]
    v_pk_mov_b32 v[114:115], v[30:31], v[30:31] op_sel:[0,1]
    v_pk_mov_b32 v[116:117], v[32:33], v[32:33] op_sel:[0,1]
    v_pk_mov_b32 v[118:119], v[34:35], v[34:35] op_sel:[0,1]
    v_pk_mov_b32 v[120:121], v[36:37], v[36:37] op_sel:[0,1]
    v_pk_mov_b32 v[122:123], v[38:39], v[38:39] op_sel:[0,1]
    v_pk_mov_b32 v[124:125], v[40:41], v[40:41] op_sel:[0,1]
    v_pk_mov_b32 v[126:127], v[42:43], v[42:43] op_sel:[0,1]
    s_mov_b64 exec, 0
    s_cmp_eq_u32 s4, 0
    s_cbranch_scc1 L_walkb_0
    s_cmp_eq_u32 s4, 1
    s_cbranch_scc1 L_walkb_1
    s_cmp_eq_u32 s4, 2
    s_cbranch_scc1 L_walkb_2
    s_cmp_eq_u32 s4, 3
    s_cbranch_scc1 L_walkb_3
L_walkedb:
    s_mov_b64 exec, -1
    s_barrier
    ds_read_b128 v[128:131], v226 offset:57344
    ds_read_b128 v[132:135], v227 offset:57344
    ds_read_b128 v[136:139], v226 offset:59392
    ds_read_b64_tr_b16 v[160:161], v241 offset:0
    ds_read_b64_tr_b16 v[162:163], v241 offset:1792
    ds_read_b64_tr_b16 v[164:165], v241 offset:14336
    ds_read_b64_tr_b16 v[166:167], v241 offset:16128
    ds_read_b64_tr_b16 v[168:169], v242 offset:0
    ds_read_b64_tr_b16 v[170:171], v242 offset:1792
    ds_read_b64_tr_b16 v[172:173], v242 offset:14336
    ds_read_b64_tr_b16 v[174:175], v242 offset:16128
    s_waitcnt lgkmcnt(6)
    v_mfma_f32_16x16x32_bf16 v[16:19], v[160:163], v[128:131], v[16:19]
    ds_read_b128 v[140:143], v227 offset:59392
    ds_read_b64_tr_b16 v[188:189], v242 offset:14400
    ds_read_b64_tr_b16 v[210:211], v243 offset:1792
    s_waitcnt lgkmcnt(7)
    v_mfma_f32_16x16x32_bf16 v[16:19], v[164:167], v[132:135], v[16:19]
    ds_read_b128 v[144:147], v226 offset:61440
    ds_read_b64_tr_b16 v[190:191], v242 offset:16192
    ds_read_b64_tr_b16 v[212:213], v243 offset:14336
    s_waitcnt lgkmcnt(8)
    v_mfma_f32_16x16x32_bf16 v[20:23], v[168:171], v[128:131], v[20:23]
    ds_read_b128 v[148:151], v227 offset:61440
    ds_read_b64_tr_b16 v[192:193], v241 offset:128
    ds_read_b64_tr_b16 v[214:215], v243 offset:16128
    s_waitcnt lgkmcnt(9)
    v_mfma_f32_16x16x32_bf16 v[20:23], v[172:175], v[132:135], v[20:23]
    ds_read_b128 v[152:155], v226 offset:63488
    ds_read_b64_tr_b16 v[194:195], v241 offset:1920
    v_mfma_f32_16x16x32_bf16 v[48:51], v[168:171], v[136:139], v[48:51]
    ds_read_b128 v[156:159], v227 offset:63488
    ds_read_b64_tr_b16 v[196:197], v241 offset:14464
    s_waitcnt lgkmcnt(10)
    v_mfma_f32_16x16x32_bf16 v[48:51], v[172:175], v[140:143], v[48:51]
    ds_read_b64_tr_b16 v[176:177], v241 offset:64
    ds_read_b64_tr_b16 v[198:199], v241 offset:16256
    v_mfma_f32_16x16x32_bf16 v[44:47], v[160:163], v[136:139], v[44:47]
    ds_read_b64_tr_b16 v[178:179], v241 offset:1856
    ds_read_b64_tr_b16 v[200:201], v242 offset:128
    v_mfma_f32_16x16x32_bf16 v[44:47], v[164:167], v[140:143], v[44:47]
    ds_read_b64_tr_b16 v[180:181], v241 offset:14400
    ds_read_b64_tr_b16 v[202:203], v242 offset:1920
    s_waitcnt lgkmcnt(8)
    v_mfma_f32_16x16x32_bf16 v[72:75], v[160:163], v[144:147], v[72:75]
    ds_read_b64_tr_b16 v[182:183], v241 offset:16192
    ds_read_b64_tr_b16 v[204:205], v242 offset:14464
    v_mfma_f32_16x16x32_bf16 v[72:75], v[164:167], v[148:151], v[72:75]
    ds_read_b64_tr_b16 v[184:185], v242 offset:64
    ds_read_b64_tr_b16 v[206:207], v242 offset:16256
    v_mfma_f32_16x16x32_bf16 v[76:79], v[168:171], v[144:147], v[76:79]
    ds_read_b64_tr_b16 v[186:187], v242 offset:1856
    ds_read_b64_tr_b16 v[208:209], v243 offset:0
    v_mfma_f32_16x16x32_bf16 v[76:79], v[172:175], v[148:151], v[76:79]
    v_mfma_f32_16x16x32_bf16 v[104:107], v[168:171], v[152:155], v[104:107]
    s_waitcnt lgkmcnt(4)
    v_mfma_f32_16x16x32_bf16 v[104:107], v[172:175], v[156:159], v[104:107]
    v_mfma_f32_16x16x32_bf16 v[100:103], v[160:163], v[152:155], v[100:103]
    v_mfma_f32_16x16x32_bf16 v[100:103], v[164:167], v[156:159], v[100:103]
    s_waitcnt lgkmcnt(0)
    s_mov_b32 s67, 5
.p2align 3
L_loop_21:
    s_barrier
    v_mfma_f32_16x16x32_bf16 v[108:111], v[176:179], v[152:155], v[108:111]
    ds_read_b64_tr_b16 v[160:161], v241 offset:45056
    v_mfma_f32_16x16x32_bf16 v[108:111], v[180:183], v[156:159], v[108:111]
    ds_read_b64_tr_b16 v[162:163], v241 offset:46848
    v_mfma_f32_16x16x32_bf16 v[80:83], v[176:179], v[144:147], v[80:83]
    ds_read_b64_tr_b16 v[164:165], v241 offset:59392
    s_sub_u32 s67, s67, 1
    v_mfma_f32_16x16x32_bf16 v[80:83], v[180:183], v[148:151], v[80:83]
    ds_read_b64_tr_b16 v[166:167], v241 offset:61184
    v_mfma_f32_16x16x32_bf16 v[52:55], v[176:179], v[136:139], v[52:55]
    ds_read_b64_tr_b16 v[168:169], v242 offset:45056
    v_mfma_f32_16x16x32_bf16 v[52:55], v[180:183], v[140:143], v[52:55]
    ds_read_b64_tr_b16 v[170:171], v242 offset:46848
    v_mfma_f32_16x16x32_bf16 v[24:27], v[176:179], v[128:131], v[24:27]
    ds_read_b64_tr_b16 v[172:173], v242 offset:59392
    v_mfma_f32_16x16x32_bf16 v[24:27], v[180:183], v[132:135], v[24:27]
    ds_read_b64_tr_b16 v[174:175], v242 offset:61184
    v_mfma_f32_16x16x32_bf16 v[28:31], v[184:187], v[128:131], v[28:31]
    ds_read_b64_tr_b16 v[176:177], v241 offset:45120
    v_mfma_f32_16x16x32_bf16 v[28:31], v[188:191], v[132:135], v[28:31]
    ds_read_b64_tr_b16 v[178:179], v241 offset:46912
    v_mfma_f32_16x16x32_bf16 v[56:59], v[184:187], v[136:139], v[56:59]
    ds_read_b64_tr_b16 v[180:181], v241 offset:59456
    v_mfma_f32_16x16x32_bf16 v[56:59], v[188:191], v[140:143], v[56:59]
    ds_read_b64_tr_b16 v[182:183], v241 offset:61248
    v_mfma_f32_16x16x32_bf16 v[84:87], v[184:187], v[144:147], v[84:87]
    v_mfma_f32_16x16x32_bf16 v[84:87], v[188:191], v[148:151], v[84:87]
    v_mfma_f32_16x16x32_bf16 v[112:115], v[184:187], v[152:155], v[112:115]
    ds_read_b64_tr_b16 v[184:185], v242 offset:45120
    v_mfma_f32_16x16x32_bf16 v[112:115], v[188:191], v[156:159], v[112:115]
    ds_read_b64_tr_b16 v[186:187], v242 offset:46912
    v_mfma_f32_16x16x32_bf16 v[116:119], v[192:195], v[152:155], v[116:119]
    ds_read_b64_tr_b16 v[188:189], v242 offset:59456
    v_mfma_f32_16x16x32_bf16 v[116:119], v[196:199], v[156:159], v[116:119]
    ds_read_b64_tr_b16 v[190:191], v242 offset:61248
    v_mfma_f32_16x16x32_bf16 v[88:91], v[192:195], v[144:147], v[88:91]
    v_mfma_f32_16x16x32_bf16 v[88:91], v[196:199], v[148:151], v[88:91]
    v_mfma_f32_16x16x32_bf16 v[60:63], v[192:195], v[136:139], v[60:63]
    v_mfma_f32_16x16x32_bf16 v[60:63], v[196:199], v[140:143], v[60:63]
    v_mfma_f32_16x16x32_bf16 v[32:35], v[192:195], v[128:131], v[32:35]
    ds_read_b64_tr_b16 v[192:193], v241 offset:45184
    v_mfma_f32_16x16x32_bf16 v[32:35], v[196:199], v[132:135], v[32:35]
    ds_read_b64_tr_b16 v[194:195], v241 offset:46976
    v_mfma_f32_16x16x32_bf16 v[36:39], v[200:203], v[128:131], v[36:39]
    ds_read_b64_tr_b16 v[196:197], v241 offset:59520
    v_mfma_f32_16x16x32_bf16 v[36:39], v[204:207], v[132:135], v[36:39]
    ds_read_b64_tr_b16 v[198:199], v241 offset:61312
    v_mfma_f32_16x16x32_bf16 v[40:43], v[208:211], v[128:131], v[40:43]
    ds_read_b128 v[128:131], v239 offset:45056
    v_mfma_f32_16x16x32_bf16 v[40:43], v[212:215], v[132:135], v[40:43]
    ds_read_b128 v[132:135], v240 offset:45056
    v_mfma_f32_16x16x32_bf16 v[68:71], v[208:211], v[136:139], v[68:71]
    v_mfma_f32_16x16x32_bf16 v[68:71], v[212:215], v[140:143], v[68:71]
    v_mfma_f32_16x16x32_bf16 v[64:67], v[200:203], v[136:139], v[64:67]
    ds_read_b128 v[136:139], v239 offset:47104
    v_mfma_f32_16x16x32_bf16 v[64:67], v[204:207], v[140:143], v[64:67]
    ds_read_b128 v[140:143], v240 offset:47104
    v_mfma_f32_16x16x32_bf16 v[92:95], v[200:203], v[144:147], v[92:95]
    v_mfma_f32_16x16x32_bf16 v[92:95], v[204:207], v[148:151], v[92:95]
    v_mfma_f32_16x16x32_bf16 v[96:99], v[208:211], v[144:147], v[96:99]
    ds_read_b128 v[144:147], v239 offset:49152
    v_mfma_f32_16x16x32_bf16 v[96:99], v[212:215], v[148:151], v[96:99]
    ds_read_b128 v[148:151], v240 offset:49152
    v_mfma_f32_16x16x32_bf16 v[124:127], v[208:211], v[152:155], v[124:127]
    ds_read_b64_tr_b16 v[208:209], v243 offset:45056
    v_mfma_f32_16x16x32_bf16 v[124:127], v[212:215], v[156:159], v[124:127]
    ds_read_b64_tr_b16 v[210:211], v243 offset:46848
    v_mfma_f32_16x16x32_bf16 v[120:123], v[200:203], v[152:155], v[120:123]
    ds_read_b128 v[152:155], v239 offset:51200
    v_mfma_f32_16x16x32_bf16 v[120:123], v[204:207], v[156:159], v[120:123]
    ds_read_b128 v[156:159], v240 offset:51200
    s_waitcnt lgkmcnt(4)
    v_mfma_f32_16x16x32_bf16 v[16:19], v[160:163], v[128:131], v[16:19]
    ds_read_b64_tr_b16 v[212:213], v243 offset:59392
    v_mfma_f32_16x16x32_bf16 v[16:19], v[164:167], v[132:135], v[16:19]
    ds_read_b64_tr_b16 v[214:215], v243 offset:61184
    v_mfma_f32_16x16x32_bf16 v[20:23], v[168:171], v[128:131], v[20:23]
    ds_read_b64_tr_b16 v[200:201], v242 offset:45184
    v_mfma_f32_16x16x32_bf16 v[20:23], v[172:175], v[132:135], v[20:23]
    ds_read_b64_tr_b16 v[202:203], v242 offset:46976
    v_mfma_f32_16x16x32_bf16 v[48:51], v[168:171], v[136:139], v[48:51]
    ds_read_b64_tr_b16 v[204:205], v242 offset:59520
    v_mfma_f32_16x16x32_bf16 v[48:51], v[172:175], v[140:143], v[48:51]
    ds_read_b64_tr_b16 v[206:207], v242 offset:61312
    v_mfma_f32_16x16x32_bf16 v[44:47], v[160:163], v[136:139], v[44:47]
    v_mfma_f32_16x16x32_bf16 v[44:47], v[164:167], v[140:143], v[44:47]
    v_mfma_f32_16x16x32_bf16 v[72:75], v[160:163], v[144:147], v[72:75]
    v_mfma_f32_16x16x32_bf16 v[72:75], v[164:167], v[148:151], v[72:75]
    v_mfma_f32_16x16x32_bf16 v[76:79], v[168:171], v[144:147], v[76:79]
    v_mfma_f32_16x16x32_bf16 v[76:79], v[172:175], v[148:151], v[76:79]
    s_waitcnt lgkmcnt(0)
    v_mfma_f32_16x16x32_bf16 v[104:107], v[168:171], v[152:155], v[104:107]
    v_mfma_f32_16x16x32_bf16 v[104:107], v[172:175], v[156:159], v[104:107]
    v_mfma_f32_16x16x32_bf16 v[100:103], v[160:163], v[152:155], v[100:103]
    v_mfma_f32_16x16x32_bf16 v[100:103], v[164:167], v[156:159], v[100:103]
    s_waitcnt lgkmcnt(0)
    s_barrier
    v_mfma_f32_16x16x32_bf16 v[108:111], v[176:179], v[152:155], v[108:111]
    ds_read_b64_tr_b16 v[160:161], v228 offset:0
    v_mfma_f32_16x16x32_bf16 v[108:111], v[180:183], v[156:159], v[108:111]
    ds_read_b64_tr_b16 v[162:163], v228 offset:1792
    v_mfma_f32_16x16x32_bf16 v[80:83], v[176:179], v[144:147], v[80:83]
    ds_read_b64_tr_b16 v[164:165], v228 offset:14336
    v_mfma_f32_16x16x32_bf16 v[80:83], v[180:183], v[148:151], v[80:83]
    ds_read_b64_tr_b16 v[166:167], v228 offset:16128
    v_mfma_f32_16x16x32_bf16 v[52:55], v[176:179], v[136:139], v[52:55]
    ds_read_b64_tr_b16 v[168:169], v229 offset:0
    v_mfma_f32_16x16x32_bf16 v[52:55], v[180:183], v[140:143], v[52:55]
    ds_read_b64_tr_b16 v[170:171], v229 offset:1792
    v_mfma_f32_16x16x32_bf16 v[24:27], v[176:179], v[128:131], v[24:27]
    ds_read_b64_tr_b16 v[172:173], v229 offset:14336
    v_mfma_f32_16x16x32_bf16 v[24:27], v[180:183], v[132:135], v[24:27]
    ds_read_b64_tr_b16 v[174:175], v229 offset:16128
    v_mfma_f32_16x16x32_bf16 v[28:31], v[184:187], v[128:131], v[28:31]
    ds_read_b64_tr_b16 v[176:177], v228 offset:64
    v_mfma_f32_16x16x32_bf16 v[28:31], v[188:191], v[132:135], v[28:31]
    ds_read_b64_tr_b16 v[178:179], v228 offset:1856
    v_mfma_f32_16x16x32_bf16 v[56:59], v[184:187], v[136:139], v[56:59]
    ds_read_b64_tr_b16 v[180:181], v228 offset:14400
    v_mfma_f32_16x16x32_bf16 v[56:59], v[188:191], v[140:143], v[56:59]
    ds_read_b64_tr_b16 v[182:183], v228 offset:16192
    v_mfma_f32_16x16x32_bf16 v[84:87], v[184:187], v[144:147], v[84:87]
    v_mfma_f32_16x16x32_bf16 v[84:87], v[188:191], v[148:151], v[84:87]
    v_mfma_f32_16x16x32_bf16 v[112:115], v[184:187], v[152:155], v[112:115]
    ds_read_b64_tr_b16 v[184:185], v229 offset:64
    v_mfma_f32_16x16x32_bf16 v[112:115], v[188:191], v[156:159], v[112:115]
    ds_read_b64_tr_b16 v[186:187], v229 offset:1856
    v_mfma_f32_16x16x32_bf16 v[116:119], v[192:195], v[152:155], v[116:119]
    ds_read_b64_tr_b16 v[188:189], v229 offset:14400
    v_mfma_f32_16x16x32_bf16 v[116:119], v[196:199], v[156:159], v[116:119]
    ds_read_b64_tr_b16 v[190:191], v229 offset:16192
    v_mfma_f32_16x16x32_bf16 v[88:91], v[192:195], v[144:147], v[88:91]
    v_mfma_f32_16x16x32_bf16 v[88:91], v[196:199], v[148:151], v[88:91]
    v_mfma_f32_16x16x32_bf16 v[60:63], v[192:195], v[136:139], v[60:63]
    v_mfma_f32_16x16x32_bf16 v[60:63], v[196:199], v[140:143], v[60:63]
    v_mfma_f32_16x16x32_bf16 v[32:35], v[192:195], v[128:131], v[32:35]
    ds_read_b64_tr_b16 v[192:193], v228 offset:128
    v_mfma_f32_16x16x32_bf16 v[32:35], v[196:199], v[132:135], v[32:35]
    ds_read_b64_tr_b16 v[194:195], v228 offset:1920
    v_mfma_f32_16x16x32_bf16 v[36:39], v[200:203], v[128:131], v[36:39]
    ds_read_b64_tr_b16 v[196:197], v228 offset:14464
    v_mfma_f32_16x16x32_bf16 v[36:39], v[204:207], v[132:135], v[36:39]
    ds_read_b64_tr_b16 v[198:199], v228 offset:16256
    v_mfma_f32_16x16x32_bf16 v[40:43], v[208:211], v[128:131], v[40:43]
    ds_read_b128 v[128:131], v226 offset:0
    v_mfma_f32_16x16x32_bf16 v[40:43], v[212:215], v[132:135], v[40:43]
    ds_read_b128 v[132:135], v227 offset:0
    v_mfma_f32_16x16x32_bf16 v[68:71], v[208:211], v[136:139], v[68:71]
    v_mfma_f32_16x16x32_bf16 v[68:71], v[212:215], v[140:143], v[68:71]
    v_mfma_f32_16x16x32_bf16 v[64:67], v[200:203], v[136:139], v[64:67]
    ds_read_b128 v[136:139], v226 offset:2048
    v_mfma_f32_16x16x32_bf16 v[64:67], v[204:207], v[140:143], v[64:67]
    ds_read_b128 v[140:143], v227 offset:2048
    v_mfma_f32_16x16x32_bf16 v[92:95], v[200:203], v[144:147], v[92:95]
    v_mfma_f32_16x16x32_bf16 v[92:95], v[204:207], v[148:151], v[92:95]
    v_mfma_f32_16x16x32_bf16 v[96:99], v[208:211], v[144:147], v[96:99]
    ds_read_b128 v[144:147], v226 offset:4096
    v_mfma_f32_16x16x32_bf16 v[96:99], v[212:215], v[148:151], v[96:99]
    ds_read_b128 v[148:151], v227 offset:4096
    v_mfma_f32_16x16x32_bf16 v[124:127], v[208:211], v[152:155], v[124:127]
    ds_read_b64_tr_b16 v[208:209], v230 offset:0
    v_mfma_f32_16x16x32_bf16 v[124:127], v[212:215], v[156:159], v[124:127]
    ds_read_b64_tr_b16 v[210:211], v230 offset:1792
    v_mfma_f32_16x16x32_bf16 v[120:123], v[200:203], v[152:155], v[120:123]
    ds_read_b128 v[152:155], v226 offset:6144
    v_mfma_f32_16x16x32_bf16 v[120:123], v[204:207], v[156:159], v[120:123]
    ds_read_b128 v[156:159], v227 offset:6144
    s_waitcnt lgkmcnt(4)
    v_mfma_f32_16x16x32_bf16 v[16:19], v[160:163], v[128:131], v[16:19]
    ds_read_b64_tr_b16 v[212:213], v230 offset:14336
    v_mfma_f32_16x16x32_bf16 v[16:19], v[164:167], v[132:135], v[16:19]
    ds_read_b64_tr_b16 v[214:215], v230 offset:16128
    v_mfma_f32_16x16x32_bf16 v[20:23], v[168:171], v[128:131], v[20:23]
    ds_read_b64_tr_b16 v[200:201], v229 offset:128
    v_mfma_f32_16x16x32_bf16 v[20:23], v[172:175], v[132:135], v[20:23]
    ds_read_b64_tr_b16 v[202:203], v229 offset:1920
    v_mfma_f32_16x16x32_bf16 v[48:51], v[168:171], v[136:139], v[48:51]
    ds_read_b64_tr_b16 v[204:205], v229 offset:14464
    v_mfma_f32_16x16x32_bf16 v[48:51], v[172:175], v[140:143], v[48:51]
    ds_read_b64_tr_b16 v[206:207], v229 offset:16256
    v_mfma_f32_16x16x32_bf16 v[44:47], v[160:163], v[136:139], v[44:47]
    v_mfma_f32_16x16x32_bf16 v[44:47], v[164:167], v[140:143], v[44:47]
    v_mfma_f32_16x16x32_bf16 v[72:75], v[160:163], v[144:147], v[72:75]
    v_mfma_f32_16x16x32_bf16 v[72:75], v[164:167], v[148:151], v[72:75]
    v_mfma_f32_16x16x32_bf16 v[76:79], v[168:171], v[144:147], v[76:79]
    v_mfma_f32_16x16x32_bf16 v[76:79], v[172:175], v[148:151], v[76:79]
    s_waitcnt lgkmcnt(0)
    v_mfma_f32_16x16x32_bf16 v[104:107], v[168:171], v[152:155], v[104:107]
    v_mfma_f32_16x16x32_bf16 v[104:107], v[172:175], v[156:159], v[104:107]
    v_mfma_f32_16x16x32_bf16 v[100:103], v[160:163], v[152:155], v[100:103]
    v_mfma_f32_16x16x32_bf16 v[100:103], v[164:167], v[156:159], v[100:103]
    s_waitcnt lgkmcnt(0)
    s_barrier
    v_mfma_f32_16x16x32_bf16 v[108:111], v[176:179], v[152:155], v[108:111]
    ds_read_b64_tr_b16 v[160:161], v241 offset:0
    v_mfma_f32_16x16x32_bf16 v[108:111], v[180:183], v[156:159], v[108:111]
    ds_read_b64_tr_b16 v[162:163], v241 offset:1792
    v_mfma_f32_16x16x32_bf16 v[80:83], v[176:179], v[144:147], v[80:83]
    ds_read_b64_tr_b16 v[164:165], v241 offset:14336
    v_mfma_f32_16x16x32_bf16 v[80:83], v[180:183], v[148:151], v[80:83]
    ds_read_b64_tr_b16 v[166:167], v241 offset:16128
    v_mfma_f32_16x16x32_bf16 v[52:55], v[176:179], v[136:139], v[52:55]
    ds_read_b64_tr_b16 v[168:169], v242 offset:0
    v_mfma_f32_16x16x32_bf16 v[52:55], v[180:183], v[140:143], v[52:55]
    ds_read_b64_tr_b16 v[170:171], v242 offset:1792
    v_mfma_f32_16x16x32_bf16 v[24:27], v[176:179], v[128:131], v[24:27]
    ds_read_b64_tr_b16 v[172:173], v242 offset:14336
    v_mfma_f32_16x16x32_bf16 v[24:27], v[180:183], v[132:135], v[24:27]
    ds_read_b64_tr_b16 v[174:175], v242 offset:16128
    v_mfma_f32_16x16x32_bf16 v[28:31], v[184:187], v[128:131], v[28:31]
    ds_read_b64_tr_b16 v[176:177], v241 offset:64
    v_mfma_f32_16x16x32_bf16 v[28:31], v[188:191], v[132:135], v[28:31]
    ds_read_b64_tr_b16 v[178:179], v241 offset:1856
    v_mfma_f32_16x16x32_bf16 v[56:59], v[184:187], v[136:139], v[56:59]
    ds_read_b64_tr_b16 v[180:181], v241 offset:14400
    v_mfma_f32_16x16x32_bf16 v[56:59], v[188:191], v[140:143], v[56:59]
    ds_read_b64_tr_b16 v[182:183], v241 offset:16192
    v_mfma_f32_16x16x32_bf16 v[84:87], v[184:187], v[144:147], v[84:87]
    v_mfma_f32_16x16x32_bf16 v[84:87], v[188:191], v[148:151], v[84:87]
    v_mfma_f32_16x16x32_bf16 v[112:115], v[184:187], v[152:155], v[112:115]
    ds_read_b64_tr_b16 v[184:185], v242 offset:64
    v_mfma_f32_16x16x32_bf16 v[112:115], v[188:191], v[156:159], v[112:115]
    ds_read_b64_tr_b16 v[186:187], v242 offset:1856
    v_mfma_f32_16x16x32_bf16 v[116:119], v[192:195], v[152:155], v[116:119]
    ds_read_b64_tr_b16 v[188:189], v242 offset:14400
    v_mfma_f32_16x16x32_bf16 v[116:119], v[196:199], v[156:159], v[116:119]
    ds_read_b64_tr_b16 v[190:191], v242 offset:16192
    v_mfma_f32_16x16x32_bf16 v[88:91], v[192:195], v[144:147], v[88:91]
    v_mfma_f32_16x16x32_bf16 v[88:91], v[196:199], v[148:151], v[88:91]
    v_mfma_f32_16x16x32_bf16 v[60:63], v[192:195], v[136:139], v[60:63]
    v_mfma_f32_16x16x32_bf16 v[60:63], v[196:199], v[140:143], v[60:63]
    v_mfma_f32_16x16x32_bf16 v[32:35], v[192:195], v[128:131], v[32:35]
    ds_read_b64_tr_b16 v[192:193], v241 offset:128
    v_mfma_f32_16x16x32_bf16 v[32:35], v[196:199], v[132:135], v[32:35]
    ds_read_b64_tr_b16 v[194:195], v241 offset:1920
    v_mfma_f32_16x16x32_bf16 v[36:39], v[200:203], v[128:131], v[36:39]
    ds_read_b64_tr_b16 v[196:197], v241 offset:14464
    v_mfma_f32_16x16x32_bf16 v[36:39], v[204:207], v[132:135], v[36:39]
    ds_read_b64_tr_b16 v[198:199], v241 offset:16256
    v_mfma_f32_16x16x32_bf16 v[40:43], v[208:211], v[128:131], v[40:43]
    ds_read_b128 v[128:131], v239 offset:0
    v_mfma_f32_16x16x32_bf16 v[40:43], v[212:215], v[132:135], v[40:43]
    ds_read_b128 v[132:135], v240 offset:0
    v_mfma_f32_16x16x32_bf16 v[68:71], v[208:211], v[136:139], v[68:71]
    v_mfma_f32_16x16x32_bf16 v[68:71], v[212:215], v[140:143], v[68:71]
    v_mfma_f32_16x16x32_bf16 v[64:67], v[200:203], v[136:139], v[64:67]
    ds_read_b128 v[136:139], v239 offset:2048
    v_mfma_f32_16x16x32_bf16 v[64:67], v[204:207], v[140:143], v[64:67]
    ds_read_b128 v[140:143], v240 offset:2048
    v_mfma_f32_16x16x32_bf16 v[92:95], v[200:203], v[144:147], v[92:95]
    v_mfma_f32_16x16x32_bf16 v[92:95], v[204:207], v[148:151], v[92:95]
    v_mfma_f32_16x16x32_bf16 v[96:99], v[208:211], v[144:147], v[96:99]
    ds_read_b128 v[144:147], v239 offset:4096
    v_mfma_f32_16x16x32_bf16 v[96:99], v[212:215], v[148:151], v[96:99]
    ds_read_b128 v[148:151], v240 offset:4096
    v_mfma_f32_16x16x32_bf16 v[124:127], v[208:211], v[152:155], v[124:127]
    ds_read_b64_tr_b16 v[208:209], v243 offset:0
    v_mfma_f32_16x16x32_bf16 v[124:127], v[212:215], v[156:159], v[124:127]
    ds_read_b64_tr_b16 v[210:211], v243 offset:1792
    v_mfma_f32_16x16x32_bf16 v[120:123], v[200:203], v[152:155], v[120:123]
    ds_read_b128 v[152:155], v239 offset:6144
    v_mfma_f32_16x16x32_bf16 v[120:123], v[204:207], v[156:159], v[120:123]
    ds_read_b128 v[156:159], v240 offset:6144
    s_waitcnt lgkmcnt(4)
    v_mfma_f32_16x16x32_bf16 v[16:19], v[160:163], v[128:131], v[16:19]
    ds_read_b64_tr_b16 v[212:213], v243 offset:14336
    v_mfma_f32_16x16x32_bf16 v[16:19], v[164:167], v[132:135], v[16:19]
L_walka_2:
    s_cbranch_execz L_walkeda
    s_nop 0
    ds_read_b64_tr_b16 v[214:215], v243 offset:16128
    v_mfma_f32_16x16x32_bf16 v[20:23], v[168:171], v[128:131], v[20:23]
    ds_read_b64_tr_b16 v[200:201], v242 offset:128
    v_mfma_f32_16x16x32_bf16 v[20:23], v[172:175], v[132:135], v[20:23]
    ds_read_b64_tr_b16 v[202:203], v242 offset:1920
    v_mfma_f32_16x16x32_bf16 v[48:51], v[168:171], v[136:139], v[48:51]
    ds_read_b64_tr_b16 v[204:205], v242 offset:14464
    v_mfma_f32_16x16x32_bf16 v[48:51], v[172:175], v[140:143], v[48:51]
    ds_read_b64_tr_b16 v[206:207], v242 offset:16256
    v_mfma_f32_16x16x32_bf16 v[44:47], v[160:163], v[136:139], v[44:47]
    v_mfma_f32_16x16x32_bf16 v[44:47], v[164:167], v[140:143], v[44:47]
    v_mfma_f32_16x16x32_bf16 v[72:75], v[160:163], v[144:147], v[72:75]
    v_mfma_f32_16x16x32_bf16 v[72:75], v[164:167], v[148:151], v[72:75]
    v_mfma_f32_16x16x32_bf16 v[76:79], v[168:171], v[144:147], v[76:79]
    v_mfma_f32_16x16x32_bf16 v[76:79], v[172:175], v[148:151], v[76:79]
    s_waitcnt lgkmcnt(0)
    v_mfma_f32_16x16x32_bf16 v[104:107], v[168:171], v[152:155], v[104:107]
    v_mfma_f32_16x16x32_bf16 v[104:107], v[172:175], v[156:159], v[104:107]
    v_mfma_f32_16x16x32_bf16 v[100:103], v[160:163], v[152:155], v[100:103]
    s_cmp_lg_u32 s67, 0
    v_mfma_f32_16x16x32_bf16 v[100:103], v[164:167], v[156:159], v[100:103]
    s_waitcnt lgkmcnt(0)
    s_cbranch_scc1 L_loop_21
    s_setprio 1
    s_barrier
    v_mfma_f32_16x16x32_bf16 v[108:111], v[176:179], v[152:155], v[108:111]
    v_mfma_f32_16x16x32_bf16 v[108:111], v[180:183], v[156:159], v[108:111]
    v_mfma_f32_16x16x32_bf16 v[80:83], v[176:179], v[144:147], v[80:83]
    v_mfma_f32_16x16x32_bf16 v[80:83], v[180:183], v[148:151], v[80:83]
    v_mfma_f32_16x16x32_bf16 v[52:55], v[176:179], v[136:139], v[52:55]
    v_mfma_f32_16x16x32_bf16 v[52:55], v[180:183], v[140:143], v[52:55]
    v_mfma_f32_16x16x32_bf16 v[24:27], v[176:179], v[128:131], v[24:27]
    v_mfma_f32_16x16x32_bf16 v[24:27], v[180:183], v[132:135], v[24:27]
    v_mfma_f32_16x16x32_bf16 v[28:31], v[184:187], v[128:131], v[28:31]
    v_mfma_f32_16x16x32_bf16 v[28:31], v[188:191], v[132:135], v[28:31]
    v_mfma_f32_16x16x32_bf16 v[56:59], v[184:187], v[136:139], v[56:59]
    v_mfma_f32_16x16x32_bf16 v[56:59], v[188:191], v[140:143], v[56:59]
    v_mfma_f32_16x16x32_bf16 v[84:87], v[184:187], v[144:147], v[84:87]
    v_mfma_f32_16x16x32_bf16 v[84:87], v[188:191], v[148:151], v[84:87]
    v_mfma_f32_16x16x32_bf16 v[112:115], v[184:187], v[152:155], v[112:115]
    v_mfma_f32_16x16x32_bf16 v[112:115], v[188:191], v[156:159], v[112:115]
    v_mfma_f32_16x16x32_bf16 v[116:119], v[192:195], v[152:155], v[116:119]
    v_mfma_f32_16x16x32_bf16 v[116:119], v[196:199], v[156:159], v[116:119]
    v_mfma_f32_16x16x32_bf16 v[88:91], v[192:195], v[144:147], v[88:91]
    v_mfma_f32_16x16x32_bf16 v[88:91], v[196:199], v[148:151], v[88:91]
    v_mfma_f32_16x16x32_bf16 v[60:63], v[192:195], v[136:139], v[60:63]
    v_mfma_f32_16x16x32_bf16 v[60:63], v[196:199], v[140:143], v[60:63]
    v_mfma_f32_16x16x32_bf16 v[32:35], v[192:195], v[128:131], v[32:35]
    v_mfma_f32_16x16x32_bf16 v[32:35], v[196:199], v[132:135], v[32:35]
    v_mfma_f32_16x16x32_bf16 v[36:39], v[200:203], v[128:131], v[36:39]
    v_mfma_f32_16x16x32_bf16 v[36:39], v[204:207], v[132:135], v[36:39]
    v_mfma_f32_16x16x32_bf16 v[40:43], v[208:211], v[128:131], v[40:43]
    v_mfma_f32_16x16x32_bf16 v[40:43], v[212:215], v[132:135], v[40:43]
    v_mfma_f32_16x16x32_bf16 v[68:71], v[208:211], v[136:139], v[68:71]
    v_mfma_f32_16x16x32_bf16 v[68:71], v[212:215], v[140:143], v[68:71]
    v_mfma_f32_16x16x32_bf16 v[64:67], v[200:203], v[136:139], v[64:67]
    v_mfma_f32_16x16x32_bf16 v[64:67], v[204:207], v[140:143], v[64:67]
    v_mfma_f32_16x16x32_bf16 v[92:95], v[200:203], v[144:147], v[92:95]
    v_mfma_f32_16x16x32_bf16 v[92:95], v[204:207], v[148:151], v[92:95]
    v_mfma_f32_16x16x32_bf16 v[96:99], v[208:211], v[144:147], v[96:99]
    v_mfma_f32_16x16x32_bf16 v[96:99], v[212:215], v[148:151], v[96:99]
    v_mfma_f32_16x16x32_bf16 v[124:127], v[208:211], v[152:155], v[124:127]
    v_mfma_f32_16x16x32_bf16 v[124:127], v[212:215], v[156:159], v[124:127]
    v_mfma_f32_16x16x32_bf16 v[120:123], v[200:203], v[152:155], v[120:123]
    v_mfma_f32_16x16x32_bf16 v[120:123], v[204:207], v[156:159], v[120:123]
    s_mov_b32 s93, 0x3e800000
    s_mul_i32 s91, s5, 144
    s_mul_i32 s92, s6, 7
    s_add_u32 s91, s91, s92
    s_lshl_b32 s91, s91, 13
    s_lshl_b32 s92, s52, 12
    s_add_u32 s91, s91, s92
    v_add_u32_e64 v146, s91, v249
    s_mul_i32 s92, s53, 24576
    v_add_u32 v13, s92, v146
    s_lshl_b32 s92, s53, 9
    s_add_u32 s92, s92, 49152
    s_add_u32 s91, s91, s92
    v_and_b32 v145, 15, v0
    v_lshlrev_b32 v145, 4, v145
    s_cmp_lg_u32 s63, 0
    s_cbranch_scc1 L_noinit_23
    s_mov_b32 s66, 1
    s_atomic_add s66, s[84:85], 0
L_noinit_23:
    s_barrier
    v_and_b32 v146, 16, v0
    v_lshl_add_u32 v145, v146, 6, v145
    v_and_b32_e64 v146, 32, v0
    v_lshl_add_u32 v145, v146, 3, v145
    v_add_u32 v146, s91, v145
    v_mul_f32 v128, s97, v40
    v_mul_f32 v129, s97, v41
    v_mul_f32 v130, s97, v42
    v_mul_f32 v131, s97, v43
    v_mul_f32 v132, s97, v68
    v_mul_f32 v133, s97, v69
    v_mul_f32 v134, s97, v70
    v_mul_f32 v135, s97, v71
    v_exp_f32 v128, v128
    v_exp_f32 v129, v129
    v_exp_f32 v130, v130
    v_exp_f32 v131, v131
    v_exp_f32 v132, v132
    v_exp_f32 v133, v133
    v_exp_f32 v134, v134
    v_exp_f32 v135, v135
    v_add_f32 v128, 0.5, v128
    v_add_f32 v129, 0.5, v129
    v_add_f32 v130, 0.5, v130
    v_add_f32 v131, 0.5, v131
    v_add_f32 v132, 0.5, v132
    v_add_f32 v133, 0.5, v133
    v_add_f32 v134, 0.5, v134
    v_add_f32_e64 v135, 0.5, v135
    v_fma_f32 v136, v128, v128, s93
    v_fma_f32 v137, v129, v129, s93
    v_fma_f32 v138, v130, v130, s93
    v_fma_f32 v139, v131, v131, s93
    v_fma_f32 v140, v132, v132, s93
    v_fma_f32 v141, v133, v133, s93
    v_fma_f32 v142, v134, v134, s93
    v_fma_f32 v143, v135, v135, s93
    v_rcp_f32 v136, v136
    v_rcp_f32 v137, v137
    v_rcp_f32 v138, v138
    v_rcp_f32 v139, v139
    v_rcp_f32 v140, v140
    v_rcp_f32 v141, v141
    v_rcp_f32 v142, v142
    v_rcp_f32 v143, v143
    v_mul_f32 v128, v40, v128
    v_mul_f32 v129, v41, v129
    v_mul_f32 v130, v42, v130
    v_mul_f32 v131, v43, v131
    v_mul_f32 v132, v68, v132
    v_mul_f32 v133, v69, v133
    v_mul_f32 v134, v70, v134
    v_mul_f32 v135, v71, v135
    v_mul_legacy_f32 v128, v128, v136
    v_mul_legacy_f32 v129, v129, v137
    v_mul_legacy_f32 v130, v130, v138
    v_mul_legacy_f32 v131, v131, v139
    v_mul_legacy_f32 v132, v132, v140
    v_mul_legacy_f32 v133, v133, v141
    v_mul_legacy_f32 v134, v134, v142
    v_mul_legacy_f32 v135, v135, v143
    v_cvt_pk_bf16_f32 v40, v128, v129
    v_cvt_pk_bf16_f32 v42, v132, v133
    v_cvt_pk_bf16_f32 v41, v130, v131
    v_cvt_pk_bf16_f32 v43, v134, v135
    v_permlane16_swap_b32 v40, v42
    s_nop 0
    v_permlane16_swap_b32_e64 v41, v43
    buffer_store_dwordx4 v[40:43], v146, s[28:31], 0 offen offset:0 sc1
    v_mul_f32 v128, s97, v96
    s_cmp_lg_u32 s63, 1
    s_cbranch_scc1 L_noinit_24
    s_mov_b32 s66, 1
    s_atomic_add s66, s[84:85], 0
L_noinit_24:
    s_barrier
    v_mul_f32 v129, s97, v97
    v_mul_f32 v130, s97, v98
    v_mul_f32 v131, s97, v99
    v_mul_f32 v132, s97, v124
    v_mul_f32 v133, s97, v125
    v_mul_f32 v134, s97, v126
    v_mul_f32 v135, s97, v127
    v_exp_f32 v128, v128
    v_exp_f32 v129, v129
    v_exp_f32 v130, v130
    v_exp_f32 v131, v131
    v_exp_f32 v132, v132
    v_exp_f32 v133, v133
    v_exp_f32 v134, v134
    v_exp_f32 v135, v135
    v_add_f32 v128, 0.5, v128
    v_add_f32 v129, 0.5, v129
    v_add_f32 v130, 0.5, v130
    v_add_f32 v131, 0.5, v131
    v_add_f32 v132, 0.5, v132
    v_add_f32 v133, 0.5, v133
    v_add_f32 v134, 0.5, v134
    v_add_f32 v135, 0.5, v135
    v_fma_f32 v136, v128, v128, s93
    v_fma_f32 v137, v129, v129, s93
    v_fma_f32 v138, v130, v130, s93
    v_fma_f32 v139, v131, v131, s93
    v_fma_f32 v140, v132, v132, s93
    v_fma_f32 v141, v133, v133, s93
    v_fma_f32 v142, v134, v134, s93
    v_fma_f32 v143, v135, v135, s93
    v_rcp_f32 v136, v136
    v_rcp_f32 v137, v137
    v_rcp_f32 v138, v138
    v_rcp_f32 v139, v139
    v_rcp_f32 v140, v140
    v_rcp_f32 v141, v141
    v_rcp_f32 v142, v142
    v_rcp_f32 v143, v143
    v_mul_f32 v128, v96, v128
    v_mul_f32 v129, v97, v129
    v_mul_f32 v130, v98, v130
    v_mul_f32 v131, v99, v131
    v_mul_f32 v132, v124, v132
    v_mul_f32 v133, v125, v133
    v_mul_f32 v134, v126, v134
    v_mul_f32 v135, v127, v135
    v_mul_legacy_f32 v128, v128, v136
    v_mul_legacy_f32 v129, v129, v137
    v_mul_legacy_f32 v130, v130, v138
    v_mul_legacy_f32 v131, v131, v139
    v_mul_legacy_f32 v132, v132, v140
    v_mul_legacy_f32 v133, v133, v141
    v_mul_legacy_f32 v134, v134, v142
    v_mul_legacy_f32 v135, v135, v143
    v_cvt_pk_bf16_f32 v96, v128, v129
    v_cvt_pk_bf16_f32 v98, v132, v133
    v_cvt_pk_bf16_f32 v97, v130, v131
    v_cvt_pk_bf16_f32 v99, v134, v135
    v_permlane16_swap_b32 v96, v98
    s_nop 0
    v_permlane16_swap_b32_e64 v97, v99
    buffer_store_dwordx4 v[96:99], v146, s[28:31], 0 offen offset:2048 sc1
    v_mul_f32 v128, s97, v32
    v_mul_f32 v129, s97, v33
    v_mul_f32 v130, s97, v34
    v_mul_f32 v131, s97, v35
    v_mul_f32 v132, s97, v36
    v_mul_f32 v133, s97, v37
    v_mul_f32 v134, s97, v38
    s_cmp_lg_u32 s63, 2
    s_cbranch_scc1 L_noinit_25
    s_mov_b32 s66, 1
    s_atomic_add s66, s[84:85], 0
L_noinit_25:
    s_barrier
    v_mul_f32 v135, s97, v39
    v_exp_f32 v128, v128
    v_exp_f32 v129, v129
    v_exp_f32 v130, v130
    v_exp_f32 v131, v131
    v_exp_f32 v132, v132
    v_exp_f32 v133, v133
    v_exp_f32 v134, v134
    v_exp_f32 v135, v135
    v_add_f32 v128, 0.5, v128
    v_add_f32 v129, 0.5, v129
    v_add_f32 v130, 0.5, v130
    v_add_f32 v131, 0.5, v131
    v_add_f32 v132, 0.5, v132
    v_add_f32 v133, 0.5, v133
    v_add_f32 v134, 0.5, v134
    v_add_f32 v135, 0.5, v135
    v_fma_f32 v136, v128, v128, s93
    v_fma_f32 v137, v129, v129, s93
    v_fma_f32 v138, v130, v130, s93
    v_fma_f32 v139, v131, v131, s93
    v_fma_f32 v140, v132, v132, s93
    v_fma_f32 v141, v133, v133, s93
    v_fma_f32 v142, v134, v134, s93
    v_fma_f32 v143, v135, v135, s93
    v_rcp_f32 v136, v136
    v_rcp_f32 v137, v137
    v_rcp_f32 v138, v138
    v_rcp_f32 v139, v139
    v_rcp_f32 v140, v140
    v_rcp_f32 v141, v141
    v_rcp_f32 v142, v142
    v_rcp_f32 v143, v143
    v_mul_f32 v128, v32, v128
    v_mul_f32 v129, v33, v129
    v_mul_f32 v130, v34, v130
    v_mul_f32 v131, v35, v131
    v_mul_f32 v132, v36, v132
    v_mul_f32 v133, v37, v133
    v_mul_f32 v134, v38, v134
    v_mul_f32 v135, v39, v135
    v_mul_legacy_f32 v128, v128, v136
    v_mul_legacy_f32 v129, v129, v137
    v_mul_legacy_f32 v130, v130, v138
    v_mul_legacy_f32 v131, v131, v139
    v_mul_legacy_f32 v132, v132, v140
    v_mul_legacy_f32 v133, v133, v141
    v_mul_legacy_f32 v134, v134, v142
    v_mul_legacy_f32 v135, v135, v143
    v_cvt_pk_bf16_f32 v32, v128, v129
    v_cvt_pk_bf16_f32 v33, v130, v131
    v_cvt_pk_bf16_f32 v34, v132, v133
    v_cvt_pk_bf16_f32 v35, v134, v135
    s_mov_b32 s91, 16384
    buffer_store_dwordx4 v[32:35], v13, s[28:31], s91 offen offset:0 sc1
    v_mul_f32 v128, s97, v60
    v_mul_f32 v129, s97, v61
    v_mul_f32 v130, s97, v62
    v_mul_f32 v131, s97, v63
    v_mul_f32 v132, s97, v64
    v_mul_f32 v133, s97, v65
    v_mul_f32 v134, s97, v66
    v_mul_f32 v135, s97, v67
    v_exp_f32 v128, v128
    v_exp_f32 v129, v129
    v_exp_f32 v130, v130
    v_exp_f32_e64 v131, v131
    s_cmp_lg_u32 s63, 3
    s_cbranch_scc1 L_noinit_26
    s_mov_b32 s66, 1
    s_atomic_add s66, s[84:85], 0
L_noinit_26:
    s_barrier
    v_exp_f32 v132, v132
    v_exp_f32 v133, v133
    v_exp_f32 v134, v134
    v_exp_f32 v135, v135
    v_add_f32 v128, 0.5, v128
    v_add_f32 v129, 0.5, v129
    v_add_f32 v130, 0.5, v130
    v_add_f32 v131, 0.5, v131
    v_add_f32 v132, 0.5, v132
    v_add_f32 v133, 0.5, v133
    v_add_f32 v134, 0.5, v134
    v_add_f32_e64 v135, 0.5, v135
    v_fma_f32 v136, v128, v128, s93
    v_fma_f32 v137, v129, v129, s93
    v_fma_f32 v138, v130, v130, s93
    v_fma_f32 v139, v131, v131, s93
    v_fma_f32 v140, v132, v132, s93
    v_fma_f32 v141, v133, v133, s93
    v_fma_f32 v142, v134, v134, s93
    v_fma_f32 v143, v135, v135, s93
    v_rcp_f32 v136, v136
    v_rcp_f32 v137, v137
    v_rcp_f32 v138, v138
    v_rcp_f32 v139, v139
    v_rcp_f32 v140, v140
    v_rcp_f32 v141, v141
    v_rcp_f32 v142, v142
    v_rcp_f32 v143, v143
    v_mul_f32 v128, v60, v128
    v_mul_f32 v129, v61, v129
    v_mul_f32 v130, v62, v130
    v_mul_f32 v131, v63, v131
    v_mul_f32 v132, v64, v132
    v_mul_f32 v133, v65, v133
    v_mul_f32 v134, v66, v134
    v_mul_f32 v135, v67, v135
    v_mul_legacy_f32 v128, v128, v136
    v_mul_legacy_f32 v129, v129, v137
    v_mul_legacy_f32 v130, v130, v138
    v_mul_legacy_f32 v131, v131, v139
    v_mul_legacy_f32 v132, v132, v140
    v_mul_legacy_f32 v133, v133, v141
    v_mul_legacy_f32 v134, v134, v142
    v_mul_legacy_f32 v135, v135, v143
    v_cvt_pk_bf16_f32 v60, v128, v129
    v_cvt_pk_bf16_f32 v61, v130, v131
    v_cvt_pk_bf16_f32 v62, v132, v133
    v_cvt_pk_bf16_f32 v63, v134, v135
    s_mov_b32 s91, 16384
    buffer_store_dwordx4 v[60:63], v13, s[28:31], s91 offen offset:1024 sc1
    v_mul_f32 v128, s97, v88
    v_mul_f32 v129, s97, v89
    v_mul_f32 v130, s97, v90
    v_mul_f32 v131, s97, v91
    v_mul_f32 v132, s97, v92
    v_mul_f32 v133, s97, v93
    v_mul_f32 v134, s97, v94
    v_mul_f32 v135, s97, v95
    v_exp_f32 v128, v128
    v_exp_f32 v129, v129
    v_exp_f32 v130, v130
    v_exp_f32 v131, v131
    v_exp_f32 v132, v132
    v_exp_f32 v133, v133
    v_exp_f32 v134, v134
    v_exp_f32_e64 v135, v135
    s_cmp_lg_u32 s63, 4
    s_cbranch_scc1 L_noinit_27
    s_mov_b32 s66, 1
    s_atomic_add s66, s[84:85], 0
L_noinit_27:
    s_barrier
    v_add_f32 v128, 0.5, v128
    v_add_f32 v129, 0.5, v129
    v_add_f32 v130, 0.5, v130
    v_add_f32 v131, 0.5, v131
    v_add_f32 v132, 0.5, v132
    v_add_f32 v133, 0.5, v133
    v_add_f32 v134, 0.5, v134
    v_add_f32_e64 v135, 0.5, v135
    v_fma_f32 v136, v128, v128, s93
    v_fma_f32 v137, v129, v129, s93
    v_fma_f32 v138, v130, v130, s93
    v_fma_f32 v139, v131, v131, s93
    v_fma_f32 v140, v132, v132, s93
    v_fma_f32 v141, v133, v133, s93
    v_fma_f32 v142, v134, v134, s93
    v_fma_f32 v143, v135, v135, s93
    v_rcp_f32 v136, v136
    v_rcp_f32 v137, v137
    v_rcp_f32 v138, v138
    v_rcp_f32 v139, v139
    v_rcp_f32 v140, v140
    v_rcp_f32 v141, v141
    v_rcp_f32 v142, v142
    v_rcp_f32 v143, v143
    v_mul_f32 v128, v88, v128
    v_mul_f32 v129, v89, v129
    v_mul_f32 v130, v90, v130
    v_mul_f32 v131, v91, v131
    v_mul_f32 v132, v92, v132
    v_mul_f32 v133, v93, v133
    v_mul_f32 v134, v94, v134
    v_mul_f32 v135, v95, v135
    v_mul_legacy_f32 v128, v128, v136
    v_mul_legacy_f32 v129, v129, v137
    v_mul_legacy_f32 v130, v130, v138
    v_mul_legacy_f32 v131, v131, v139
    v_mul_legacy_f32 v132, v132, v140
    v_mul_legacy_f32 v133, v133, v141
    v_mul_legacy_f32 v134, v134, v142
    v_mul_legacy_f32 v135, v135, v143
    v_cvt_pk_bf16_f32 v88, v128, v129
    v_cvt_pk_bf16_f32 v89, v130, v131
    v_cvt_pk_bf16_f32 v90, v132, v133
    v_cvt_pk_bf16_f32 v91, v134, v135
    s_mov_b32 s91, 16384
    buffer_store_dwordx4 v[88:91], v13, s[28:31], s91 offen offset:2048 sc1
    v_mul_f32 v128, s97, v116
    v_mul_f32 v129, s97, v117
    v_mul_f32 v130, s97, v118
    v_mul_f32 v131, s97, v119
    v_mul_f32 v132, s97, v120
    v_mul_f32 v133, s97, v121
    v_mul_f32 v134, s97, v122
    v_mul_f32 v135, s97, v123
    v_exp_f32 v128, v128
    v_exp_f32 v129, v129
    v_exp_f32 v130, v130
    v_exp_f32 v131, v131
    v_exp_f32 v132, v132
    v_exp_f32 v133, v133
    v_exp_f32 v134, v134
    v_exp_f32 v135, v135
    v_add_f32 v128, 0.5, v128
    v_add_f32 v129, 0.5, v129
    v_add_f32 v130, 0.5, v130
    v_add_f32 v131, 0.5, v131
    v_add_f32 v132, 0.5, v132
    v_add_f32 v133, 0.5, v133
    v_add_f32 v134, 0.5, v134
    v_add_f32_e64 v135, 0.5, v135
    s_barrier
    v_fma_f32 v136, v128, v128, s93
    v_fma_f32 v137, v129, v129, s93
    v_fma_f32 v138, v130, v130, s93
    v_fma_f32 v139, v131, v131, s93
    v_fma_f32 v140, v132, v132, s93
    v_fma_f32 v141, v133, v133, s93
    v_fma_f32 v142, v134, v134, s93
    v_fma_f32 v143, v135, v135, s93
    v_rcp_f32 v136, v136
    v_rcp_f32 v137, v137
    v_rcp_f32 v138, v138
    v_rcp_f32 v139, v139
    v_rcp_f32 v140, v140
    v_rcp_f32 v141, v141
    v_rcp_f32 v142, v142
    v_rcp_f32 v143, v143
    v_mul_f32 v128, v116, v128
    v_mul_f32 v129, v117, v129
    v_mul_f32 v130, v118, v130
    v_mul_f32 v131, v119, v131
    v_mul_f32 v132, v120, v132
    v_mul_f32 v133, v121, v133
    v_mul_f32 v134, v122, v134
    v_mul_f32 v135, v123, v135
    v_mul_legacy_f32 v128, v128, v136
    v_mul_legacy_f32 v129, v129, v137
    v_mul_legacy_f32 v130, v130, v138
    v_mul_legacy_f32 v131, v131, v139
    v_mul_legacy_f32 v132, v132, v140
    v_mul_legacy_f32 v133, v133, v141
    v_mul_legacy_f32 v134, v134, v142
    v_mul_legacy_f32 v135, v135, v143
    v_cvt_pk_bf16_f32 v116, v128, v129
    v_cvt_pk_bf16_f32 v117, v130, v131
    v_cvt_pk_bf16_f32 v118, v132, v133
    v_cvt_pk_bf16_f32 v119, v134, v135
    s_mov_b32 s91, 16384
    buffer_store_dwordx4 v[116:119], v13, s[28:31], s91 offen offset:3072 sc1
    v_mul_f32 v128, s97, v16
    v_mul_f32 v129, s97, v17
    v_mul_f32 v130, s97, v18
    v_mul_f32 v131, s97, v19
    v_mul_f32 v132, s97, v20
    v_mul_f32 v133, s97, v21
    v_mul_f32 v134, s97, v22
    v_mul_f32 v135, s97, v23
    v_exp_f32 v128, v128
    v_exp_f32 v129, v129
    v_exp_f32 v130, v130
    v_exp_f32 v131, v131
    v_exp_f32 v132, v132
    v_exp_f32 v133, v133
    v_exp_f32 v134, v134
    v_exp_f32 v135, v135
    v_add_f32 v128, 0.5, v128
    v_add_f32 v129, 0.5, v129
    v_add_f32 v130, 0.5, v130
    v_add_f32 v131, 0.5, v131
    v_add_f32 v132, 0.5, v132
    v_add_f32 v133, 0.5, v133
    v_add_f32 v134, 0.5, v134
    v_add_f32 v135, 0.5, v135
    v_fma_f32 v136, v128, v128, s93
    v_fma_f32 v137, v129, v129, s93
    v_fma_f32 v138, v130, v130, s93
    v_fma_f32 v139, v131, v131, s93
    v_fma_f32 v140, v132, v132, s93
    v_fma_f32 v141, v133, v133, s93
    v_fma_f32 v142, v134, v134, s93
    v_fma_f32 v143, v135, v135, s93
    s_barrier
    v_rcp_f32 v136, v136
    v_rcp_f32 v137, v137
    v_rcp_f32 v138, v138
    v_rcp_f32 v139, v139
    v_rcp_f32 v140, v140
    v_rcp_f32 v141, v141
    v_rcp_f32 v142, v142
    v_rcp_f32 v143, v143
    v_mul_f32 v128, v16, v128
    v_mul_f32 v129, v17, v129
    v_mul_f32 v130, v18, v130
    v_mul_f32 v131, v19, v131
    v_mul_f32 v132, v20, v132
    v_mul_f32 v133, v21, v133
    v_mul_f32 v134, v22, v134
    v_mul_f32_e64 v135, v23, v135
    v_mul_legacy_f32 v128, v128, v136
    v_mul_legacy_f32 v129, v129, v137
    v_mul_legacy_f32 v130, v130, v138
    v_mul_legacy_f32 v131, v131, v139
    v_mul_legacy_f32 v132, v132, v140
    v_mul_legacy_f32 v133, v133, v141
    v_mul_legacy_f32 v134, v134, v142
    v_mul_legacy_f32 v135, v135, v143
    v_cvt_pk_bf16_f32 v16, v128, v129
    v_cvt_pk_bf16_f32 v17, v130, v131
    v_cvt_pk_bf16_f32 v18, v132, v133
    v_cvt_pk_bf16_f32 v19, v134, v135
    s_mov_b32 s91, 0
    buffer_store_dwordx4 v[16:19], v13, s[28:31], s91 offen offset:0 sc1
    v_mul_f32 v128, s97, v44
    v_mul_f32 v129, s97, v45
    v_mul_f32 v130, s97, v46
    v_mul_f32 v131, s97, v47
    v_mul_f32 v132, s97, v48
    v_mul_f32 v133, s97, v49
    v_mul_f32 v134, s97, v50
    v_mul_f32 v135, s97, v51
    v_exp_f32 v128, v128
    v_exp_f32 v129, v129
    v_exp_f32 v130, v130
    v_exp_f32 v131, v131
    v_exp_f32 v132, v132
    v_exp_f32 v133, v133
    v_exp_f32 v134, v134
    v_exp_f32 v135, v135
    v_add_f32 v128, 0.5, v128
    v_add_f32 v129, 0.5, v129
    v_add_f32 v130, 0.5, v130
    v_add_f32 v131, 0.5, v131
    v_add_f32 v132, 0.5, v132
    v_add_f32 v133, 0.5, v133
    v_add_f32 v134, 0.5, v134
    v_add_f32_e64 v135, 0.5, v135
    v_fma_f32 v136, v128, v128, s93
    v_fma_f32 v137, v129, v129, s93
    v_fma_f32 v138, v130, v130, s93
    v_fma_f32 v139, v131, v131, s93
    v_fma_f32 v140, v132, v132, s93
    v_fma_f32 v141, v133, v133, s93
    v_fma_f32 v142, v134, v134, s93
    v_fma_f32 v143, v135, v135, s93
    v_rcp_f32 v136, v136
    v_rcp_f32 v137, v137
    v_rcp_f32 v138, v138
    v_rcp_f32_e64 v139, v139
    s_waitcnt vmcnt(1)
    s_barrier
    s_cmp_lg_u32 s4, 0
    s_cbranch_scc1 L_w0_31
    s_lshl_b32 s64, s55, 7
    s_add_u32 s64, s64, 27697152
    s_mov_b32 s66, 1
    s_atomic_add s66, s[86:87], s64
L_w0_31:
    v_rcp_f32 v140, v140
    v_rcp_f32 v141, v141
    v_rcp_f32 v142, v142
    v_rcp_f32 v143, v143
    v_mul_f32 v128, v44, v128
    v_mul_f32 v129, v45, v129
    v_mul_f32 v130, v46, v130
    v_mul_f32 v131, v47, v131
    v_mul_f32 v132, v48, v132
    v_mul_f32 v133, v49, v133
    v_mul_f32 v134, v50, v134
    v_mul_f32_e64 v135, v51, v135
    v_mul_legacy_f32 v128, v128, v136
    v_mul_legacy_f32 v129, v129, v137
    v_mul_legacy_f32 v130, v130, v138
    v_mul_legacy_f32 v131, v131, v139
    v_mul_legacy_f32 v132, v132, v140
    v_mul_legacy_f32 v133, v133, v141
    v_mul_legacy_f32 v134, v134, v142
    v_mul_legacy_f32 v135, v135, v143
    v_cvt_pk_bf16_f32 v44, v128, v129
    v_cvt_pk_bf16_f32 v45, v130, v131
    v_cvt_pk_bf16_f32 v46, v132, v133
    v_cvt_pk_bf16_f32 v47, v134, v135
    s_mov_b32 s91, 0
    buffer_store_dwordx4 v[44:47], v13, s[28:31], s91 offen offset:1024 sc1
    v_mul_f32 v128, s97, v72
    v_mul_f32 v129, s97, v73
    v_mul_f32 v130, s97, v74
    v_mul_f32 v131, s97, v75
    v_mul_f32 v132, s97, v76
    v_mul_f32 v133, s97, v77
    v_mul_f32 v134, s97, v78
    v_mul_f32 v135, s97, v79
    v_exp_f32 v128, v128
    v_exp_f32 v129, v129
    v_exp_f32 v130, v130
    v_exp_f32 v131, v131
    v_exp_f32 v132, v132
    v_exp_f32 v133, v133
    v_exp_f32 v134, v134
    v_exp_f32 v135, v135
    v_add_f32 v128, 0.5, v128
    v_add_f32 v129, 0.5, v129
    v_add_f32 v130, 0.5, v130
    v_add_f32 v131, 0.5, v131
    v_add_f32 v132, 0.5, v132
    v_add_f32 v133, 0.5, v133
    v_add_f32 v134, 0.5, v134
    v_add_f32_e64 v135, 0.5, v135
    v_fma_f32 v136, v128, v128, s93
    v_fma_f32 v137, v129, v129, s93
    v_fma_f32 v138, v130, v130, s93
    v_fma_f32 v139, v131, v131, s93
    v_fma_f32 v140, v132, v132, s93
    v_fma_f32 v141, v133, v133, s93
    v_fma_f32 v142, v134, v134, s93
    v_fma_f32 v143, v135, v135, s93
    v_rcp_f32 v136, v136
    v_rcp_f32 v137, v137
    v_rcp_f32 v138, v138
    v_rcp_f32 v139, v139
    v_rcp_f32 v140, v140
    v_rcp_f32 v141, v141
    v_rcp_f32 v142, v142
    v_rcp_f32 v143, v143
    s_barrier
    v_mul_f32 v128, v72, v128
    v_mul_f32 v129, v73, v129
    v_mul_f32 v130, v74, v130
    v_mul_f32 v131, v75, v131
    v_mul_f32 v132, v76, v132
    v_mul_f32 v133, v77, v133
    v_mul_f32 v134, v78, v134
    v_mul_f32_e64 v135, v79, v135
    v_mul_legacy_f32 v128, v128, v136
    v_mul_legacy_f32 v129, v129, v137
    v_mul_legacy_f32 v130, v130, v138
    v_mul_legacy_f32 v131, v131, v139
    v_mul_legacy_f32 v132, v132, v140
    v_mul_legacy_f32 v133, v133, v141
    v_mul_legacy_f32 v134, v134, v142
    v_mul_legacy_f32 v135, v135, v143
    v_cvt_pk_bf16_f32 v72, v128, v129
    v_cvt_pk_bf16_f32 v73, v130, v131
    v_cvt_pk_bf16_f32 v74, v132, v133
    v_cvt_pk_bf16_f32 v75, v134, v135
    s_mov_b32 s91, 0
    buffer_store_dwordx4 v[72:75], v13, s[28:31], s91 offen offset:2048 sc1
    v_mul_f32 v128, s97, v100
    v_mul_f32 v129, s97, v101
    v_mul_f32 v130, s97, v102
    v_mul_f32 v131, s97, v103
    v_mul_f32 v132, s97, v104
    v_mul_f32 v133, s97, v105
    v_mul_f32 v134, s97, v106
    v_mul_f32 v135, s97, v107
    v_exp_f32 v128, v128
    v_exp_f32 v129, v129
    v_exp_f32 v130, v130
    v_exp_f32 v131, v131
    v_exp_f32 v132, v132
    v_exp_f32 v133, v133
    v_exp_f32 v134, v134
    v_exp_f32 v135, v135
    v_add_f32 v128, 0.5, v128
    v_add_f32 v129, 0.5, v129
    v_add_f32 v130, 0.5, v130
    v_add_f32 v131, 0.5, v131
    v_add_f32 v132, 0.5, v132
    v_add_f32 v133, 0.5, v133
    v_add_f32 v134, 0.5, v134
    v_add_f32_e64 v135, 0.5, v135
    v_fma_f32 v136, v128, v128, s93
    v_fma_f32 v137, v129, v129, s93
    v_fma_f32 v138, v130, v130, s93
    v_fma_f32 v139, v131, v131, s93
    v_fma_f32 v140, v132, v132, s93
    v_fma_f32 v141, v133, v133, s93
    v_fma_f32 v142, v134, v134, s93
    v_fma_f32 v143, v135, v135, s93
    v_rcp_f32 v136, v136
    v_rcp_f32 v137, v137
    v_rcp_f32 v138, v138
    v_rcp_f32 v139, v139
    v_rcp_f32 v140, v140
    v_rcp_f32 v141, v141
    v_rcp_f32 v142, v142
    v_rcp_f32 v143, v143
    v_mul_f32 v128, v100, v128
    v_mul_f32 v129, v101, v129
    v_mul_f32 v130, v102, v130
    v_mul_f32 v131, v103, v131
    v_mul_f32 v132, v104, v132
    v_mul_f32 v133, v105, v133
    v_mul_f32 v134, v106, v134
    v_mul_f32_e64 v135, v107, v135
L_walka_3:
    s_cbranch_execz L_walkeda
    s_nop 0
    s_barrier
    v_mul_legacy_f32 v128, v128, v136
    v_mul_legacy_f32 v129, v129, v137
    v_mul_legacy_f32 v130, v130, v138
    v_mul_legacy_f32 v131, v131, v139
    v_mul_legacy_f32 v132, v132, v140
    v_mul_legacy_f32 v133, v133, v141
    v_mul_legacy_f32 v134, v134, v142
    v_mul_legacy_f32 v135, v135, v143
    v_cvt_pk_bf16_f32 v100, v128, v129
    v_cvt_pk_bf16_f32 v101, v130, v131
    v_cvt_pk_bf16_f32 v102, v132, v133
    v_cvt_pk_bf16_f32 v103, v134, v135
    s_mov_b32 s91, 0
    buffer_store_dwordx4 v[100:103], v13, s[28:31], s91 offen offset:3072 sc1
    v_mul_f32 v128, s97, v24
    v_mul_f32 v129, s97, v25
    v_mul_f32 v130, s97, v26
    v_mul_f32 v131, s97, v27
    v_mul_f32 v132, s97, v28
    v_mul_f32 v133, s97, v29
    v_mul_f32 v134, s97, v30
    v_mul_f32 v135, s97, v31
    v_exp_f32 v128, v128
    v_exp_f32 v129, v129
    v_exp_f32 v130, v130
    v_exp_f32 v131, v131
    v_exp_f32 v132, v132
    v_exp_f32 v133, v133
    v_exp_f32 v134, v134
    v_exp_f32 v135, v135
    v_add_f32 v128, 0.5, v128
    v_add_f32 v129, 0.5, v129
    v_add_f32 v130, 0.5, v130
    v_add_f32 v131, 0.5, v131
    v_add_f32 v132, 0.5, v132
    v_add_f32 v133, 0.5, v133
    v_add_f32 v134, 0.5, v134
    v_add_f32_e64 v135, 0.5, v135
    v_fma_f32 v136, v128, v128, s93
    v_fma_f32 v137, v129, v129, s93
    v_fma_f32 v138, v130, v130, s93
    v_fma_f32 v139, v131, v131, s93
    v_fma_f32 v140, v132, v132, s93
    v_fma_f32 v141, v133, v133, s93
    v_fma_f32 v142, v134, v134, s93
    v_fma_f32 v143, v135, v135, s93
    v_rcp_f32 v136, v136
    v_rcp_f32 v137, v137
    v_rcp_f32 v138, v138
    v_rcp_f32 v139, v139
    v_rcp_f32 v140, v140
    v_rcp_f32 v141, v141
    v_rcp_f32 v142, v142
    v_rcp_f32 v143, v143
    v_mul_f32 v128, v24, v128
    v_mul_f32 v129, v25, v129
    v_mul_f32 v130, v26, v130
    v_mul_f32 v131, v27, v131
    v_mul_f32 v132, v28, v132
    v_mul_f32 v133, v29, v133
    v_mul_f32 v134, v30, v134
    v_mul_f32 v135, v31, v135
    v_mul_legacy_f32 v128, v128, v136
    v_mul_legacy_f32 v129, v129, v137
    v_mul_legacy_f32 v130, v130, v138
    v_mul_legacy_f32 v131, v131, v139
    v_mul_legacy_f32 v132, v132, v140
    v_mul_legacy_f32 v133, v133, v141
    v_mul_legacy_f32 v134, v134, v142
    v_mul_legacy_f32 v135, v135, v143
    s_barrier
    v_cvt_pk_bf16_f32 v24, v128, v129
    v_cvt_pk_bf16_f32 v25, v130, v131
    v_cvt_pk_bf16_f32 v26, v132, v133
    v_cvt_pk_bf16_f32 v27, v134, v135
    s_mov_b32 s91, 8192
    buffer_store_dwordx4 v[24:27], v13, s[28:31], s91 offen offset:0 sc1
    v_mul_f32 v128, s97, v52
    v_mul_f32 v129, s97, v53
    v_mul_f32 v130, s97, v54
    v_mul_f32 v131, s97, v55
    v_mul_f32 v132, s97, v56
    v_mul_f32 v133, s97, v57
    v_mul_f32 v134, s97, v58
    v_mul_f32 v135, s97, v59
    v_exp_f32 v128, v128
    v_exp_f32 v129, v129
    v_exp_f32 v130, v130
    v_exp_f32 v131, v131
    v_exp_f32 v132, v132
    v_exp_f32 v133, v133
    v_exp_f32 v134, v134
    v_exp_f32 v135, v135
    v_add_f32 v128, 0.5, v128
    v_add_f32 v129, 0.5, v129
    v_add_f32 v130, 0.5, v130
    v_add_f32 v131, 0.5, v131
    v_add_f32 v132, 0.5, v132
    v_add_f32 v133, 0.5, v133
    v_add_f32 v134, 0.5, v134
    v_add_f32_e64 v135, 0.5, v135
    v_fma_f32 v136, v128, v128, s93
    v_fma_f32 v137, v129, v129, s93
    v_fma_f32 v138, v130, v130, s93
    v_fma_f32 v139, v131, v131, s93
    v_fma_f32 v140, v132, v132, s93
    v_fma_f32 v141, v133, v133, s93
    v_fma_f32 v142, v134, v134, s93
    v_fma_f32 v143, v135, v135, s93
    v_rcp_f32 v136, v136
    v_rcp_f32 v137, v137
    v_rcp_f32 v138, v138
    v_rcp_f32 v139, v139
    v_rcp_f32 v140, v140
    v_rcp_f32 v141, v141
    v_rcp_f32 v142, v142
    v_rcp_f32 v143, v143
    v_mul_f32 v128, v52, v128
    v_mul_f32 v129, v53, v129
    v_mul_f32 v130, v54, v130
    v_mul_f32 v131, v55, v131
    v_mul_f32 v132, v56, v132
    v_mul_f32 v133, v57, v133
    v_mul_f32 v134, v58, v134
    v_mul_f32 v135, v59, v135
    v_mul_legacy_f32 v128, v128, v136
    v_mul_legacy_f32 v129, v129, v137
    v_mul_legacy_f32 v130, v130, v138
    v_mul_legacy_f32 v131, v131, v139
    v_mul_legacy_f32 v132, v132, v140
    v_mul_legacy_f32 v133, v133, v141
    v_mul_legacy_f32 v134, v134, v142
    v_mul_legacy_f32 v135, v135, v143
    v_cvt_pk_bf16_f32 v52, v128, v129
    v_cvt_pk_bf16_f32 v53, v130, v131
    v_cvt_pk_bf16_f32 v54, v132, v133
    v_cvt_pk_bf16_f32 v55, v134, v135
    s_mov_b32 s91, 8192
    buffer_store_dwordx4 v[52:55], v13, s[28:31], s91 offen offset:1024 sc1
    v_mul_f32 v128, s97, v80
    v_mul_f32 v129, s97, v81
    v_mul_f32 v130, s97, v82
    v_mul_f32_e64 v131, s97, v83
    s_waitcnt vmcnt(2)
    s_barrier
    s_cmp_lg_u32 s4, 0
    s_cbranch_scc1 L_w0_22
    s_lshl_b32 s64, s55, 7
    s_add_u32 s64, s64, 27729920
    s_mov_b32 s66, 1
    s_atomic_add s66, s[86:87], s64
L_w0_22:
    s_cmp_lg_u32 s4, 0
    s_cbranch_scc1 L_w0_28
    s_load_dword s74, s[84:85], 0
L_w0_28:
    v_mul_f32 v132, s97, v84
    v_mul_f32 v133, s97, v85
    v_mul_f32 v134, s97, v86
    v_mul_f32 v135, s97, v87
    v_exp_f32 v128, v128
    v_exp_f32 v129, v129
    v_exp_f32 v130, v130
    v_exp_f32 v131, v131
    v_exp_f32 v132, v132
    v_exp_f32 v133, v133
    v_exp_f32 v134, v134
    v_exp_f32 v135, v135
    v_add_f32 v128, 0.5, v128
    v_add_f32 v129, 0.5, v129
    v_add_f32 v130, 0.5, v130
    v_add_f32 v131, 0.5, v131
    v_add_f32 v132, 0.5, v132
    v_add_f32 v133, 0.5, v133
    v_add_f32 v134, 0.5, v134
    v_add_f32_e64 v135, 0.5, v135
    v_fma_f32 v136, v128, v128, s93
    v_fma_f32 v137, v129, v129, s93
    v_fma_f32 v138, v130, v130, s93
    v_fma_f32 v139, v131, v131, s93
    v_fma_f32 v140, v132, v132, s93
    v_fma_f32 v141, v133, v133, s93
    v_fma_f32 v142, v134, v134, s93
    v_fma_f32 v143, v135, v135, s93
    v_rcp_f32 v136, v136
    v_rcp_f32 v137, v137
    v_rcp_f32 v138, v138
    v_rcp_f32 v139, v139
    v_rcp_f32 v140, v140
    v_rcp_f32 v141, v141
    v_rcp_f32 v142, v142
    v_rcp_f32 v143, v143
    v_mul_f32 v128, v80, v128
    v_mul_f32 v129, v81, v129
    v_mul_f32 v130, v82, v130
    v_mul_f32 v131, v83, v131
    v_mul_f32 v132, v84, v132
    v_mul_f32 v133, v85, v133
    v_mul_f32 v134, v86, v134
    v_mul_f32 v135, v87, v135
    v_mul_legacy_f32 v128, v128, v136
    v_mul_legacy_f32 v129, v129, v137
    v_mul_legacy_f32 v130, v130, v138
    v_mul_legacy_f32 v131, v131, v139
    v_mul_legacy_f32 v132, v132, v140
    v_mul_legacy_f32 v133, v133, v141
    v_mul_legacy_f32 v134, v134, v142
    v_mul_legacy_f32 v135, v135, v143
    v_cvt_pk_bf16_f32 v204, v128, v129
    v_cvt_pk_bf16_f32 v205, v130, v131
    v_cvt_pk_bf16_f32 v206, v132, v133
    v_cvt_pk_bf16_f32 v207, v134, v135
    v_mul_f32 v128, s97, v108
    v_mul_f32 v129, s97, v109
    v_mul_f32 v130, s97, v110
    v_mul_f32 v131, s97, v111
    v_mul_f32 v132, s97, v112
    v_mul_f32 v133, s97, v113
    v_mul_f32 v134, s97, v114
    v_mul_f32 v135, s97, v115
    v_exp_f32 v128, v128
    v_exp_f32 v129, v129
    s_cmp_lg_u32 s4, 0
    s_cbranch_scc1 L_ok_29
    s_mov_b32 s94, 0
L_spin_30:
    s_waitcnt lgkmcnt(0)
    s_cmp_ge_u32 s74, 256
    s_cbranch_scc1 L_ok_29
    s_add_u32 s94, s94, 1
    s_cmp_gt_u32 s94, 0x80000
    s_cbranch_scc1 L_ok_29
    s_sleep 24
    s_load_dword s74, s[84:85], 0 glc
    s_branch L_spin_30
L_ok_29:
    s_barrier
    s_and_b32 s64, s55, -8
    s_lshl_b32 s65, s4, 1
    s_add_u32 s64, s64, s65
    s_lshl_b32 s64, s64, 7
    s_add_u32 s64, s64, 27697152
    s_load_dword s74, s[86:87], s64 glc
    s_add_u32 s64, s64, 128
    s_load_dword s75, s[86:87], s64 glc
    s_lshl_b32 s91, s5, 2
    s_lshl_b32 s92, s7, 1
    s_add_u32 s91, s91, s92
    s_add_u32 s91, s91, s52
    s_lshl_b32 s91, s91, 7
    v_and_b32 v1, 31, v0
    v_lshl_add_u32 v1, v1, 2, s91
    v_and_b32 v245, 32, v0
    v_lshlrev_b32 v245, 3, v245
    v_xor_b32_e64 v1, v1, v245
    s_mov_b32 s91, 27688960
    buffer_load_dword v245, v1, s[28:31], s91 offen sc1
    v_exp_f32 v130, v130
    v_exp_f32 v131, v131
    v_exp_f32 v132, v132
    v_exp_f32 v133, v133
    v_exp_f32 v134, v134
    v_exp_f32 v135, v135
    v_add_f32 v128, 0.5, v128
    v_add_f32 v129, 0.5, v129
    v_add_f32 v130, 0.5, v130
    v_add_f32 v131, 0.5, v131
    v_add_f32 v132, 0.5, v132
    v_add_f32 v133, 0.5, v133
    v_add_f32 v134, 0.5, v134
    v_add_f32 v135, 0.5, v135
    v_fma_f32 v136, v128, v128, s93
    v_fma_f32 v137, v129, v129, s93
    v_fma_f32 v138, v130, v130, s93
    v_fma_f32 v139, v131, v131, s93
    v_fma_f32 v140, v132, v132, s93
    v_fma_f32 v141, v133, v133, s93
    v_fma_f32 v142, v134, v134, s93
    v_fma_f32 v143, v135, v135, s93
    v_rcp_f32 v136, v136
    v_rcp_f32 v137, v137
    v_rcp_f32 v138, v138
    v_rcp_f32 v139, v139
    v_rcp_f32 v140, v140
    v_rcp_f32 v141, v141
    v_rcp_f32 v142, v142
    v_rcp_f32 v143, v143
    v_mul_f32 v128, v108, v128
    v_mul_f32 v129, v109, v129
    v_mul_f32 v130, v110, v130
    v_mul_f32 v131, v111, v131
    v_mul_f32 v132, v112, v132
    v_mul_f32 v133, v113, v133
    v_mul_f32 v134, v114, v134
    v_mul_f32 v135, v115, v135
    v_mul_legacy_f32 v128, v128, v136
    v_mul_legacy_f32 v129, v129, v137
    v_mul_legacy_f32 v130, v130, v138
    v_mul_legacy_f32 v131, v131, v139
    v_mul_legacy_f32 v132, v132, v140
    v_mul_legacy_f32 v133, v133, v141
    v_mul_legacy_f32 v134, v134, v142
    v_mul_legacy_f32 v135, v135, v143
    v_cvt_pk_bf16_f32 v208, v128, v129
    v_cvt_pk_bf16_f32 v209, v130, v131
    v_cvt_pk_bf16_f32 v210, v132, v133
    v_cvt_pk_bf16_f32 v211, v134, v135
    s_mov_b32 s94, 0
L_spin_33:
    s_waitcnt lgkmcnt(0)
    s_min_u32 s74, s74, s75
    s_cmp_ge_u32 s74, 1
    s_cbranch_scc1 L_ok_32
    s_add_u32 s94, s94, 1
    s_cmp_gt_u32 s94, 0x80000
    s_cbranch_scc1 L_ok_32
    s_sleep 2
    s_and_b32 s64, s55, -8
    s_lshl_b32 s65, s4, 1
    s_add_u32 s64, s64, s65
    s_lshl_b32 s64, s64, 7
    s_add_u32 s64, s64, 27697152
    s_load_dword s74, s[86:87], s64 glc
    s_add_u32 s64, s64, 128
    s_load_dword s75, s[86:87], s64 glc
    s_branch L_spin_33
L_ok_32:
    s_barrier
    s_mul_i32 s90, s52, 7
    s_add_u32 s90, s90, 6
    s_add_u32 s60, s60, s90
    s_sub_u32 s90, s60, 56
    s_min_u32 s60, s60, s90
    s_lshl_b32 s89, s60, 16
    s_add_u32 m0, s56, 147456
    s_lshl_b32 s88, s60, 13
    buffer_load_dwordx4 v233, s[20:23], s89 offen offset:0 lds
    buffer_load_dwordx4 v234, s[20:23], s89 offen offset:1024 lds
    buffer_load_dwordx4 v235, s[20:23], s89 offen offset:2048 lds
    buffer_load_dwordx4 v236, s[20:23], s89 offen offset:3072 lds
    s_add_u32 m0, s56, 131072
    s_nop 0
    buffer_load_dwordx4 v237, s[28:31], s88 offen offset:0 sc1 lds
    buffer_load_dwordx4 v237, s[28:31], s88 offen offset:1024 sc1 lds
    buffer_load_dwordx4 v237, s[28:31], s88 offen offset:2048 sc1 lds
    buffer_load_dwordx4 v237, s[28:31], s88 offen offset:3072 sc1 lds
    s_mul_i32 s90, s52, 0
    s_add_u32 s90, s90, 14
    s_add_u32 s60, s60, s90
    s_sub_u32 s90, s60, 56
    s_min_u32 s60, s60, s90
    s_lshl_b32 s89, s60, 16
    s_add_u32 m0, s56, 114688
    s_lshl_b32 s88, s60, 13
    buffer_load_dwordx4 v233, s[20:23], s89 offen offset:0 lds
    buffer_load_dwordx4 v234, s[20:23], s89 offen offset:1024 lds
    buffer_load_dwordx4 v235, s[20:23], s89 offen offset:2048 lds
    buffer_load_dwordx4 v236, s[20:23], s89 offen offset:3072 lds
    s_barrier
    s_add_u32 m0, s56, 98304
    s_nop 0
    buffer_load_dwordx4 v237, s[28:31], s88 offen offset:0 sc1 lds
    v_and_b32 v1, 15, v0
    v_lshrrev_b32_e64 v2, 4, v0
    v_bfe_u32 v3, v0, 2, 2
    v_and_b32_e64 v4, 3, v0
    buffer_load_dwordx4 v237, s[28:31], s88 offen offset:1024 sc1 lds
    s_lshl_b32 s92, s7, 1
    s_add_u32 s92, s92, s52
    s_lshl_b32 s92, s92, 11
    v_add_u32 v5, s92, v249
    v_add_u32_e64 v239, 0, v5
    v_xor_b32 v5, 0x1000, v5
    v_add_u32_e64 v240, 0, v5
    buffer_load_dwordx4 v237, s[28:31], s88 offen offset:2048 sc1 lds
    v_lshrrev_b32 v6, 2, v0
    v_lshlrev_b32 v5, 8, v6
    v_lshl_add_u32 v5, v4, 3, v5
    v_add_u32 v5, 16384, v5
    buffer_load_dwordx4 v237, s[28:31], s88 offen offset:3072 sc1 lds
    v_and_b32 v6, 7, v6
    s_lshl_b32 s92, s53, 2
    s_add_u32 s92, s92, 0
    v_xor_b32 v7, s92, v6
    s_mul_i32 s90, s52, 0
    s_add_u32 s90, s90, 14
    s_add_u32 s60, s60, s90
    s_sub_u32 s90, s60, 56
    s_min_u32 s60, s60, s90
    s_lshl_b32 s89, s60, 16
    s_add_u32 m0, s56, 16384
    s_lshl_b32 s88, s60, 13
    buffer_load_dwordx4 v233, s[20:23], s89 offen offset:0 lds
    v_lshl_add_u32 v241, v7, 5, v5
    s_lshl_b32 s92, s53, 2
    s_add_u32 s92, s92, 1
    v_xor_b32 v7, s92, v6
    v_lshl_add_u32 v242, v7, 5, v5
    s_lshl_b32 s92, s53, 2
    s_add_u32 s92, s92, 2
    v_xor_b32_e64 v7, s92, v6
    buffer_load_dwordx4 v234, s[20:23], s89 offen offset:1024 lds
    v_lshl_add_u32 v243, v7, 5, v5
    s_lshl_b32 s92, s53, 2
    s_add_u32 s92, s92, 3
    v_xor_b32_e64 v7, s92, v6
    v_lshl_add_u32 v244, v7, 5, v5
    v_add_u32 v226, 65536, v239
    buffer_load_dwordx4 v235, s[20:23], s89 offen offset:2048 lds
    v_add_u32 v227, 65536, v240
    v_add_u32 v228, 65536, v241
    v_add_u32 v229, 65536, v242
    v_add_u32 v230, 65536, v243
    buffer_load_dwordx4 v236, s[20:23], s89 offen offset:3072 lds
    v_add_u32 v231, 65536, v244
    s_lshl_b32 s92, s7, 1
    s_add_u32 s92, s92, s52
    s_lshl_b32 s92, s92, 11
    v_lshlrev_b32 v5, 4, v1
    s_add_u32 m0, s56, 0
    s_nop 0
    buffer_load_dwordx4 v237, s[28:31], s88 offen offset:0 sc1 lds
    v_and_b32_e64 v6, 1, v2
    v_lshl_add_u32 v5, v6, 3, v5
    v_lshrrev_b32_e64 v6, 1, v2
    v_lshl_add_u32 v5, v6, 8, v5
    buffer_load_dwordx4 v237, s[28:31], s88 offen offset:1024 sc1 lds
    v_add_u32_e64 v198, s92, v5
    v_xor_b32 v199, 0x1000, v198
    v_add_u32 v200, 65536, v198
    v_add_u32 v201, 65536, v199
    buffer_load_dwordx4 v237, s[28:31], s88 offen offset:2048 sc1 lds
    v_add_u32 v192, 131072, v198
    v_add_u32 v193, 131072, v199
    v_add_u32 v194, 131072, v241
    v_add_u32 v195, 131072, v242
    buffer_load_dwordx4 v237, s[28:31], s88 offen offset:3072 sc1 lds
    v_add_u32 v196, 131072, v243
    v_add_u32 v197, 131072, v244
    s_waitcnt vmcnt(24)
    v_sub_f32 v245, 1.0, v245
    v_mov_b32 v246, v245
    s_nop 1
    v_permlane16_swap_b32 v245, v246
    v_mov_b32 v247, v245
    v_mov_b32 v248, v246
    s_nop 0
    v_permlane32_swap_b32 v245, v247
    v_permlane32_swap_b32_e64 v246, v248
    s_waitcnt vmcnt(16) lgkmcnt(0)
    s_setprio 0
    s_barrier
    ds_read_b64 v[128:129], v192 offset:0
    ds_read_b64 v[130:131], v192 offset:512
    ds_read_b64 v[132:133], v192 offset:8192
    ds_read_b64 v[134:135], v192 offset:8704
    ds_read_b64 v[136:137], v192 offset:1024
    ds_read_b64 v[138:139], v192 offset:1536
    ds_read_b64_tr_b16 v[160:161], v194 offset:0
    ds_read_b64_tr_b16 v[162:163], v194 offset:4096
    ds_read_b64_tr_b16 v[164:165], v194 offset:8192
    ds_read_b64_tr_b16 v[166:167], v194 offset:12288
    ds_read_b64_tr_b16 v[168:169], v195 offset:0
    ds_read_b64_tr_b16 v[170:171], v195 offset:4096
    ds_read_b64_tr_b16 v[172:173], v195 offset:8192
    ds_read_b64_tr_b16 v[174:175], v195 offset:12288
    ds_read_b64 v[140:141], v192 offset:9216
    ds_read_b64 v[142:143], v192 offset:9728
    ds_read_b64 v[144:145], v193 offset:0
    ds_read_b64 v[146:147], v193 offset:512
    ds_read_b64 v[148:149], v193 offset:8192
    ds_read_b64 v[150:151], v193 offset:8704
    ds_read_b64 v[152:153], v193 offset:1024
    ds_read_b64 v[154:155], v193 offset:1536
    ds_read_b64 v[156:157], v193 offset:9216
    ds_read_b64 v[158:159], v193 offset:9728
    ds_read_b64_tr_b16 v[176:177], v196 offset:0
    ds_read_b64_tr_b16 v[178:179], v196 offset:4096
    ds_read_b64_tr_b16 v[180:181], v196 offset:8192
    ds_read_b64_tr_b16 v[182:183], v196 offset:12288
    ds_read_b64_tr_b16 v[184:185], v197 offset:0
    ds_read_b64_tr_b16 v[186:187], v197 offset:4096
    ds_read_b64_tr_b16 v[188:189], v197 offset:8192
    ds_read_b64_tr_b16 v[190:191], v197 offset:12288
    s_mul_i32 s90, s52, 0
    s_add_u32 s90, s90, 14
    s_add_u32 s60, s60, s90
    s_sub_u32 s90, s60, 56
    s_min_u32 s60, s60, s90
    s_lshl_b32 s89, s60, 16
    s_add_u32 m0, s56, 49152
    s_lshl_b32 s88, s60, 13
    buffer_load_dwordx4 v233, s[20:23], s89 offen offset:0 lds
    buffer_load_dwordx4 v234, s[20:23], s89 offen offset:1024 lds
    buffer_load_dwordx4 v235, s[20:23], s89 offen offset:2048 lds
    buffer_load_dwordx4 v236, s[20:23], s89 offen offset:3072 lds
    s_add_u32 m0, s56, 32768
    s_nop 0
    buffer_load_dwordx4 v237, s[28:31], s88 offen offset:0 sc1 lds
    s_mov_b32 s91, 8192
    buffer_store_dwordx4 v[204:207], v13, s[28:31], s91 offen offset:2048 sc1
    s_waitcnt lgkmcnt(15)
    v_mfma_f32_16x16x32_bf16 v[16:19], v[160:163], v[128:131], 0
    v_mfma_f32_16x16x32_bf16 v[16:19], v[164:167], v[132:135], v[16:19]
    buffer_load_dwordx4 v237, s[28:31], s88 offen offset:1024 sc1 lds
    v_mfma_f32_16x16x32_bf16 v[20:23], v[168:171], v[128:131], 0
    v_mfma_f32_16x16x32_bf16 v[20:23], v[172:175], v[132:135], v[20:23]
    v_mfma_f32_16x16x32_bf16 v[36:39], v[168:171], v[136:139], 0
    v_mfma_f32_16x16x32_bf16 v[36:39], v[172:175], v[140:143], v[36:39]
    buffer_load_dwordx4 v237, s[28:31], s88 offen offset:2048 sc1 lds
    v_mfma_f32_16x16x32_bf16 v[32:35], v[160:163], v[136:139], 0
    v_mfma_f32_16x16x32_bf16 v[32:35], v[164:167], v[140:143], v[32:35]
    s_waitcnt lgkmcnt(0)
    v_mfma_f32_16x16x32_bf16 v[48:51], v[160:163], v[144:147], 0
    v_mfma_f32_16x16x32_bf16 v[48:51], v[164:167], v[148:151], v[48:51]
    v_mfma_f32_16x16x32_bf16 v[52:55], v[168:171], v[144:147], 0
    v_mfma_f32_16x16x32_bf16 v[52:55], v[172:175], v[148:151], v[52:55]
    buffer_load_dwordx4 v237, s[28:31], s88 offen offset:3072 sc1 lds
    s_mul_i32 s90, s52, -4
    s_add_u32 s90, s90, 10
    v_mfma_f32_16x16x32_bf16 v[68:71], v[168:171], v[152:155], 0
    s_add_u32 s60, s60, s90
    s_sub_u32 s90, s60, 56
    v_mfma_f32_16x16x32_bf16 v[68:71], v[172:175], v[156:159], v[68:71]
    s_min_u32 s60, s60, s90
    s_lshl_b32 s89, s60, 16
    v_mfma_f32_16x16x32_bf16 v[64:67], v[160:163], v[152:155], 0
    s_add_u32 m0, s56, 81920
    s_lshl_b32 s88, s60, 13
    v_mfma_f32_16x16x32_bf16 v[64:67], v[164:167], v[156:159], v[64:67]
    s_waitcnt vmcnt(16) lgkmcnt(0)
    s_barrier
    v_mfma_f32_16x16x32_bf16 v[24:27], v[176:179], v[128:131], 0
    ds_read_b64_tr_b16 v[160:161], v228 offset:32768
    ds_read_b64_tr_b16 v[174:175], v229 offset:45056
    v_mfma_f32_16x16x32_bf16 v[24:27], v[180:183], v[132:135], v[24:27]
    buffer_load_dwordx4 v233, s[20:23], s89 offen offset:0 lds
    v_mfma_f32_16x16x32_bf16 v[28:31], v[184:187], v[128:131], 0
    ds_read_b64_tr_b16 v[162:163], v228 offset:36864
    v_mfma_f32_16x16x32_bf16 v[28:31], v[188:191], v[132:135], v[28:31]
    ds_read_b64 v[128:129], v200 offset:32768
    v_mfma_f32_16x16x32_bf16 v[44:47], v[184:187], v[136:139], 0
    ds_read_b64 v[130:131], v200 offset:33280
    v_mfma_f32_16x16x32_bf16 v[44:47], v[188:191], v[140:143], v[44:47]
    buffer_load_dwordx4 v234, s[20:23], s89 offen offset:1024 lds
    v_mfma_f32_16x16x32_bf16 v[40:43], v[176:179], v[136:139], 0
    ds_read_b64_tr_b16 v[164:165], v228 offset:40960
    ds_read_b64 v[138:139], v200 offset:34304
    v_mfma_f32_16x16x32_bf16 v[40:43], v[180:183], v[140:143], v[40:43]
    ds_read_b64_tr_b16 v[166:167], v228 offset:45056
    ds_read_b64 v[142:143], v200 offset:42496
    v_mfma_f32_16x16x32_bf16 v[56:59], v[176:179], v[144:147], 0
    ds_read_b64 v[132:133], v200 offset:40960
    v_mfma_f32_16x16x32_bf16 v[56:59], v[180:183], v[148:151], v[56:59]
    buffer_load_dwordx4 v235, s[20:23], s89 offen offset:2048 lds
    v_mfma_f32_16x16x32_bf16 v[60:63], v[184:187], v[144:147], 0
    ds_read_b64 v[134:135], v200 offset:41472
    v_mfma_f32_16x16x32_bf16 v[60:63], v[188:191], v[148:151], v[60:63]
    ds_read_b64_tr_b16 v[168:169], v229 offset:32768
    ds_read_b64 v[150:151], v201 offset:41472
    v_mfma_f32_16x16x32_bf16 v[76:79], v[184:187], v[152:155], 0
    ds_read_b64_tr_b16 v[170:171], v229 offset:36864
    v_mfma_f32_16x16x32_bf16 v[76:79], v[188:191], v[156:159], v[76:79]
    buffer_load_dwordx4 v236, s[20:23], s89 offen offset:3072 lds
    v_mfma_f32_16x16x32_bf16 v[72:75], v[176:179], v[152:155], 0
    ds_read_b64_tr_b16 v[172:173], v229 offset:40960
    ds_read_b64_tr_b16 v[190:191], v231 offset:45056
    v_mfma_f32_16x16x32_bf16 v[72:75], v[180:183], v[156:159], v[72:75]
    ds_read_b64 v[136:137], v200 offset:33792
    ds_read_b64 v[158:159], v201 offset:42496
    s_waitcnt lgkmcnt(5)
    v_mfma_f32_16x16x32_bf16 v[16:19], v[160:163], v[128:131], v[16:19]
    ds_read_b64 v[140:141], v200 offset:41984
    ds_read_b64_tr_b16 v[176:177], v230 offset:32768
    s_add_u32 m0, s56, 65536
    v_mfma_f32_16x16x32_bf16 v[16:19], v[164:167], v[132:135], v[16:19]
    buffer_load_dwordx4 v237, s[28:31], s88 offen offset:0 sc1 lds
    s_waitcnt lgkmcnt(6)
    v_mfma_f32_16x16x32_bf16 v[20:23], v[168:171], v[128:131], v[20:23]
    ds_read_b64 v[144:145], v201 offset:32768
    ds_read_b64_tr_b16 v[178:179], v230 offset:36864
    s_waitcnt lgkmcnt(6)
    v_mfma_f32_16x16x32_bf16 v[20:23], v[172:175], v[132:135], v[20:23]
    ds_read_b64 v[146:147], v201 offset:33280
    ds_read_b64_tr_b16 v[180:181], v230 offset:40960
    s_waitcnt lgkmcnt(6)
    v_mfma_f32_16x16x32_bf16 v[36:39], v[168:171], v[136:139], v[36:39]
    ds_read_b64 v[148:149], v201 offset:40960
    ds_read_b64_tr_b16 v[182:183], v230 offset:45056
    s_waitcnt lgkmcnt(6)
    v_mfma_f32_16x16x32_bf16 v[36:39], v[172:175], v[140:143], v[36:39]
    buffer_load_dwordx4 v237, s[28:31], s88 offen offset:1024 sc1 lds
    v_mfma_f32_16x16x32_bf16 v[32:35], v[160:163], v[136:139], v[32:35]
    ds_read_b64 v[152:153], v201 offset:33792
    v_mfma_f32_16x16x32_bf16 v[32:35], v[164:167], v[140:143], v[32:35]
    ds_read_b64 v[154:155], v201 offset:34304
    s_waitcnt lgkmcnt(4)
    v_mfma_f32_16x16x32_bf16 v[48:51], v[160:163], v[144:147], v[48:51]
    ds_read_b64 v[156:157], v201 offset:41984
    s_waitcnt lgkmcnt(3)
    v_mfma_f32_16x16x32_bf16 v[48:51], v[164:167], v[148:151], v[48:51]
    buffer_load_dwordx4 v237, s[28:31], s88 offen offset:2048 sc1 lds
    v_mfma_f32_16x16x32_bf16 v[52:55], v[168:171], v[144:147], v[52:55]
    ds_read_b64_tr_b16 v[184:185], v231 offset:32768
    v_mfma_f32_16x16x32_bf16 v[52:55], v[172:175], v[148:151], v[52:55]
    ds_read_b64_tr_b16 v[186:187], v231 offset:36864
    s_waitcnt lgkmcnt(3)
    v_mfma_f32_16x16x32_bf16 v[68:71], v[168:171], v[152:155], v[68:71]
    ds_read_b64_tr_b16 v[188:189], v231 offset:40960
    s_waitcnt lgkmcnt(3)
    v_mfma_f32_16x16x32_bf16 v[68:71], v[172:175], v[156:159], v[68:71]
    buffer_load_dwordx4 v237, s[28:31], s88 offen offset:3072 sc1 lds
    s_mul_i32 s90, s52, 0
    s_add_u32 s90, s90, 7
    s_add_u32 s60, s60, s90
    s_sub_u32 s90, s60, 56
    v_mfma_f32_16x16x32_bf16 v[64:67], v[160:163], v[152:155], v[64:67]
    s_min_u32 s60, s60, s90
    s_lshl_b32 s89, s60, 16
    s_add_u32 m0, s56, 114688
    s_lshl_b32 s88, s60, 13
    v_mfma_f32_16x16x32_bf16 v[64:67], v[164:167], v[156:159], v[64:67]
    s_waitcnt vmcnt(16) lgkmcnt(0)
    s_barrier
    v_mfma_f32_16x16x32_bf16 v[24:27], v[176:179], v[128:131], v[24:27]
    ds_read_b64_tr_b16 v[160:161], v241 offset:0
    ds_read_b64_tr_b16 v[174:175], v242 offset:12288
    v_mfma_f32_16x16x32_bf16 v[24:27], v[180:183], v[132:135], v[24:27]
    buffer_load_dwordx4 v233, s[20:23], s89 offen offset:0 lds
    v_mfma_f32_16x16x32_bf16 v[28:31], v[184:187], v[128:131], v[28:31]
    ds_read_b64_tr_b16 v[162:163], v241 offset:4096
    v_mfma_f32_16x16x32_bf16 v[28:31], v[188:191], v[132:135], v[28:31]
    ds_read_b64 v[128:129], v198 offset:0
    v_mfma_f32_16x16x32_bf16 v[44:47], v[184:187], v[136:139], v[44:47]
    ds_read_b64 v[130:131], v198 offset:512
    v_mfma_f32_16x16x32_bf16 v[44:47], v[188:191], v[140:143], v[44:47]
    buffer_load_dwordx4 v234, s[20:23], s89 offen offset:1024 lds
    v_mfma_f32_16x16x32_bf16 v[40:43], v[176:179], v[136:139], v[40:43]
    ds_read_b64_tr_b16 v[164:165], v241 offset:8192
    ds_read_b64 v[138:139], v198 offset:1536
    v_mfma_f32_16x16x32_bf16 v[40:43], v[180:183], v[140:143], v[40:43]
    ds_read_b64_tr_b16 v[166:167], v241 offset:12288
    ds_read_b64 v[142:143], v198 offset:9728
    v_mfma_f32_16x16x32_bf16 v[56:59], v[176:179], v[144:147], v[56:59]
    ds_read_b64 v[132:133], v198 offset:8192
    v_mfma_f32_16x16x32_bf16 v[56:59], v[180:183], v[148:151], v[56:59]
    buffer_load_dwordx4 v235, s[20:23], s89 offen offset:2048 lds
    v_mfma_f32_16x16x32_bf16 v[60:63], v[184:187], v[144:147], v[60:63]
    ds_read_b64 v[134:135], v198 offset:8704
    v_mfma_f32_16x16x32_bf16 v[60:63], v[188:191], v[148:151], v[60:63]
    ds_read_b64_tr_b16 v[168:169], v242 offset:0
    ds_read_b64 v[150:151], v199 offset:8704
    v_mfma_f32_16x16x32_bf16 v[76:79], v[184:187], v[152:155], v[76:79]
    ds_read_b64_tr_b16 v[170:171], v242 offset:4096
    v_mfma_f32_16x16x32_bf16 v[76:79], v[188:191], v[156:159], v[76:79]
    buffer_load_dwordx4 v236, s[20:23], s89 offen offset:3072 lds
    v_mfma_f32_16x16x32_bf16 v[72:75], v[176:179], v[152:155], v[72:75]
    ds_read_b64_tr_b16 v[172:173], v242 offset:8192
    ds_read_b64_tr_b16 v[190:191], v244 offset:12288
    v_mfma_f32_16x16x32_bf16 v[72:75], v[180:183], v[156:159], v[72:75]
    ds_read_b64 v[136:137], v198 offset:1024
    ds_read_b64 v[158:159], v199 offset:9728
    s_waitcnt lgkmcnt(5)
    v_mfma_f32_16x16x32_bf16 v[16:19], v[160:163], v[128:131], v[16:19]
    ds_read_b64 v[140:141], v198 offset:9216
    ds_read_b64_tr_b16 v[176:177], v243 offset:0
L_walkb_2:
    s_cbranch_execz L_walkedb
    s_nop 0
    s_add_u32 m0, s56, 98304
    v_mfma_f32_16x16x32_bf16 v[16:19], v[164:167], v[132:135], v[16:19]
    buffer_load_dwordx4 v237, s[28:31], s88 offen offset:0 sc1 lds
    s_waitcnt lgkmcnt(6)
    v_mfma_f32_16x16x32_bf16 v[20:23], v[168:171], v[128:131], v[20:23]
    ds_read_b64 v[144:145], v199 offset:0
    ds_read_b64_tr_b16 v[178:179], v243 offset:4096
    s_waitcnt lgkmcnt(6)
    v_mfma_f32_16x16x32_bf16 v[20:23], v[172:175], v[132:135], v[20:23]
    ds_read_b64 v[146:147], v199 offset:512
    ds_read_b64_tr_b16 v[180:181], v243 offset:8192
    s_waitcnt lgkmcnt(6)
    v_mfma_f32_16x16x32_bf16 v[36:39], v[168:171], v[136:139], v[36:39]
    ds_read_b64 v[148:149], v199 offset:8192
    ds_read_b64_tr_b16 v[182:183], v243 offset:12288
    s_waitcnt lgkmcnt(6)
    v_mfma_f32_16x16x32_bf16 v[36:39], v[172:175], v[140:143], v[36:39]
    buffer_load_dwordx4 v237, s[28:31], s88 offen offset:1024 sc1 lds
    v_mfma_f32_16x16x32_bf16 v[32:35], v[160:163], v[136:139], v[32:35]
    ds_read_b64 v[152:153], v199 offset:1024
    v_mfma_f32_16x16x32_bf16 v[32:35], v[164:167], v[140:143], v[32:35]
    ds_read_b64 v[154:155], v199 offset:1536
    s_waitcnt lgkmcnt(4)
    v_mfma_f32_16x16x32_bf16 v[48:51], v[160:163], v[144:147], v[48:51]
    ds_read_b64 v[156:157], v199 offset:9216
    s_waitcnt lgkmcnt(3)
    v_mfma_f32_16x16x32_bf16 v[48:51], v[164:167], v[148:151], v[48:51]
    buffer_load_dwordx4 v237, s[28:31], s88 offen offset:2048 sc1 lds
    v_mfma_f32_16x16x32_bf16 v[52:55], v[168:171], v[144:147], v[52:55]
    ds_read_b64_tr_b16 v[184:185], v244 offset:0
    v_mfma_f32_16x16x32_bf16 v[52:55], v[172:175], v[148:151], v[52:55]
    ds_read_b64_tr_b16 v[186:187], v244 offset:4096
    s_waitcnt lgkmcnt(3)
    v_mfma_f32_16x16x32_bf16 v[68:71], v[168:171], v[152:155], v[68:71]
    ds_read_b64_tr_b16 v[188:189], v244 offset:8192
    s_waitcnt lgkmcnt(3)
    v_mfma_f32_16x16x32_bf16 v[68:71], v[172:175], v[156:159], v[68:71]
    buffer_load_dwordx4 v237, s[28:31], s88 offen offset:3072 sc1 lds
    s_mul_i32 s90, s52, 0
    s_add_u32 s90, s90, 7
    s_add_u32 s60, s60, s90
    s_sub_u32 s90, s60, 56
    v_mfma_f32_16x16x32_bf16 v[64:67], v[160:163], v[152:155], v[64:67]
    s_min_u32 s60, s60, s90
    s_lshl_b32 s89, s60, 16
    s_add_u32 m0, s56, 16384
    s_lshl_b32 s88, s60, 13
    v_mfma_f32_16x16x32_bf16 v[64:67], v[164:167], v[156:159], v[64:67]
    s_waitcnt vmcnt(16) lgkmcnt(0)
    s_barrier
    v_mfma_f32_16x16x32_bf16 v[24:27], v[176:179], v[128:131], v[24:27]
    ds_read_b64_tr_b16 v[160:161], v241 offset:32768
    ds_read_b64_tr_b16 v[174:175], v242 offset:45056
    v_mfma_f32_16x16x32_bf16 v[24:27], v[180:183], v[132:135], v[24:27]
    buffer_load_dwordx4 v233, s[20:23], s89 offen offset:0 lds
    v_mfma_f32_16x16x32_bf16 v[28:31], v[184:187], v[128:131], v[28:31]
    ds_read_b64_tr_b16 v[162:163], v241 offset:36864
    v_mfma_f32_16x16x32_bf16 v[28:31], v[188:191], v[132:135], v[28:31]
    ds_read_b64 v[128:129], v198 offset:32768
    v_mfma_f32_16x16x32_bf16 v[44:47], v[184:187], v[136:139], v[44:47]
    ds_read_b64 v[130:131], v198 offset:33280
    v_mfma_f32_16x16x32_bf16 v[44:47], v[188:191], v[140:143], v[44:47]
    buffer_load_dwordx4 v234, s[20:23], s89 offen offset:1024 lds
    v_mfma_f32_16x16x32_bf16 v[40:43], v[176:179], v[136:139], v[40:43]
    ds_read_b64_tr_b16 v[164:165], v241 offset:40960
    ds_read_b64 v[138:139], v198 offset:34304
    v_mfma_f32_16x16x32_bf16 v[40:43], v[180:183], v[140:143], v[40:43]
    ds_read_b64_tr_b16 v[166:167], v241 offset:45056
    ds_read_b64 v[142:143], v198 offset:42496
    s_mov_b32 s91, 8192
    buffer_store_dwordx4 v[208:211], v13, s[28:31], s91 offen offset:3072 sc1
    v_mfma_f32_16x16x32_bf16 v[56:59], v[176:179], v[144:147], v[56:59]
    ds_read_b64 v[132:133], v198 offset:40960
    v_mfma_f32_16x16x32_bf16 v[56:59], v[180:183], v[148:151], v[56:59]
    buffer_load_dwordx4 v235, s[20:23], s89 offen offset:2048 lds
    v_mfma_f32_16x16x32_bf16 v[60:63], v[184:187], v[144:147], v[60:63]
    ds_read_b64 v[134:135], v198 offset:41472
    v_mfma_f32_16x16x32_bf16 v[60:63], v[188:191], v[148:151], v[60:63]
    ds_read_b64_tr_b16 v[168:169], v242 offset:32768
    ds_read_b64 v[150:151], v199 offset:41472
    v_mfma_f32_16x16x32_bf16 v[76:79], v[184:187], v[152:155], v[76:79]
    ds_read_b64_tr_b16 v[170:171], v242 offset:36864
    v_mfma_f32_16x16x32_bf16 v[76:79], v[188:191], v[156:159], v[76:79]
    buffer_load_dwordx4 v236, s[20:23], s89 offen offset:3072 lds
    v_mfma_f32_16x16x32_bf16 v[72:75], v[176:179], v[152:155], v[72:75]
    ds_read_b64_tr_b16 v[172:173], v242 offset:40960
    ds_read_b64_tr_b16 v[190:191], v244 offset:45056
    v_mfma_f32_16x16x32_bf16 v[72:75], v[180:183], v[156:159], v[72:75]
    ds_read_b64 v[136:137], v198 offset:33792
    ds_read_b64 v[158:159], v199 offset:42496
    s_waitcnt lgkmcnt(5)
    v_mfma_f32_16x16x32_bf16 v[16:19], v[160:163], v[128:131], v[16:19]
    ds_read_b64 v[140:141], v198 offset:41984
    ds_read_b64_tr_b16 v[176:177], v243 offset:32768
    s_add_u32 m0, s56, 0
    v_mfma_f32_16x16x32_bf16 v[16:19], v[164:167], v[132:135], v[16:19]
    buffer_load_dwordx4 v237, s[28:31], s88 offen offset:0 sc1 lds
    s_waitcnt lgkmcnt(6)
    v_mfma_f32_16x16x32_bf16 v[20:23], v[168:171], v[128:131], v[20:23]
    ds_read_b64 v[144:145], v199 offset:32768
    ds_read_b64_tr_b16 v[178:179], v243 offset:36864
    s_waitcnt lgkmcnt(6)
    v_mfma_f32_16x16x32_bf16 v[20:23], v[172:175], v[132:135], v[20:23]
    ds_read_b64 v[146:147], v199 offset:33280
    ds_read_b64_tr_b16 v[180:181], v243 offset:40960
    s_waitcnt lgkmcnt(6)
    v_mfma_f32_16x16x32_bf16 v[36:39], v[168:171], v[136:139], v[36:39]
    ds_read_b64 v[148:149], v199 offset:40960
    ds_read_b64_tr_b16 v[182:183], v243 offset:45056
    s_waitcnt lgkmcnt(6)
    v_mfma_f32_16x16x32_bf16 v[36:39], v[172:175], v[140:143], v[36:39]
    buffer_load_dwordx4 v237, s[28:31], s88 offen offset:1024 sc1 lds
    v_mfma_f32_16x16x32_bf16 v[32:35], v[160:163], v[136:139], v[32:35]
    ds_read_b64 v[152:153], v199 offset:33792
    v_mfma_f32_16x16x32_bf16 v[32:35], v[164:167], v[140:143], v[32:35]
    ds_read_b64 v[154:155], v199 offset:34304
    s_waitcnt lgkmcnt(4)
    v_mfma_f32_16x16x32_bf16 v[48:51], v[160:163], v[144:147], v[48:51]
    ds_read_b64 v[156:157], v199 offset:41984
    s_waitcnt lgkmcnt(3)
    v_mfma_f32_16x16x32_bf16 v[48:51], v[164:167], v[148:151], v[48:51]
    buffer_load_dwordx4 v237, s[28:31], s88 offen offset:2048 sc1 lds
    v_mfma_f32_16x16x32_bf16 v[52:55], v[168:171], v[144:147], v[52:55]
    ds_read_b64_tr_b16 v[184:185], v244 offset:32768
    v_mfma_f32_16x16x32_bf16 v[52:55], v[172:175], v[148:151], v[52:55]
    ds_read_b64_tr_b16 v[186:187], v244 offset:36864
    s_waitcnt lgkmcnt(3)
    v_mfma_f32_16x16x32_bf16 v[68:71], v[168:171], v[152:155], v[68:71]
    ds_read_b64_tr_b16 v[188:189], v244 offset:40960
    s_waitcnt lgkmcnt(3)
    v_mfma_f32_16x16x32_bf16 v[68:71], v[172:175], v[156:159], v[68:71]
    buffer_load_dwordx4 v237, s[28:31], s88 offen offset:3072 sc1 lds
    s_mul_i32 s72, s52, 0
    s_add_u32 s72, s72, 4294901759
    s_mul_i32 s73, s52, 0
    s_add_u32 s73, s73, 2147482879
    s_and_b32 s90, s72, 7
    s_lshr_b64 s[72:73], s[72:73], 3
    v_mfma_f32_16x16x32_bf16 v[64:67], v[160:163], v[152:155], v[64:67]
    s_add_u32 s60, s60, s90
    s_sub_u32 s90, s60, 56
    s_min_u32 s60, s60, s90
    s_lshl_b32 s89, s60, 16
    s_add_u32 m0, s56, 49152
    s_lshl_b32 s88, s60, 13
    v_mfma_f32_16x16x32_bf16 v[64:67], v[164:167], v[156:159], v[64:67]
    s_waitcnt vmcnt(16) lgkmcnt(0)
    s_barrier
    v_mfma_f32_16x16x32_bf16 v[24:27], v[176:179], v[128:131], v[24:27]
    ds_read_b64_tr_b16 v[160:161], v228 offset:0
    v_mfma_f32_16x16x32_bf16 v[24:27], v[180:183], v[132:135], v[24:27]
    buffer_load_dwordx4 v233, s[20:23], s89 offen offset:0 lds
    v_mfma_f32_16x16x32_bf16 v[28:31], v[184:187], v[128:131], v[28:31]
    ds_read_b64_tr_b16 v[162:163], v228 offset:4096
    v_mfma_f32_16x16x32_bf16 v[28:31], v[188:191], v[132:135], v[28:31]
    ds_read_b128 v[128:131], v226 offset:0
    v_mfma_f32_16x16x32_bf16 v[44:47], v[184:187], v[136:139], v[44:47]
    ds_read_b64_tr_b16 v[164:165], v228 offset:8192
    v_mfma_f32_16x16x32_bf16 v[44:47], v[188:191], v[140:143], v[44:47]
    buffer_load_dwordx4 v234, s[20:23], s89 offen offset:1024 lds
    v_mfma_f32_16x16x32_bf16 v[40:43], v[176:179], v[136:139], v[40:43]
    ds_read_b64_tr_b16 v[166:167], v228 offset:12288
    v_mfma_f32_16x16x32_bf16 v[40:43], v[180:183], v[140:143], v[40:43]
    ds_read_b128 v[132:135], v226 offset:8192
    v_mfma_f32_16x16x32_bf16 v[56:59], v[176:179], v[144:147], v[56:59]
    ds_read_b64_tr_b16 v[168:169], v229 offset:0
    v_mfma_f32_16x16x32_bf16 v[56:59], v[180:183], v[148:151], v[56:59]
    buffer_load_dwordx4 v235, s[20:23], s89 offen offset:2048 lds
    v_mfma_f32_16x16x32_bf16 v[60:63], v[184:187], v[144:147], v[60:63]
    ds_read_b64_tr_b16 v[170:171], v229 offset:4096
    v_mfma_f32_16x16x32_bf16 v[60:63], v[188:191], v[148:151], v[60:63]
    ds_read_b64_tr_b16 v[172:173], v229 offset:8192
    v_mfma_f32_16x16x32_bf16 v[76:79], v[184:187], v[152:155], v[76:79]
    ds_read_b64_tr_b16 v[174:175], v229 offset:12288
    v_mfma_f32_16x16x32_bf16 v[76:79], v[188:191], v[156:159], v[76:79]
    buffer_load_dwordx4 v236, s[20:23], s89 offen offset:3072 lds
    v_mfma_f32_16x16x32_bf16 v[72:75], v[176:179], v[152:155], v[72:75]
    ds_read_b128 v[136:139], v226 offset:1024
    v_mfma_f32_16x16x32_bf16 v[72:75], v[180:183], v[156:159], v[72:75]
    ds_read_b128 v[140:143], v226 offset:9216
    ds_read_b64_tr_b16 v[180:181], v230 offset:8192
    s_waitcnt lgkmcnt(4)
    v_mfma_f32_16x16x32_bf16 v[16:19], v[160:163], v[128:131], v[16:19]
    ds_read_b128 v[144:147], v227 offset:0
    ds_read_b64_tr_b16 v[182:183], v230 offset:12288
    s_add_u32 m0, s56, 32768
    v_mfma_f32_16x16x32_bf16 v[16:19], v[164:167], v[132:135], v[16:19]
    buffer_load_dwordx4 v237, s[28:31], s88 offen offset:0 sc1 lds
    v_mfma_f32_16x16x32_bf16 v[20:23], v[168:171], v[128:131], v[20:23]
    ds_read_b128 v[148:151], v227 offset:8192
    s_waitcnt lgkmcnt(5)
    v_mfma_f32_16x16x32_bf16 v[20:23], v[172:175], v[132:135], v[20:23]
    ds_read_b128 v[152:155], v227 offset:1024
    v_mfma_f32_16x16x32_bf16 v[36:39], v[168:171], v[136:139], v[36:39]
    ds_read_b128 v[156:159], v227 offset:9216
    s_waitcnt lgkmcnt(3)
    v_mfma_f32_16x16x32_bf16 v[36:39], v[172:175], v[140:143], v[36:39]
    buffer_load_dwordx4 v237, s[28:31], s88 offen offset:1024 sc1 lds
    v_mfma_f32_16x16x32_bf16 v[32:35], v[160:163], v[136:139], v[32:35]
    ds_read_b64_tr_b16 v[184:185], v231 offset:0
    v_mfma_f32_16x16x32_bf16 v[32:35], v[164:167], v[140:143], v[32:35]
    ds_read_b64_tr_b16 v[186:187], v231 offset:4096
    v_mfma_f32_16x16x32_bf16 v[48:51], v[160:163], v[144:147], v[48:51]
    ds_read_b64_tr_b16 v[188:189], v231 offset:8192
    s_waitcnt lgkmcnt(3)
    v_mfma_f32_16x16x32_bf16 v[48:51], v[164:167], v[148:151], v[48:51]
    buffer_load_dwordx4 v237, s[28:31], s88 offen offset:2048 sc1 lds
    v_mfma_f32_16x16x32_bf16 v[52:55], v[168:171], v[144:147], v[52:55]
    ds_read_b64_tr_b16 v[190:191], v231 offset:12288
    v_mfma_f32_16x16x32_bf16 v[52:55], v[172:175], v[148:151], v[52:55]
    ds_read_b64_tr_b16 v[176:177], v230 offset:0
    v_mfma_f32_16x16x32_bf16 v[68:71], v[168:171], v[152:155], v[68:71]
    ds_read_b64_tr_b16 v[178:179], v230 offset:4096
    v_mfma_f32_16x16x32_bf16 v[68:71], v[172:175], v[156:159], v[68:71]
    buffer_load_dwordx4 v237, s[28:31], s88 offen offset:3072 sc1 lds
    s_and_b32 s90, s72, 7
    s_lshr_b64 s[72:73], s[72:73], 3
    s_add_u32 s60, s60, s90
    s_sub_u32 s90, s60, 56
    v_mfma_f32_16x16x32_bf16 v[64:67], v[160:163], v[152:155], v[64:67]
    s_min_u32 s60, s60, s90
    s_lshl_b32 s89, s60, 16
    s_add_u32 m0, s56, 81920
    s_lshl_b32 s88, s60, 13
    v_mfma_f32_16x16x32_bf16 v[64:67], v[164:167], v[156:159], v[64:67]
    s_waitcnt vmcnt(16) lgkmcnt(0)
    s_mov_b32 s67, 5
.p2align 3
L_loop_34:
    s_barrier
    v_mfma_f32_16x16x32_bf16 v[24:27], v[176:179], v[128:131], v[24:27]
    ds_read_b64_tr_b16 v[160:161], v228 offset:32768
    v_mfma_f32_16x16x32_bf16 v[24:27], v[180:183], v[132:135], v[24:27]
    buffer_load_dwordx4 v233, s[20:23], s89 offen offset:0 lds
    v_mfma_f32_16x16x32_bf16 v[28:31], v[184:187], v[128:131], v[28:31]
    ds_read_b64_tr_b16 v[162:163], v228 offset:36864
    s_sub_u32 s67, s67, 1
    v_mfma_f32_16x16x32_bf16 v[28:31], v[188:191], v[132:135], v[28:31]
    ds_read_b128 v[128:131], v226 offset:32768
    v_mfma_f32_16x16x32_bf16 v[44:47], v[184:187], v[136:139], v[44:47]
    ds_read_b64_tr_b16 v[164:165], v228 offset:40960
    v_mfma_f32_16x16x32_bf16 v[44:47], v[188:191], v[140:143], v[44:47]
    buffer_load_dwordx4 v234, s[20:23], s89 offen offset:1024 lds
    v_mfma_f32_16x16x32_bf16 v[40:43], v[176:179], v[136:139], v[40:43]
    ds_read_b64_tr_b16 v[166:167], v228 offset:45056
    v_mfma_f32_16x16x32_bf16 v[40:43], v[180:183], v[140:143], v[40:43]
    ds_read_b128 v[132:135], v226 offset:40960
    v_mfma_f32_16x16x32_bf16 v[56:59], v[176:179], v[144:147], v[56:59]
    ds_read_b64_tr_b16 v[168:169], v229 offset:32768
    v_mfma_f32_16x16x32_bf16 v[56:59], v[180:183], v[148:151], v[56:59]
    buffer_load_dwordx4 v235, s[20:23], s89 offen offset:2048 lds
    v_mfma_f32_16x16x32_bf16 v[60:63], v[184:187], v[144:147], v[60:63]
    ds_read_b64_tr_b16 v[170:171], v229 offset:36864
    v_mfma_f32_16x16x32_bf16 v[60:63], v[188:191], v[148:151], v[60:63]
    ds_read_b64_tr_b16 v[172:173], v229 offset:40960
    v_mfma_f32_16x16x32_bf16 v[76:79], v[184:187], v[152:155], v[76:79]
    ds_read_b64_tr_b16 v[174:175], v229 offset:45056
    v_mfma_f32_16x16x32_bf16 v[76:79], v[188:191], v[156:159], v[76:79]
    buffer_load_dwordx4 v236, s[20:23], s89 offen offset:3072 lds
    v_mfma_f32_16x16x32_bf16 v[72:75], v[176:179], v[152:155], v[72:75]
    ds_read_b128 v[136:139], v226 offset:33792
    v_mfma_f32_16x16x32_bf16 v[72:75], v[180:183], v[156:159], v[72:75]
    ds_read_b128 v[140:143], v226 offset:41984
    ds_read_b64_tr_b16 v[180:181], v230 offset:40960
    s_waitcnt lgkmcnt(4)
    v_mfma_f32_16x16x32_bf16 v[16:19], v[160:163], v[128:131], v[16:19]
    ds_read_b128 v[144:147], v227 offset:32768
    ds_read_b64_tr_b16 v[182:183], v230 offset:45056
    s_add_u32 m0, s56, 65536
    v_mfma_f32_16x16x32_bf16 v[16:19], v[164:167], v[132:135], v[16:19]
    buffer_load_dwordx4 v237, s[28:31], s88 offen offset:0 sc1 lds
    v_mfma_f32_16x16x32_bf16 v[20:23], v[168:171], v[128:131], v[20:23]
    ds_read_b128 v[148:151], v227 offset:40960
    s_waitcnt lgkmcnt(5)
    v_mfma_f32_16x16x32_bf16 v[20:23], v[172:175], v[132:135], v[20:23]
    ds_read_b128 v[152:155], v227 offset:33792
    v_mfma_f32_16x16x32_bf16 v[36:39], v[168:171], v[136:139], v[36:39]
    ds_read_b128 v[156:159], v227 offset:41984
    s_waitcnt lgkmcnt(3)
    v_mfma_f32_16x16x32_bf16 v[36:39], v[172:175], v[140:143], v[36:39]
    buffer_load_dwordx4 v237, s[28:31], s88 offen offset:1024 sc1 lds
    v_mfma_f32_16x16x32_bf16 v[32:35], v[160:163], v[136:139], v[32:35]
    ds_read_b64_tr_b16 v[184:185], v231 offset:32768
    v_mfma_f32_16x16x32_bf16 v[32:35], v[164:167], v[140:143], v[32:35]
    ds_read_b64_tr_b16 v[186:187], v231 offset:36864
    v_mfma_f32_16x16x32_bf16 v[48:51], v[160:163], v[144:147], v[48:51]
    ds_read_b64_tr_b16 v[188:189], v231 offset:40960
    s_waitcnt lgkmcnt(3)
    v_mfma_f32_16x16x32_bf16 v[48:51], v[164:167], v[148:151], v[48:51]
    buffer_load_dwordx4 v237, s[28:31], s88 offen offset:2048 sc1 lds
    v_mfma_f32_16x16x32_bf16 v[52:55], v[168:171], v[144:147], v[52:55]
    ds_read_b64_tr_b16 v[190:191], v231 offset:45056
    v_mfma_f32_16x16x32_bf16 v[52:55], v[172:175], v[148:151], v[52:55]
    ds_read_b64_tr_b16 v[176:177], v230 offset:32768
    v_mfma_f32_16x16x32_bf16 v[68:71], v[168:171], v[152:155], v[68:71]
    ds_read_b64_tr_b16 v[178:179], v230 offset:36864
    v_mfma_f32_16x16x32_bf16 v[68:71], v[172:175], v[156:159], v[68:71]
    buffer_load_dwordx4 v237, s[28:31], s88 offen offset:3072 sc1 lds
    s_and_b32 s90, s72, 7
    s_lshr_b64 s[72:73], s[72:73], 3
    s_add_u32 s60, s60, s90
    s_sub_u32 s90, s60, 56
    v_mfma_f32_16x16x32_bf16 v[64:67], v[160:163], v[152:155], v[64:67]
    s_min_u32 s60, s60, s90
    s_lshl_b32 s89, s60, 16
    s_add_u32 m0, s56, 114688
    s_lshl_b32 s88, s60, 13
    v_mfma_f32_16x16x32_bf16 v[64:67], v[164:167], v[156:159], v[64:67]
    s_waitcnt vmcnt(16) lgkmcnt(0)
    s_barrier
    v_mfma_f32_16x16x32_bf16 v[24:27], v[176:179], v[128:131], v[24:27]
    ds_read_b64_tr_b16 v[160:161], v241 offset:0
    v_mfma_f32_16x16x32_bf16 v[24:27], v[180:183], v[132:135], v[24:27]
    buffer_load_dwordx4 v233, s[20:23], s89 offen offset:0 lds
    v_mfma_f32_16x16x32_bf16 v[28:31], v[184:187], v[128:131], v[28:31]
    ds_read_b64_tr_b16 v[162:163], v241 offset:4096
    v_mfma_f32_16x16x32_bf16 v[28:31], v[188:191], v[132:135], v[28:31]
    ds_read_b128 v[128:131], v239 offset:0
    v_mfma_f32_16x16x32_bf16 v[44:47], v[184:187], v[136:139], v[44:47]
    ds_read_b64_tr_b16 v[164:165], v241 offset:8192
    v_mfma_f32_16x16x32_bf16 v[44:47], v[188:191], v[140:143], v[44:47]
    buffer_load_dwordx4 v234, s[20:23], s89 offen offset:1024 lds
    v_mfma_f32_16x16x32_bf16 v[40:43], v[176:179], v[136:139], v[40:43]
    ds_read_b64_tr_b16 v[166:167], v241 offset:12288
    v_mfma_f32_16x16x32_bf16 v[40:43], v[180:183], v[140:143], v[40:43]
    ds_read_b128 v[132:135], v239 offset:8192
    v_mfma_f32_16x16x32_bf16 v[56:59], v[176:179], v[144:147], v[56:59]
    ds_read_b64_tr_b16 v[168:169], v242 offset:0
    v_mfma_f32_16x16x32_bf16 v[56:59], v[180:183], v[148:151], v[56:59]
    buffer_load_dwordx4 v235, s[20:23], s89 offen offset:2048 lds
    v_mfma_f32_16x16x32_bf16 v[60:63], v[184:187], v[144:147], v[60:63]
    ds_read_b64_tr_b16 v[170:171], v242 offset:4096
    v_mfma_f32_16x16x32_bf16 v[60:63], v[188:191], v[148:151], v[60:63]
    ds_read_b64_tr_b16 v[172:173], v242 offset:8192
    v_mfma_f32_16x16x32_bf16 v[76:79], v[184:187], v[152:155], v[76:79]
    ds_read_b64_tr_b16 v[174:175], v242 offset:12288
    v_mfma_f32_16x16x32_bf16 v[76:79], v[188:191], v[156:159], v[76:79]
    buffer_load_dwordx4 v236, s[20:23], s89 offen offset:3072 lds
    v_mfma_f32_16x16x32_bf16 v[72:75], v[176:179], v[152:155], v[72:75]
    ds_read_b128 v[136:139], v239 offset:1024
    v_mfma_f32_16x16x32_bf16 v[72:75], v[180:183], v[156:159], v[72:75]
    ds_read_b128 v[140:143], v239 offset:9216
    ds_read_b64_tr_b16 v[180:181], v243 offset:8192
    s_waitcnt lgkmcnt(4)
    v_mfma_f32_16x16x32_bf16 v[16:19], v[160:163], v[128:131], v[16:19]
    ds_read_b128 v[144:147], v240 offset:0
    ds_read_b64_tr_b16 v[182:183], v243 offset:12288
    s_add_u32 m0, s56, 98304
    v_mfma_f32_16x16x32_bf16 v[16:19], v[164:167], v[132:135], v[16:19]
    buffer_load_dwordx4 v237, s[28:31], s88 offen offset:0 sc1 lds
    v_mfma_f32_16x16x32_bf16 v[20:23], v[168:171], v[128:131], v[20:23]
    ds_read_b128 v[148:151], v240 offset:8192
    s_waitcnt lgkmcnt(5)
    v_mfma_f32_16x16x32_bf16 v[20:23], v[172:175], v[132:135], v[20:23]
    ds_read_b128 v[152:155], v240 offset:1024
    v_mfma_f32_16x16x32_bf16 v[36:39], v[168:171], v[136:139], v[36:39]
    ds_read_b128 v[156:159], v240 offset:9216
    s_waitcnt lgkmcnt(3)
    v_mfma_f32_16x16x32_bf16 v[36:39], v[172:175], v[140:143], v[36:39]
    buffer_load_dwordx4 v237, s[28:31], s88 offen offset:1024 sc1 lds
    v_mfma_f32_16x16x32_bf16 v[32:35], v[160:163], v[136:139], v[32:35]
    ds_read_b64_tr_b16 v[184:185], v244 offset:0
    v_mfma_f32_16x16x32_bf16 v[32:35], v[164:167], v[140:143], v[32:35]
    ds_read_b64_tr_b16 v[186:187], v244 offset:4096
    v_mfma_f32_16x16x32_bf16 v[48:51], v[160:163], v[144:147], v[48:51]
    ds_read_b64_tr_b16 v[188:189], v244 offset:8192
    s_waitcnt lgkmcnt(3)
    v_mfma_f32_16x16x32_bf16 v[48:51], v[164:167], v[148:151], v[48:51]
    buffer_load_dwordx4 v237, s[28:31], s88 offen offset:2048 sc1 lds
    v_mfma_f32_16x16x32_bf16 v[52:55], v[168:171], v[144:147], v[52:55]
    ds_read_b64_tr_b16 v[190:191], v244 offset:12288
    v_mfma_f32_16x16x32_bf16 v[52:55], v[172:175], v[148:151], v[52:55]
    ds_read_b64_tr_b16 v[176:177], v243 offset:0
    v_mfma_f32_16x16x32_bf16 v[68:71], v[168:171], v[152:155], v[68:71]
    ds_read_b64_tr_b16 v[178:179], v243 offset:4096
    v_mfma_f32_16x16x32_bf16 v[68:71], v[172:175], v[156:159], v[68:71]
    buffer_load_dwordx4 v237, s[28:31], s88 offen offset:3072 sc1 lds
    s_and_b32 s90, s72, 7
    s_lshr_b64 s[72:73], s[72:73], 3
    s_add_u32 s60, s60, s90
    s_sub_u32 s90, s60, 56
    v_mfma_f32_16x16x32_bf16 v[64:67], v[160:163], v[152:155], v[64:67]
    s_min_u32 s60, s60, s90
    s_lshl_b32 s89, s60, 16
    s_add_u32 m0, s56, 16384
    s_lshl_b32 s88, s60, 13
    v_mfma_f32_16x16x32_bf16 v[64:67], v[164:167], v[156:159], v[64:67]
    s_waitcnt vmcnt(16) lgkmcnt(0)
    s_barrier
    v_mfma_f32_16x16x32_bf16 v[24:27], v[176:179], v[128:131], v[24:27]
    ds_read_b64_tr_b16 v[160:161], v241 offset:32768
    v_mfma_f32_16x16x32_bf16 v[24:27], v[180:183], v[132:135], v[24:27]
    buffer_load_dwordx4 v233, s[20:23], s89 offen offset:0 lds
    v_mfma_f32_16x16x32_bf16 v[28:31], v[184:187], v[128:131], v[28:31]
    ds_read_b64_tr_b16 v[162:163], v241 offset:36864
    v_mfma_f32_16x16x32_bf16 v[28:31], v[188:191], v[132:135], v[28:31]
    ds_read_b128 v[128:131], v239 offset:32768
    v_mfma_f32_16x16x32_bf16 v[44:47], v[184:187], v[136:139], v[44:47]
    ds_read_b64_tr_b16 v[164:165], v241 offset:40960
    v_mfma_f32_16x16x32_bf16 v[44:47], v[188:191], v[140:143], v[44:47]
    buffer_load_dwordx4 v234, s[20:23], s89 offen offset:1024 lds
    v_mfma_f32_16x16x32_bf16 v[40:43], v[176:179], v[136:139], v[40:43]
    ds_read_b64_tr_b16 v[166:167], v241 offset:45056
    v_mfma_f32_16x16x32_bf16 v[40:43], v[180:183], v[140:143], v[40:43]
    ds_read_b128 v[132:135], v239 offset:40960
    v_mfma_f32_16x16x32_bf16 v[56:59], v[176:179], v[144:147], v[56:59]
    ds_read_b64_tr_b16 v[168:169], v242 offset:32768
    v_mfma_f32_16x16x32_bf16 v[56:59], v[180:183], v[148:151], v[56:59]
    buffer_load_dwordx4 v235, s[20:23], s89 offen offset:2048 lds
    v_mfma_f32_16x16x32_bf16 v[60:63], v[184:187], v[144:147], v[60:63]
    ds_read_b64_tr_b16 v[170:171], v242 offset:36864
    v_mfma_f32_16x16x32_bf16 v[60:63], v[188:191], v[148:151], v[60:63]
    ds_read_b64_tr_b16 v[172:173], v242 offset:40960
    v_mfma_f32_16x16x32_bf16 v[76:79], v[184:187], v[152:155], v[76:79]
    ds_read_b64_tr_b16 v[174:175], v242 offset:45056
    v_mfma_f32_16x16x32_bf16 v[76:79], v[188:191], v[156:159], v[76:79]
    buffer_load_dwordx4 v236, s[20:23], s89 offen offset:3072 lds
    v_mfma_f32_16x16x32_bf16 v[72:75], v[176:179], v[152:155], v[72:75]
    ds_read_b128 v[136:139], v239 offset:33792
    v_mfma_f32_16x16x32_bf16 v[72:75], v[180:183], v[156:159], v[72:75]
    ds_read_b128 v[140:143], v239 offset:41984
    ds_read_b64_tr_b16 v[180:181], v243 offset:40960
    s_waitcnt lgkmcnt(4)
    v_mfma_f32_16x16x32_bf16 v[16:19], v[160:163], v[128:131], v[16:19]
    ds_read_b128 v[144:147], v240 offset:32768
    ds_read_b64_tr_b16 v[182:183], v243 offset:45056
    s_add_u32 m0, s56, 0
    v_mfma_f32_16x16x32_bf16 v[16:19], v[164:167], v[132:135], v[16:19]
    buffer_load_dwordx4 v237, s[28:31], s88 offen offset:0 sc1 lds
    v_mfma_f32_16x16x32_bf16 v[20:23], v[168:171], v[128:131], v[20:23]
    ds_read_b128 v[148:151], v240 offset:40960
    s_waitcnt lgkmcnt(5)
    v_mfma_f32_16x16x32_bf16 v[20:23], v[172:175], v[132:135], v[20:23]
    ds_read_b128 v[152:155], v240 offset:33792
    v_mfma_f32_16x16x32_bf16 v[36:39], v[168:171], v[136:139], v[36:39]
    ds_read_b128 v[156:159], v240 offset:41984
    s_waitcnt lgkmcnt(3)
    v_mfma_f32_16x16x32_bf16 v[36:39], v[172:175], v[140:143], v[36:39]
    buffer_load_dwordx4 v237, s[28:31], s88 offen offset:1024 sc1 lds
    v_mfma_f32_16x16x32_bf16 v[32:35], v[160:163], v[136:139], v[32:35]
    ds_read_b64_tr_b16 v[184:185], v244 offset:32768
    v_mfma_f32_16x16x32_bf16 v[32:35], v[164:167], v[140:143], v[32:35]
    ds_read_b64_tr_b16 v[186:187], v244 offset:36864
    v_mfma_f32_16x16x32_bf16 v[48:51], v[160:163], v[144:147], v[48:51]
    ds_read_b64_tr_b16 v[188:189], v244 offset:40960
    s_waitcnt lgkmcnt(3)
    v_mfma_f32_16x16x32_bf16 v[48:51], v[164:167], v[148:151], v[48:51]
    buffer_load_dwordx4 v237, s[28:31], s88 offen offset:2048 sc1 lds
    v_mfma_f32_16x16x32_bf16 v[52:55], v[168:171], v[144:147], v[52:55]
    ds_read_b64_tr_b16 v[190:191], v244 offset:45056
    v_mfma_f32_16x16x32_bf16 v[52:55], v[172:175], v[148:151], v[52:55]
    ds_read_b64_tr_b16 v[176:177], v243 offset:32768
    v_mfma_f32_16x16x32_bf16 v[68:71], v[168:171], v[152:155], v[68:71]
    ds_read_b64_tr_b16 v[178:179], v243 offset:36864
    v_mfma_f32_16x16x32_bf16 v[68:71], v[172:175], v[156:159], v[68:71]
    buffer_load_dwordx4 v237, s[28:31], s88 offen offset:3072 sc1 lds
    s_and_b32 s90, s72, 7
    s_lshr_b64 s[72:73], s[72:73], 3
    s_add_u32 s60, s60, s90
    s_sub_u32 s90, s60, 56
    v_mfma_f32_16x16x32_bf16 v[64:67], v[160:163], v[152:155], v[64:67]
    s_min_u32 s60, s60, s90
    s_lshl_b32 s89, s60, 16
    s_add_u32 m0, s56, 49152
    s_lshl_b32 s88, s60, 13
    v_mfma_f32_16x16x32_bf16 v[64:67], v[164:167], v[156:159], v[64:67]
    s_waitcnt vmcnt(16) lgkmcnt(0)
    s_barrier
    v_mfma_f32_16x16x32_bf16 v[24:27], v[176:179], v[128:131], v[24:27]
    ds_read_b64_tr_b16 v[160:161], v228 offset:0
    v_mfma_f32_16x16x32_bf16 v[24:27], v[180:183], v[132:135], v[24:27]
    buffer_load_dwordx4 v233, s[20:23], s89 offen offset:0 lds
    v_mfma_f32_16x16x32_bf16 v[28:31], v[184:187], v[128:131], v[28:31]
    ds_read_b64_tr_b16 v[162:163], v228 offset:4096
    v_mfma_f32_16x16x32_bf16 v[28:31], v[188:191], v[132:135], v[28:31]
    ds_read_b128 v[128:131], v226 offset:0
    v_mfma_f32_16x16x32_bf16 v[44:47], v[184:187], v[136:139], v[44:47]
    ds_read_b64_tr_b16 v[164:165], v228 offset:8192
    v_mfma_f32_16x16x32_bf16 v[44:47], v[188:191], v[140:143], v[44:47]
    buffer_load_dwordx4 v234, s[20:23], s89 offen offset:1024 lds
    v_mfma_f32_16x16x32_bf16 v[40:43], v[176:179], v[136:139], v[40:43]
    ds_read_b64_tr_b16 v[166:167], v228 offset:12288
    v_mfma_f32_16x16x32_bf16 v[40:43], v[180:183], v[140:143], v[40:43]
    ds_read_b128 v[132:135], v226 offset:8192
    v_mfma_f32_16x16x32_bf16 v[56:59], v[176:179], v[144:147], v[56:59]
    ds_read_b64_tr_b16 v[168:169], v229 offset:0
    v_mfma_f32_16x16x32_bf16 v[56:59], v[180:183], v[148:151], v[56:59]
    buffer_load_dwordx4 v235, s[20:23], s89 offen offset:2048 lds
    v_mfma_f32_16x16x32_bf16 v[60:63], v[184:187], v[144:147], v[60:63]
    ds_read_b64_tr_b16 v[170:171], v229 offset:4096
    v_mfma_f32_16x16x32_bf16 v[60:63], v[188:191], v[148:151], v[60:63]
    ds_read_b64_tr_b16 v[172:173], v229 offset:8192
    v_mfma_f32_16x16x32_bf16 v[76:79], v[184:187], v[152:155], v[76:79]
    ds_read_b64_tr_b16 v[174:175], v229 offset:12288
    v_mfma_f32_16x16x32_bf16 v[76:79], v[188:191], v[156:159], v[76:79]
    buffer_load_dwordx4 v236, s[20:23], s89 offen offset:3072 lds
    v_mfma_f32_16x16x32_bf16 v[72:75], v[176:179], v[152:155], v[72:75]
    ds_read_b128 v[136:139], v226 offset:1024
    v_mfma_f32_16x16x32_bf16 v[72:75], v[180:183], v[156:159], v[72:75]
    ds_read_b128 v[140:143], v226 offset:9216
    ds_read_b64_tr_b16 v[180:181], v230 offset:8192
    s_waitcnt lgkmcnt(4)
    v_mfma_f32_16x16x32_bf16 v[16:19], v[160:163], v[128:131], v[16:19]
    ds_read_b128 v[144:147], v227 offset:0
    ds_read_b64_tr_b16 v[182:183], v230 offset:12288
    s_add_u32 m0, s56, 32768
    v_mfma_f32_16x16x32_bf16 v[16:19], v[164:167], v[132:135], v[16:19]
    buffer_load_dwordx4 v237, s[28:31], s88 offen offset:0 sc1 lds
    v_mfma_f32_16x16x32_bf16 v[20:23], v[168:171], v[128:131], v[20:23]
    ds_read_b128 v[148:151], v227 offset:8192
    s_waitcnt lgkmcnt(5)
    v_mfma_f32_16x16x32_bf16 v[20:23], v[172:175], v[132:135], v[20:23]
    ds_read_b128 v[152:155], v227 offset:1024
    v_mfma_f32_16x16x32_bf16 v[36:39], v[168:171], v[136:139], v[36:39]
    ds_read_b128 v[156:159], v227 offset:9216
    s_waitcnt lgkmcnt(3)
    v_mfma_f32_16x16x32_bf16 v[36:39], v[172:175], v[140:143], v[36:39]
    buffer_load_dwordx4 v237, s[28:31], s88 offen offset:1024 sc1 lds
    v_mfma_f32_16x16x32_bf16 v[32:35], v[160:163], v[136:139], v[32:35]
    ds_read_b64_tr_b16 v[184:185], v231 offset:0
    v_mfma_f32_16x16x32_bf16 v[32:35], v[164:167], v[140:143], v[32:35]
    ds_read_b64_tr_b16 v[186:187], v231 offset:4096
    v_mfma_f32_16x16x32_bf16 v[48:51], v[160:163], v[144:147], v[48:51]
    ds_read_b64_tr_b16 v[188:189], v231 offset:8192
    s_waitcnt lgkmcnt(3)
    v_mfma_f32_16x16x32_bf16 v[48:51], v[164:167], v[148:151], v[48:51]
    buffer_load_dwordx4 v237, s[28:31], s88 offen offset:2048 sc1 lds
    v_mfma_f32_16x16x32_bf16 v[52:55], v[168:171], v[144:147], v[52:55]
    ds_read_b64_tr_b16 v[190:191], v231 offset:12288
    v_mfma_f32_16x16x32_bf16 v[52:55], v[172:175], v[148:151], v[52:55]
    ds_read_b64_tr_b16 v[176:177], v230 offset:0
    v_mfma_f32_16x16x32_bf16 v[68:71], v[168:171], v[152:155], v[68:71]
    ds_read_b64_tr_b16 v[178:179], v230 offset:4096
    v_mfma_f32_16x16x32_bf16 v[68:71], v[172:175], v[156:159], v[68:71]
    buffer_load_dwordx4 v237, s[28:31], s88 offen offset:3072 sc1 lds
    s_and_b32 s90, s72, 7
    s_lshr_b64 s[72:73], s[72:73], 3
    s_add_u32 s60, s60, s90
    s_sub_u32 s90, s60, 56
    v_mfma_f32_16x16x32_bf16 v[64:67], v[160:163], v[152:155], v[64:67]
    s_min_u32 s60, s60, s90
    s_lshl_b32 s89, s60, 16
    s_add_u32 m0, s56, 81920
    s_lshl_b32 s88, s60, 13
    s_cmp_lg_u32 s67, 0
    v_mfma_f32_16x16x32_bf16 v[64:67], v[164:167], v[156:159], v[64:67]
    s_waitcnt vmcnt(16) lgkmcnt(0)
    s_cbranch_scc1 L_loop_34
    s_barrier
    v_mfma_f32_16x16x32_bf16 v[24:27], v[176:179], v[128:131], v[24:27]
    ds_read_b64_tr_b16 v[160:161], v228 offset:32768
    v_mfma_f32_16x16x32_bf16 v[24:27], v[180:183], v[132:135], v[24:27]
    ds_read_b64_tr_b16 v[162:163], v228 offset:36864
    v_mfma_f32_16x16x32_bf16 v[28:31], v[184:187], v[128:131], v[28:31]
    ds_read_b128 v[128:131], v226 offset:32768
    v_mfma_f32_16x16x32_bf16 v[28:31], v[188:191], v[132:135], v[28:31]
    ds_read_b64_tr_b16 v[164:165], v228 offset:40960
    v_mfma_f32_16x16x32_bf16 v[44:47], v[184:187], v[136:139], v[44:47]
    ds_read_b64_tr_b16 v[166:167], v228 offset:45056
    v_mfma_f32_16x16x32_bf16 v[44:47], v[188:191], v[140:143], v[44:47]
    ds_read_b128 v[132:135], v226 offset:40960
    v_mfma_f32_16x16x32_bf16 v[40:43], v[176:179], v[136:139], v[40:43]
    ds_read_b64_tr_b16 v[168:169], v229 offset:32768
    v_mfma_f32_16x16x32_bf16 v[40:43], v[180:183], v[140:143], v[40:43]
    ds_read_b64_tr_b16 v[170:171], v229 offset:36864
    v_mfma_f32_16x16x32_bf16 v[56:59], v[176:179], v[144:147], v[56:59]
    ds_read_b64_tr_b16 v[172:173], v229 offset:40960
L_walkb_3:
    s_cbranch_execz L_walkedb
    s_nop 0
    v_mfma_f32_16x16x32_bf16 v[56:59], v[180:183], v[148:151], v[56:59]
    ds_read_b64_tr_b16 v[174:175], v229 offset:45056
    v_mfma_f32_16x16x32_bf16 v[60:63], v[184:187], v[144:147], v[60:63]
    ds_read_b128 v[136:139], v226 offset:33792
    v_mfma_f32_16x16x32_bf16 v[60:63], v[188:191], v[148:151], v[60:63]
    ds_read_b128 v[140:143], v226 offset:41984
    v_mfma_f32_16x16x32_bf16 v[76:79], v[184:187], v[152:155], v[76:79]
    ds_read_b128 v[144:147], v227 offset:32768
    v_mfma_f32_16x16x32_bf16 v[76:79], v[188:191], v[156:159], v[76:79]
    ds_read_b128 v[148:151], v227 offset:40960
    v_mfma_f32_16x16x32_bf16 v[72:75], v[176:179], v[152:155], v[72:75]
    ds_read_b128 v[152:155], v227 offset:33792
    v_mfma_f32_16x16x32_bf16 v[72:75], v[180:183], v[156:159], v[72:75]
    ds_read_b128 v[156:159], v227 offset:41984
    s_waitcnt lgkmcnt(4)
    v_mfma_f32_16x16x32_bf16 v[16:19], v[160:163], v[128:131], v[16:19]
    ds_read_b64_tr_b16 v[184:185], v231 offset:32768
    v_mfma_f32_16x16x32_bf16 v[16:19], v[164:167], v[132:135], v[16:19]
    ds_read_b64_tr_b16 v[186:187], v231 offset:36864
    v_mfma_f32_16x16x32_bf16 v[20:23], v[168:171], v[128:131], v[20:23]
    ds_read_b64_tr_b16 v[188:189], v231 offset:40960
    v_mfma_f32_16x16x32_bf16 v[20:23], v[172:175], v[132:135], v[20:23]
    ds_read_b64_tr_b16 v[190:191], v231 offset:45056
    v_mfma_f32_16x16x32_bf16 v[36:39], v[168:171], v[136:139], v[36:39]
    ds_read_b64_tr_b16 v[176:177], v230 offset:32768
    v_mfma_f32_16x16x32_bf16 v[36:39], v[172:175], v[140:143], v[36:39]
    ds_read_b64_tr_b16 v[178:179], v230 offset:36864
    v_mfma_f32_16x16x32_bf16 v[32:35], v[160:163], v[136:139], v[32:35]
    ds_read_b64_tr_b16 v[180:181], v230 offset:40960
    v_mfma_f32_16x16x32_bf16 v[32:35], v[164:167], v[140:143], v[32:35]
    ds_read_b64_tr_b16 v[182:183], v230 offset:45056
    s_waitcnt lgkmcnt(4)
    v_mfma_f32_16x16x32_bf16 v[48:51], v[160:163], v[144:147], v[48:51]
    v_mfma_f32_16x16x32_bf16 v[48:51], v[164:167], v[148:151], v[48:51]
    v_mfma_f32_16x16x32_bf16 v[52:55], v[168:171], v[144:147], v[52:55]
    v_mfma_f32_16x16x32_bf16 v[52:55], v[172:175], v[148:151], v[52:55]
    v_mfma_f32_16x16x32_bf16 v[68:71], v[168:171], v[152:155], v[68:71]
    v_mfma_f32_16x16x32_bf16 v[68:71], v[172:175], v[156:159], v[68:71]
    v_mfma_f32_16x16x32_bf16 v[64:67], v[160:163], v[152:155], v[64:67]
    v_mfma_f32_16x16x32_bf16 v[64:67], v[164:167], v[156:159], v[64:67]
    s_waitcnt vmcnt(8) lgkmcnt(0)
    s_barrier
    v_mfma_f32_16x16x32_bf16 v[24:27], v[176:179], v[128:131], v[24:27]
    ds_read_b64_tr_b16 v[160:161], v241 offset:0
    v_mfma_f32_16x16x32_bf16 v[24:27], v[180:183], v[132:135], v[24:27]
    ds_read_b64_tr_b16 v[162:163], v241 offset:4096
    v_mfma_f32_16x16x32_bf16 v[28:31], v[184:187], v[128:131], v[28:31]
    ds_read_b128 v[128:131], v239 offset:0
    v_mfma_f32_16x16x32_bf16 v[28:31], v[188:191], v[132:135], v[28:31]
    ds_read_b64_tr_b16 v[164:165], v241 offset:8192
    v_mfma_f32_16x16x32_bf16 v[44:47], v[184:187], v[136:139], v[44:47]
    ds_read_b64_tr_b16 v[166:167], v241 offset:12288
    v_mfma_f32_16x16x32_bf16 v[44:47], v[188:191], v[140:143], v[44:47]
    ds_read_b128 v[132:135], v239 offset:8192
    v_mfma_f32_16x16x32_bf16 v[40:43], v[176:179], v[136:139], v[40:43]
    ds_read_b64_tr_b16 v[168:169], v242 offset:0
    v_mfma_f32_16x16x32_bf16 v[40:43], v[180:183], v[140:143], v[40:43]
    ds_read_b64_tr_b16 v[170:171], v242 offset:4096
    v_mfma_f32_16x16x32_bf16 v[56:59], v[176:179], v[144:147], v[56:59]
    ds_read_b64_tr_b16 v[172:173], v242 offset:8192
    v_mfma_f32_16x16x32_bf16 v[56:59], v[180:183], v[148:151], v[56:59]
    ds_read_b64_tr_b16 v[174:175], v242 offset:12288
    v_mfma_f32_16x16x32_bf16 v[60:63], v[184:187], v[144:147], v[60:63]
    ds_read_b128 v[136:139], v239 offset:1024
    v_mfma_f32_16x16x32_bf16 v[60:63], v[188:191], v[148:151], v[60:63]
    ds_read_b128 v[140:143], v239 offset:9216
    v_mfma_f32_16x16x32_bf16 v[76:79], v[184:187], v[152:155], v[76:79]
    ds_read_b128 v[144:147], v240 offset:0
    v_mfma_f32_16x16x32_bf16 v[76:79], v[188:191], v[156:159], v[76:79]
    ds_read_b128 v[148:151], v240 offset:8192
    v_mfma_f32_16x16x32_bf16 v[72:75], v[176:179], v[152:155], v[72:75]
    ds_read_b128 v[152:155], v240 offset:1024
    v_mfma_f32_16x16x32_bf16 v[72:75], v[180:183], v[156:159], v[72:75]
    ds_read_b128 v[156:159], v240 offset:9216
    s_waitcnt lgkmcnt(4)
    v_mfma_f32_16x16x32_bf16 v[16:19], v[160:163], v[128:131], v[16:19]
    ds_read_b64_tr_b16 v[184:185], v244 offset:0
    v_mfma_f32_16x16x32_bf16 v[16:19], v[164:167], v[132:135], v[16:19]
    ds_read_b64_tr_b16 v[186:187], v244 offset:4096
    v_mfma_f32_16x16x32_bf16 v[20:23], v[168:171], v[128:131], v[20:23]
    ds_read_b64_tr_b16 v[188:189], v244 offset:8192
    v_mfma_f32_16x16x32_bf16 v[20:23], v[172:175], v[132:135], v[20:23]
    ds_read_b64_tr_b16 v[190:191], v244 offset:12288
    v_mfma_f32_16x16x32_bf16 v[36:39], v[168:171], v[136:139], v[36:39]
    ds_read_b64_tr_b16 v[176:177], v243 offset:0
    v_mfma_f32_16x16x32_bf16 v[36:39], v[172:175], v[140:143], v[36:39]
    ds_read_b64_tr_b16 v[178:179], v243 offset:4096
    v_mfma_f32_16x16x32_bf16 v[32:35], v[160:163], v[136:139], v[32:35]
    ds_read_b64_tr_b16 v[180:181], v243 offset:8192
    v_mfma_f32_16x16x32_bf16 v[32:35], v[164:167], v[140:143], v[32:35]
    ds_read_b64_tr_b16 v[182:183], v243 offset:12288
    s_waitcnt lgkmcnt(4)
    v_mfma_f32_16x16x32_bf16 v[48:51], v[160:163], v[144:147], v[48:51]
    v_mfma_f32_16x16x32_bf16 v[48:51], v[164:167], v[148:151], v[48:51]
    v_mfma_f32_16x16x32_bf16 v[52:55], v[168:171], v[144:147], v[52:55]
    v_mfma_f32_16x16x32_bf16 v[52:55], v[172:175], v[148:151], v[52:55]
    v_mfma_f32_16x16x32_bf16 v[68:71], v[168:171], v[152:155], v[68:71]
    v_mfma_f32_16x16x32_bf16 v[68:71], v[172:175], v[156:159], v[68:71]
    v_mfma_f32_16x16x32_bf16 v[64:67], v[160:163], v[152:155], v[64:67]
    v_mfma_f32_16x16x32_bf16 v[64:67], v[164:167], v[156:159], v[64:67]
    s_waitcnt vmcnt(0) lgkmcnt(0)
    s_barrier
    v_mfma_f32_16x16x32_bf16 v[24:27], v[176:179], v[128:131], v[24:27]
    ds_read_b64_tr_b16 v[160:161], v241 offset:32768
    v_mfma_f32_16x16x32_bf16 v[24:27], v[180:183], v[132:135], v[24:27]
    ds_read_b64_tr_b16 v[162:163], v241 offset:36864
    v_mfma_f32_16x16x32_bf16 v[28:31], v[184:187], v[128:131], v[28:31]
    ds_read_b128 v[128:131], v239 offset:32768
    v_mfma_f32_16x16x32_bf16 v[28:31], v[188:191], v[132:135], v[28:31]
    ds_read_b64_tr_b16 v[164:165], v241 offset:40960
    v_mfma_f32_16x16x32_bf16 v[44:47], v[184:187], v[136:139], v[44:47]
    ds_read_b64_tr_b16 v[166:167], v241 offset:45056
    v_mfma_f32_16x16x32_bf16 v[44:47], v[188:191], v[140:143], v[44:47]
    ds_read_b128 v[132:135], v239 offset:40960
    v_mfma_f32_16x16x32_bf16 v[40:43], v[176:179], v[136:139], v[40:43]
    ds_read_b64_tr_b16 v[168:169], v242 offset:32768
    v_mfma_f32_16x16x32_bf16 v[40:43], v[180:183], v[140:143], v[40:43]
    ds_read_b64_tr_b16 v[170:171], v242 offset:36864
    v_mfma_f32_16x16x32_bf16 v[56:59], v[176:179], v[144:147], v[56:59]
    ds_read_b64_tr_b16 v[172:173], v242 offset:40960
    v_mfma_f32_16x16x32_bf16 v[56:59], v[180:183], v[148:151], v[56:59]
    ds_read_b64_tr_b16 v[174:175], v242 offset:45056
    v_mfma_f32_16x16x32_bf16 v[60:63], v[184:187], v[144:147], v[60:63]
    ds_read_b128 v[136:139], v239 offset:33792
    v_mfma_f32_16x16x32_bf16 v[60:63], v[188:191], v[148:151], v[60:63]
    ds_read_b128 v[140:143], v239 offset:41984
    v_mfma_f32_16x16x32_bf16 v[76:79], v[184:187], v[152:155], v[76:79]
    ds_read_b128 v[144:147], v240 offset:32768
    v_mfma_f32_16x16x32_bf16 v[76:79], v[188:191], v[156:159], v[76:79]
    ds_read_b128 v[148:151], v240 offset:40960
    v_mfma_f32_16x16x32_bf16 v[72:75], v[176:179], v[152:155], v[72:75]
    ds_read_b128 v[152:155], v240 offset:33792
    v_mfma_f32_16x16x32_bf16 v[72:75], v[180:183], v[156:159], v[72:75]
    ds_read_b128 v[156:159], v240 offset:41984
    s_waitcnt lgkmcnt(4)
    v_mfma_f32_16x16x32_bf16 v[16:19], v[160:163], v[128:131], v[16:19]
    ds_read_b64_tr_b16 v[184:185], v244 offset:32768
    v_mfma_f32_16x16x32_bf16 v[16:19], v[164:167], v[132:135], v[16:19]
    ds_read_b64_tr_b16 v[186:187], v244 offset:36864
    v_mfma_f32_16x16x32_bf16 v[20:23], v[168:171], v[128:131], v[20:23]
    ds_read_b64_tr_b16 v[188:189], v244 offset:40960
    v_mfma_f32_16x16x32_bf16 v[20:23], v[172:175], v[132:135], v[20:23]
    ds_read_b64_tr_b16 v[190:191], v244 offset:45056
    v_mfma_f32_16x16x32_bf16 v[36:39], v[168:171], v[136:139], v[36:39]
    ds_read_b64_tr_b16 v[176:177], v243 offset:32768
    v_mfma_f32_16x16x32_bf16 v[36:39], v[172:175], v[140:143], v[36:39]
    ds_read_b64_tr_b16 v[178:179], v243 offset:36864
    v_mfma_f32_16x16x32_bf16 v[32:35], v[160:163], v[136:139], v[32:35]
    ds_read_b64_tr_b16 v[180:181], v243 offset:40960
    v_mfma_f32_16x16x32_bf16 v[32:35], v[164:167], v[140:143], v[32:35]
    ds_read_b64_tr_b16 v[182:183], v243 offset:45056
    s_waitcnt lgkmcnt(4)
    v_mfma_f32_16x16x32_bf16 v[48:51], v[160:163], v[144:147], v[48:51]
    v_mfma_f32_16x16x32_bf16 v[48:51], v[164:167], v[148:151], v[48:51]
    v_mfma_f32_16x16x32_bf16 v[52:55], v[168:171], v[144:147], v[52:55]
    v_mfma_f32_16x16x32_bf16 v[52:55], v[172:175], v[148:151], v[52:55]
    v_mfma_f32_16x16x32_bf16 v[68:71], v[168:171], v[152:155], v[68:71]
    v_mfma_f32_16x16x32_bf16 v[68:71], v[172:175], v[156:159], v[68:71]
    v_mfma_f32_16x16x32_bf16 v[64:67], v[160:163], v[152:155], v[64:67]
    v_mfma_f32_16x16x32_bf16 v[64:67], v[164:167], v[156:159], v[64:67]
    s_waitcnt lgkmcnt(0)
    s_barrier
    v_mfma_f32_16x16x32_bf16 v[24:27], v[176:179], v[128:131], v[24:27]
    ds_read_b64_tr_b16 v[160:161], v228 offset:0
    v_mul_f32 v16, v245, v16
    v_mul_f32_e64 v17, v245, v17
    v_mfma_f32_16x16x32_bf16 v[24:27], v[180:183], v[132:135], v[24:27]
    ds_read_b64_tr_b16 v[162:163], v228 offset:4096
    v_mul_f32 v18, v245, v18
    v_mul_f32 v19, v245, v19
    v_mfma_f32_16x16x32_bf16 v[28:31], v[184:187], v[128:131], v[28:31]
    ds_read_b128 v[128:131], v226 offset:0
    v_mul_f32 v20, v245, v20
    v_mul_f32 v21, v245, v21
    v_mfma_f32_16x16x32_bf16 v[28:31], v[188:191], v[132:135], v[28:31]
    ds_read_b64_tr_b16 v[164:165], v228 offset:8192
    v_mul_f32 v22, v245, v22
    v_mul_f32 v23, v245, v23
    v_mfma_f32_16x16x32_bf16 v[44:47], v[184:187], v[136:139], v[44:47]
    ds_read_b64_tr_b16 v[166:167], v228 offset:12288
    v_mul_f32 v32, v246, v32
    v_mul_f32 v33, v246, v33
    v_mfma_f32_16x16x32_bf16 v[44:47], v[188:191], v[140:143], v[44:47]
    ds_read_b128 v[132:135], v226 offset:8192
    v_mul_f32 v34, v246, v34
    v_mul_f32 v35, v246, v35
    v_mfma_f32_16x16x32_bf16 v[40:43], v[176:179], v[136:139], v[40:43]
    ds_read_b64_tr_b16 v[168:169], v229 offset:0
    v_mul_f32 v36, v246, v36
    v_mul_f32 v37, v246, v37
    v_mfma_f32_16x16x32_bf16 v[40:43], v[180:183], v[140:143], v[40:43]
    ds_read_b64_tr_b16 v[170:171], v229 offset:4096
    v_mul_f32 v38, v246, v38
    v_mul_f32 v39, v246, v39
    v_mfma_f32_16x16x32_bf16 v[56:59], v[176:179], v[144:147], v[56:59]
    ds_read_b64_tr_b16 v[172:173], v229 offset:8192
    v_mul_f32 v48, v247, v48
    v_mul_f32 v49, v247, v49
    v_mfma_f32_16x16x32_bf16 v[56:59], v[180:183], v[148:151], v[56:59]
    ds_read_b64_tr_b16 v[174:175], v229 offset:12288
    v_mul_f32 v50, v247, v50
    v_mul_f32 v51, v247, v51
    v_mfma_f32_16x16x32_bf16 v[60:63], v[184:187], v[144:147], v[60:63]
    ds_read_b128 v[136:139], v226 offset:1024
    v_mul_f32 v52, v247, v52
    v_mul_f32 v53, v247, v53
    v_mfma_f32_16x16x32_bf16 v[60:63], v[188:191], v[148:151], v[60:63]
    ds_read_b128 v[140:143], v226 offset:9216
    v_mul_f32 v54, v247, v54
    v_mul_f32 v55, v247, v55
    v_mfma_f32_16x16x32_bf16 v[76:79], v[184:187], v[152:155], v[76:79]
    ds_read_b128 v[144:147], v227 offset:0
    v_mul_f32 v64, v248, v64
    v_mul_f32 v65, v248, v65
    v_mfma_f32_16x16x32_bf16 v[76:79], v[188:191], v[156:159], v[76:79]
    ds_read_b128 v[148:151], v227 offset:8192
    v_mul_f32 v66, v248, v66
    v_mul_f32 v67, v248, v67
    v_mfma_f32_16x16x32_bf16 v[72:75], v[176:179], v[152:155], v[72:75]
    ds_read_b128 v[152:155], v227 offset:1024
    v_mul_f32 v68, v248, v68
    v_mul_f32 v69, v248, v69
    v_mfma_f32_16x16x32_bf16 v[72:75], v[180:183], v[156:159], v[72:75]
    ds_read_b128 v[156:159], v227 offset:9216
    v_mul_f32 v70, v248, v70
    v_mul_f32_e64 v71, v248, v71
    s_waitcnt lgkmcnt(4)
    v_mfma_f32_16x16x32_bf16 v[16:19], v[160:163], v[128:131], v[16:19]
    ds_read_b64_tr_b16 v[184:185], v231 offset:0
    v_mul_f32 v24, v245, v24
    v_mul_f32 v25, v245, v25
    v_mfma_f32_16x16x32_bf16 v[16:19], v[164:167], v[132:135], v[16:19]
    ds_read_b64_tr_b16 v[186:187], v231 offset:4096
    v_mul_f32 v26, v245, v26
    v_mul_f32 v27, v245, v27
    v_mfma_f32_16x16x32_bf16 v[20:23], v[168:171], v[128:131], v[20:23]
    ds_read_b64_tr_b16 v[188:189], v231 offset:8192
    v_mul_f32 v28, v245, v28
    v_mul_f32 v29, v245, v29
    v_mfma_f32_16x16x32_bf16 v[20:23], v[172:175], v[132:135], v[20:23]
    ds_read_b64_tr_b16 v[190:191], v231 offset:12288
    v_mul_f32 v30, v245, v30
    v_mul_f32 v31, v245, v31
    v_mfma_f32_16x16x32_bf16 v[36:39], v[168:171], v[136:139], v[36:39]
    ds_read_b64_tr_b16 v[176:177], v230 offset:0
    v_mul_f32 v40, v246, v40
    v_mul_f32 v41, v246, v41
    v_mfma_f32_16x16x32_bf16 v[36:39], v[172:175], v[140:143], v[36:39]
    ds_read_b64_tr_b16 v[178:179], v230 offset:4096
    v_mul_f32 v42, v246, v42
    v_mul_f32 v43, v246, v43
    v_mfma_f32_16x16x32_bf16 v[32:35], v[160:163], v[136:139], v[32:35]
    ds_read_b64_tr_b16 v[180:181], v230 offset:8192
    v_mul_f32 v44, v246, v44
    v_mul_f32 v45, v246, v45
    v_mfma_f32_16x16x32_bf16 v[32:35], v[164:167], v[140:143], v[32:35]
    ds_read_b64_tr_b16 v[182:183], v230 offset:12288
    v_mul_f32 v46, v246, v46
    v_mul_f32_e64 v47, v246, v47
    s_waitcnt lgkmcnt(4)
    v_mfma_f32_16x16x32_bf16 v[48:51], v[160:163], v[144:147], v[48:51]
    v_mul_f32 v56, v247, v56
    v_mul_f32 v57, v247, v57
    v_mfma_f32_16x16x32_bf16 v[48:51], v[164:167], v[148:151], v[48:51]
    v_mul_f32 v58, v247, v58
    v_mul_f32 v59, v247, v59
    v_mfma_f32_16x16x32_bf16 v[52:55], v[168:171], v[144:147], v[52:55]
    v_mul_f32 v60, v247, v60
    v_mul_f32 v61, v247, v61
    v_mfma_f32_16x16x32_bf16 v[52:55], v[172:175], v[148:151], v[52:55]
    v_mul_f32 v62, v247, v62
    v_mul_f32 v63, v247, v63
    v_mfma_f32_16x16x32_bf16 v[68:71], v[168:171], v[152:155], v[68:71]
    v_mul_f32 v72, v248, v72
    v_mul_f32 v73, v248, v73
    v_mfma_f32_16x16x32_bf16 v[68:71], v[172:175], v[156:159], v[68:71]
    v_mul_f32 v74, v248, v74
    v_mul_f32 v75, v248, v75
    v_mfma_f32_16x16x32_bf16 v[64:67], v[160:163], v[152:155], v[64:67]
    v_mul_f32 v76, v248, v76
    v_mul_f32 v77, v248, v77
    v_mfma_f32_16x16x32_bf16 v[64:67], v[164:167], v[156:159], v[64:67]
    v_mul_f32 v78, v248, v78
    v_mul_f32 v79, v248, v79
    s_waitcnt lgkmcnt(0)
    s_barrier
    v_mfma_f32_16x16x32_bf16 v[24:27], v[176:179], v[128:131], v[24:27]
    ds_read_b64_tr_b16 v[160:161], v228 offset:32768
    v_mfma_f32_16x16x32_bf16 v[24:27], v[180:183], v[132:135], v[24:27]
    ds_read_b64_tr_b16 v[162:163], v228 offset:36864
    v_mfma_f32_16x16x32_bf16 v[28:31], v[184:187], v[128:131], v[28:31]
    ds_read_b128 v[128:131], v226 offset:32768
    v_mfma_f32_16x16x32_bf16 v[28:31], v[188:191], v[132:135], v[28:31]
    ds_read_b64_tr_b16 v[164:165], v228 offset:40960
    v_mfma_f32_16x16x32_bf16 v[44:47], v[184:187], v[136:139], v[44:47]
    ds_read_b64_tr_b16 v[166:167], v228 offset:45056
    v_mfma_f32_16x16x32_bf16 v[44:47], v[188:191], v[140:143], v[44:47]
    ds_read_b128 v[132:135], v226 offset:40960
    v_mfma_f32_16x16x32_bf16 v[40:43], v[176:179], v[136:139], v[40:43]
    ds_read_b64_tr_b16 v[168:169], v229 offset:32768
    v_mfma_f32_16x16x32_bf16 v[40:43], v[180:183], v[140:143], v[40:43]
    ds_read_b64_tr_b16 v[170:171], v229 offset:36864
    v_mfma_f32_16x16x32_bf16 v[56:59], v[176:179], v[144:147], v[56:59]
    ds_read_b64_tr_b16 v[172:173], v229 offset:40960
    v_mfma_f32_16x16x32_bf16 v[56:59], v[180:183], v[148:151], v[56:59]
    ds_read_b64_tr_b16 v[174:175], v229 offset:45056
    v_mfma_f32_16x16x32_bf16 v[60:63], v[184:187], v[144:147], v[60:63]
    ds_read_b128 v[136:139], v226 offset:33792
    v_mfma_f32_16x16x32_bf16 v[60:63], v[188:191], v[148:151], v[60:63]
    ds_read_b128 v[140:143], v226 offset:41984
    v_mfma_f32_16x16x32_bf16 v[76:79], v[184:187], v[152:155], v[76:79]
    ds_read_b128 v[144:147], v227 offset:32768
    v_mfma_f32_16x16x32_bf16 v[76:79], v[188:191], v[156:159], v[76:79]
    ds_read_b128 v[148:151], v227 offset:40960
    v_mfma_f32_16x16x32_bf16 v[72:75], v[176:179], v[152:155], v[72:75]
    ds_read_b128 v[152:155], v227 offset:33792
    v_mfma_f32_16x16x32_bf16 v[72:75], v[180:183], v[156:159], v[72:75]
    ds_read_b128 v[156:159], v227 offset:41984
    s_waitcnt lgkmcnt(4)
    v_mfma_f32_16x16x32_bf16 v[16:19], v[160:163], v[128:131], v[16:19]
    ds_read_b64_tr_b16 v[184:185], v231 offset:32768
    v_mfma_f32_16x16x32_bf16 v[16:19], v[164:167], v[132:135], v[16:19]
    ds_read_b64_tr_b16 v[186:187], v231 offset:36864
    v_mfma_f32_16x16x32_bf16 v[20:23], v[168:171], v[128:131], v[20:23]
    ds_read_b64_tr_b16 v[188:189], v231 offset:40960
    v_mfma_f32_16x16x32_bf16 v[20:23], v[172:175], v[132:135], v[20:23]
    ds_read_b64_tr_b16 v[190:191], v231 offset:45056
    v_mfma_f32_16x16x32_bf16 v[36:39], v[168:171], v[136:139], v[36:39]
    ds_read_b64_tr_b16 v[176:177], v230 offset:32768
    v_mfma_f32_16x16x32_bf16 v[36:39], v[172:175], v[140:143], v[36:39]
    ds_read_b64_tr_b16 v[178:179], v230 offset:36864
    v_mfma_f32_16x16x32_bf16 v[32:35], v[160:163], v[136:139], v[32:35]
    ds_read_b64_tr_b16 v[180:181], v230 offset:40960
    v_mfma_f32_16x16x32_bf16 v[32:35], v[164:167], v[140:143], v[32:35]
    ds_read_b64_tr_b16 v[182:183], v230 offset:45056
    s_waitcnt lgkmcnt(4)
    v_mfma_f32_16x16x32_bf16 v[48:51], v[160:163], v[144:147], v[48:51]
    v_mfma_f32_16x16x32_bf16 v[48:51], v[164:167], v[148:151], v[48:51]
    v_mfma_f32_16x16x32_bf16 v[52:55], v[168:171], v[144:147], v[52:55]
    v_mfma_f32_16x16x32_bf16 v[52:55], v[172:175], v[148:151], v[52:55]
    v_mfma_f32_16x16x32_bf16 v[68:71], v[168:171], v[152:155], v[68:71]
    v_mfma_f32_16x16x32_bf16 v[68:71], v[172:175], v[156:159], v[68:71]
    v_mfma_f32_16x16x32_bf16 v[64:67], v[160:163], v[152:155], v[64:67]
    v_mfma_f32_16x16x32_bf16 v[64:67], v[164:167], v[156:159], v[64:67]
    s_waitcnt lgkmcnt(0)
    s_barrier
    v_mfma_f32_16x16x32_bf16 v[24:27], v[176:179], v[128:131], v[24:27]
    ds_read_b64_tr_b16 v[160:161], v241 offset:0
    v_mfma_f32_16x16x32_bf16 v[24:27], v[180:183], v[132:135], v[24:27]
    ds_read_b64_tr_b16 v[162:163], v241 offset:4096
    v_mfma_f32_16x16x32_bf16 v[28:31], v[184:187], v[128:131], v[28:31]
    ds_read_b128 v[128:131], v239 offset:0
    v_mfma_f32_16x16x32_bf16 v[28:31], v[188:191], v[132:135], v[28:31]
    ds_read_b64_tr_b16 v[164:165], v241 offset:8192
    v_mfma_f32_16x16x32_bf16 v[44:47], v[184:187], v[136:139], v[44:47]
    ds_read_b64_tr_b16 v[166:167], v241 offset:12288
    v_mfma_f32_16x16x32_bf16 v[44:47], v[188:191], v[140:143], v[44:47]
    ds_read_b128 v[132:135], v239 offset:8192
    v_mfma_f32_16x16x32_bf16 v[40:43], v[176:179], v[136:139], v[40:43]
    ds_read_b64_tr_b16 v[168:169], v242 offset:0
    v_mfma_f32_16x16x32_bf16 v[40:43], v[180:183], v[140:143], v[40:43]
    ds_read_b64_tr_b16 v[170:171], v242 offset:4096
    v_mfma_f32_16x16x32_bf16 v[56:59], v[176:179], v[144:147], v[56:59]
    ds_read_b64_tr_b16 v[172:173], v242 offset:8192
    v_mfma_f32_16x16x32_bf16 v[56:59], v[180:183], v[148:151], v[56:59]
    ds_read_b64_tr_b16 v[174:175], v242 offset:12288
    v_mfma_f32_16x16x32_bf16 v[60:63], v[184:187], v[144:147], v[60:63]
    ds_read_b128 v[136:139], v239 offset:1024
    v_mfma_f32_16x16x32_bf16 v[60:63], v[188:191], v[148:151], v[60:63]
    ds_read_b128 v[140:143], v239 offset:9216
    v_mfma_f32_16x16x32_bf16 v[76:79], v[184:187], v[152:155], v[76:79]
    ds_read_b128 v[144:147], v240 offset:0
    v_mfma_f32_16x16x32_bf16 v[76:79], v[188:191], v[156:159], v[76:79]
    ds_read_b128 v[148:151], v240 offset:8192
    v_mfma_f32_16x16x32_bf16 v[72:75], v[176:179], v[152:155], v[72:75]
    ds_read_b128 v[152:155], v240 offset:1024
    v_mfma_f32_16x16x32_bf16 v[72:75], v[180:183], v[156:159], v[72:75]
    ds_read_b128 v[156:159], v240 offset:9216
    s_waitcnt lgkmcnt(4)
    v_mfma_f32_16x16x32_bf16 v[16:19], v[160:163], v[128:131], v[16:19]
    ds_read_b64_tr_b16 v[184:185], v244 offset:0
    v_mfma_f32_16x16x32_bf16 v[16:19], v[164:167], v[132:135], v[16:19]
    ds_read_b64_tr_b16 v[186:187], v244 offset:4096
    v_mfma_f32_16x16x32_bf16 v[20:23], v[168:171], v[128:131], v[20:23]
    ds_read_b64_tr_b16 v[188:189], v244 offset:8192
    v_mfma_f32_16x16x32_bf16 v[20:23], v[172:175], v[132:135], v[20:23]
    ds_read_b64_tr_b16 v[190:191], v244 offset:12288
    v_mfma_f32_16x16x32_bf16 v[36:39], v[168:171], v[136:139], v[36:39]
    ds_read_b64_tr_b16 v[176:177], v243 offset:0
    v_mfma_f32_16x16x32_bf16 v[36:39], v[172:175], v[140:143], v[36:39]
    ds_read_b64_tr_b16 v[178:179], v243 offset:4096
    v_mfma_f32_16x16x32_bf16 v[32:35], v[160:163], v[136:139], v[32:35]
    ds_read_b64_tr_b16 v[180:181], v243 offset:8192
    v_mfma_f32_16x16x32_bf16 v[32:35], v[164:167], v[140:143], v[32:35]
    ds_read_b64_tr_b16 v[182:183], v243 offset:12288
    s_waitcnt lgkmcnt(4)
    v_mfma_f32_16x16x32_bf16 v[48:51], v[160:163], v[144:147], v[48:51]
    v_mfma_f32_16x16x32_bf16 v[48:51], v[164:167], v[148:151], v[48:51]
    v_mfma_f32_16x16x32_bf16 v[52:55], v[168:171], v[144:147], v[52:55]
    v_mfma_f32_16x16x32_bf16 v[52:55], v[172:175], v[148:151], v[52:55]
    v_mfma_f32_16x16x32_bf16 v[68:71], v[168:171], v[152:155], v[68:71]
    v_mfma_f32_16x16x32_bf16 v[68:71], v[172:175], v[156:159], v[68:71]
    v_mfma_f32_16x16x32_bf16 v[64:67], v[160:163], v[152:155], v[64:67]
    v_mfma_f32_16x16x32_bf16 v[64:67], v[164:167], v[156:159], v[64:67]
    s_waitcnt lgkmcnt(0)
    s_barrier
    v_mfma_f32_16x16x32_bf16 v[24:27], v[176:179], v[128:131], v[24:27]
    ds_read_b64_tr_b16 v[160:161], v241 offset:32768
    v_mfma_f32_16x16x32_bf16 v[24:27], v[180:183], v[132:135], v[24:27]
    ds_read_b64_tr_b16 v[162:163], v241 offset:36864
    v_mfma_f32_16x16x32_bf16 v[28:31], v[184:187], v[128:131], v[28:31]
    ds_read_b128 v[128:131], v239 offset:32768
    v_mfma_f32_16x16x32_bf16 v[28:31], v[188:191], v[132:135], v[28:31]
    ds_read_b64_tr_b16 v[164:165], v241 offset:40960
    v_mfma_f32_16x16x32_bf16 v[44:47], v[184:187], v[136:139], v[44:47]
    ds_read_b64_tr_b16 v[166:167], v241 offset:45056
    v_mfma_f32_16x16x32_bf16 v[44:47], v[188:191], v[140:143], v[44:47]
    ds_read_b128 v[132:135], v239 offset:40960
    v_mfma_f32_16x16x32_bf16 v[40:43], v[176:179], v[136:139], v[40:43]
    ds_read_b64_tr_b16 v[168:169], v242 offset:32768
    v_mfma_f32_16x16x32_bf16 v[40:43], v[180:183], v[140:143], v[40:43]
    ds_read_b64_tr_b16 v[170:171], v242 offset:36864
    v_mfma_f32_16x16x32_bf16 v[56:59], v[176:179], v[144:147], v[56:59]
    ds_read_b64_tr_b16 v[172:173], v242 offset:40960
    v_mfma_f32_16x16x32_bf16 v[56:59], v[180:183], v[148:151], v[56:59]
    ds_read_b64_tr_b16 v[174:175], v242 offset:45056
    v_mfma_f32_16x16x32_bf16 v[60:63], v[184:187], v[144:147], v[60:63]
    ds_read_b128 v[136:139], v239 offset:33792
    v_mfma_f32_16x16x32_bf16 v[60:63], v[188:191], v[148:151], v[60:63]
    ds_read_b128 v[140:143], v239 offset:41984
    v_mfma_f32_16x16x32_bf16 v[76:79], v[184:187], v[152:155], v[76:79]
    ds_read_b128 v[144:147], v240 offset:32768
    v_mfma_f32_16x16x32_bf16 v[76:79], v[188:191], v[156:159], v[76:79]
    ds_read_b128 v[148:151], v240 offset:40960
    v_mfma_f32_16x16x32_bf16 v[72:75], v[176:179], v[152:155], v[72:75]
    ds_read_b128 v[152:155], v240 offset:33792
    v_mfma_f32_16x16x32_bf16 v[72:75], v[180:183], v[156:159], v[72:75]
    ds_read_b128 v[156:159], v240 offset:41984
    s_waitcnt lgkmcnt(4)
    v_mfma_f32_16x16x32_bf16 v[16:19], v[160:163], v[128:131], v[16:19]
    ds_read_b64_tr_b16 v[184:185], v244 offset:32768
    v_mfma_f32_16x16x32_bf16 v[16:19], v[164:167], v[132:135], v[16:19]
    ds_read_b64_tr_b16 v[186:187], v244 offset:36864
    v_mfma_f32_16x16x32_bf16 v[20:23], v[168:171], v[128:131], v[20:23]
    ds_read_b64_tr_b16 v[188:189], v244 offset:40960
    v_mfma_f32_16x16x32_bf16 v[20:23], v[172:175], v[132:135], v[20:23]
    ds_read_b64_tr_b16 v[190:191], v244 offset:45056
    v_mfma_f32_16x16x32_bf16 v[36:39], v[168:171], v[136:139], v[36:39]
    ds_read_b64_tr_b16 v[176:177], v243 offset:32768
    v_mfma_f32_16x16x32_bf16 v[36:39], v[172:175], v[140:143], v[36:39]
    ds_read_b64_tr_b16 v[178:179], v243 offset:36864
    v_mfma_f32_16x16x32_bf16 v[32:35], v[160:163], v[136:139], v[32:35]
    ds_read_b64_tr_b16 v[180:181], v243 offset:40960
    v_mfma_f32_16x16x32_bf16 v[32:35], v[164:167], v[140:143], v[32:35]
    ds_read_b64_tr_b16 v[182:183], v243 offset:45056
    s_waitcnt lgkmcnt(4)
    v_mfma_f32_16x16x32_bf16 v[48:51], v[160:163], v[144:147], v[48:51]
    v_mfma_f32_16x16x32_bf16 v[48:51], v[164:167], v[148:151], v[48:51]
    v_mfma_f32_16x16x32_bf16 v[52:55], v[168:171], v[144:147], v[52:55]
    v_mfma_f32_16x16x32_bf16 v[52:55], v[172:175], v[148:151], v[52:55]
    v_mfma_f32_16x16x32_bf16 v[68:71], v[168:171], v[152:155], v[68:71]
    v_mfma_f32_16x16x32_bf16 v[68:71], v[172:175], v[156:159], v[68:71]
    v_mfma_f32_16x16x32_bf16 v[64:67], v[160:163], v[152:155], v[64:67]
    v_mfma_f32_16x16x32_bf16 v[64:67], v[164:167], v[156:159], v[64:67]
    s_waitcnt lgkmcnt(0)
    s_barrier
    v_mfma_f32_16x16x32_bf16 v[24:27], v[176:179], v[128:131], v[24:27]
    ds_read_b64_tr_b16 v[160:161], v228 offset:0
    v_mfma_f32_16x16x32_bf16 v[24:27], v[180:183], v[132:135], v[24:27]
    ds_read_b64_tr_b16 v[162:163], v228 offset:4096
    v_mfma_f32_16x16x32_bf16 v[28:31], v[184:187], v[128:131], v[28:31]
    ds_read_b128 v[128:131], v226 offset:0
    s_lshl_b32 s91, s55, 2
    s_add_u32 s91, s91, s4
    s_lshl_b32 s91, s91, 12
    s_add_u32 s91, s91, 18874368
    v_cvt_pk_bf16_f32 v48, v48, v49
    v_cvt_pk_bf16_f32 v49, v50, v51
    v_mfma_f32_16x16x32_bf16 v[28:31], v[188:191], v[132:135], v[28:31]
    ds_read_b64_tr_b16 v[164:165], v228 offset:8192
    v_cvt_pk_bf16_f32 v50, v52, v53
    v_cvt_pk_bf16_f32 v51, v54, v55
    buffer_store_dwordx4 v[48:51], v249, s[28:31], s91 offen offset:0 sc1
    v_mfma_f32_16x16x32_bf16 v[44:47], v[184:187], v[136:139], v[44:47]
    ds_read_b64_tr_b16 v[166:167], v228 offset:12288
    v_mfma_f32_16x16x32_bf16 v[44:47], v[188:191], v[140:143], v[44:47]
    ds_read_b128 v[132:135], v226 offset:8192
    v_mfma_f32_16x16x32_bf16 v[40:43], v[176:179], v[136:139], v[40:43]
    ds_read_b64_tr_b16 v[168:169], v229 offset:0
    v_mfma_f32_16x16x32_bf16 v[40:43], v[180:183], v[140:143], v[40:43]
    ds_read_b64_tr_b16 v[170:171], v229 offset:4096
    v_mfma_f32_16x16x32_bf16 v[56:59], v[176:179], v[144:147], v[56:59]
    ds_read_b64_tr_b16 v[172:173], v229 offset:8192
    v_cvt_pk_bf16_f32 v64, v64, v65
    v_cvt_pk_bf16_f32 v65, v66, v67
    v_mfma_f32_16x16x32_bf16 v[56:59], v[180:183], v[148:151], v[56:59]
    ds_read_b64_tr_b16 v[174:175], v229 offset:12288
    v_cvt_pk_bf16_f32 v66, v68, v69
    v_cvt_pk_bf16_f32 v67, v70, v71
    buffer_store_dwordx4 v[64:67], v249, s[28:31], s91 offen offset:2048 sc1
    v_mfma_f32_16x16x32_bf16 v[60:63], v[184:187], v[144:147], v[60:63]
    ds_read_b128 v[136:139], v226 offset:1024
    v_mfma_f32_16x16x32_bf16 v[60:63], v[188:191], v[148:151], v[60:63]
    ds_read_b128 v[140:143], v226 offset:9216
    v_mfma_f32_16x16x32_bf16 v[76:79], v[184:187], v[152:155], v[76:79]
    ds_read_b64_tr_b16 v[184:185], v231 offset:0
    v_mfma_f32_16x16x32_bf16 v[76:79], v[188:191], v[156:159], v[76:79]
    ds_read_b64_tr_b16 v[186:187], v231 offset:4096
    v_mfma_f32_16x16x32_bf16 v[72:75], v[176:179], v[152:155], v[72:75]
    ds_read_b64_tr_b16 v[188:189], v231 offset:8192
    v_mfma_f32_16x16x32_bf16 v[72:75], v[180:183], v[156:159], v[72:75]
    ds_read_b64_tr_b16 v[190:191], v231 offset:12288
    v_cvt_pk_bf16_f32 v56, v56, v57
    v_cvt_pk_bf16_f32 v57, v58, v59
    s_waitcnt lgkmcnt(4)
    v_mfma_f32_16x16x32_bf16 v[16:19], v[160:163], v[128:131], v[16:19]
    ds_read_b64_tr_b16 v[176:177], v230 offset:0
    v_cvt_pk_bf16_f32 v58, v60, v61
    v_cvt_pk_bf16_f32 v59, v62, v63
    buffer_store_dwordx4 v[56:59], v249, s[28:31], s91 offen offset:1024 sc1
    v_mfma_f32_16x16x32_bf16 v[16:19], v[164:167], v[132:135], v[16:19]
    ds_read_b64_tr_b16 v[178:179], v230 offset:4096
    v_mfma_f32_16x16x32_bf16 v[20:23], v[168:171], v[128:131], v[20:23]
    ds_read_b64_tr_b16 v[180:181], v230 offset:8192
    v_mfma_f32_16x16x32_bf16 v[20:23], v[172:175], v[132:135], v[20:23]
    ds_read_b64_tr_b16 v[182:183], v230 offset:12288
    v_mfma_f32_16x16x32_bf16 v[36:39], v[168:171], v[136:139], v[36:39]
    v_cvt_pk_bf16_f32 v72, v72, v73
    v_cvt_pk_bf16_f32 v73, v74, v75
    v_mfma_f32_16x16x32_bf16 v[36:39], v[172:175], v[140:143], v[36:39]
    v_cvt_pk_bf16_f32 v74, v76, v77
    v_cvt_pk_bf16_f32 v75, v78, v79
    buffer_store_dwordx4 v[72:75], v249, s[28:31], s91 offen offset:3072 sc1
    v_mfma_f32_16x16x32_bf16 v[32:35], v[160:163], v[136:139], v[32:35]
    v_mfma_f32_16x16x32_bf16 v[32:35], v[164:167], v[140:143], v[32:35]
    s_waitcnt lgkmcnt(0)
    s_barrier
    v_mfma_f32_16x16x32_bf16 v[24:27], v[176:179], v[128:131], v[24:27]
    ds_read_b128 v[144:147], v226 offset:32768
    ds_read_b64_tr_b16 v[166:167], v228 offset:45056
    v_mfma_f32_16x16x32_bf16 v[24:27], v[180:183], v[132:135], v[24:27]
    ds_read_b64_tr_b16 v[160:161], v228 offset:32768
    ds_read_b64_tr_b16 v[170:171], v229 offset:36864
    v_mfma_f32_16x16x32_bf16 v[28:31], v[184:187], v[128:131], v[28:31]
    ds_read_b64_tr_b16 v[162:163], v228 offset:36864
    ds_read_b64_tr_b16 v[174:175], v229 offset:45056
    v_mfma_f32_16x16x32_bf16 v[28:31], v[188:191], v[132:135], v[28:31]
    ds_read_b128 v[148:151], v226 offset:40960
    v_mfma_f32_16x16x32_bf16 v[44:47], v[184:187], v[136:139], v[44:47]
    ds_read_b64_tr_b16 v[164:165], v228 offset:40960
    v_mfma_f32_16x16x32_bf16 v[44:47], v[188:191], v[140:143], v[44:47]
    ds_read_b64_tr_b16 v[168:169], v229 offset:32768
    v_mfma_f32_16x16x32_bf16 v[40:43], v[176:179], v[136:139], v[40:43]
    ds_read_b64_tr_b16 v[172:173], v229 offset:40960
    ds_read_b64_tr_b16 v[178:179], v230 offset:36864
    v_mfma_f32_16x16x32_bf16 v[40:43], v[180:183], v[140:143], v[40:43]
    ds_read_b128 v[152:155], v226 offset:33792
    ds_read_b64_tr_b16 v[180:181], v230 offset:40960
L_walkc_1:
    s_cbranch_execz L_walkedc
    s_nop 0
    s_waitcnt lgkmcnt(6)
    v_mfma_f32_16x16x32_bf16 v[16:19], v[160:163], v[144:147], v[16:19]
    ds_read_b128 v[156:159], v226 offset:41984
    ds_read_b64_tr_b16 v[182:183], v230 offset:45056
    s_waitcnt lgkmcnt(7)
    v_mfma_f32_16x16x32_bf16 v[16:19], v[164:167], v[148:151], v[16:19]
    ds_read_b64_tr_b16 v[184:185], v231 offset:32768
    s_waitcnt lgkmcnt(7)
    v_mfma_f32_16x16x32_bf16 v[20:23], v[168:171], v[144:147], v[20:23]
    ds_read_b64_tr_b16 v[186:187], v231 offset:36864
    s_waitcnt lgkmcnt(6)
    v_mfma_f32_16x16x32_bf16 v[20:23], v[172:175], v[148:151], v[20:23]
    ds_read_b64_tr_b16 v[188:189], v231 offset:40960
    s_waitcnt lgkmcnt(5)
    v_mfma_f32_16x16x32_bf16 v[36:39], v[168:171], v[152:155], v[36:39]
    ds_read_b64_tr_b16 v[190:191], v231 offset:45056
    s_waitcnt lgkmcnt(4)
    v_mfma_f32_16x16x32_bf16 v[36:39], v[172:175], v[156:159], v[36:39]
    ds_read_b64_tr_b16 v[176:177], v230 offset:32768
    v_mfma_f32_16x16x32_bf16 v[32:35], v[160:163], v[152:155], v[32:35]
    v_mfma_f32_16x16x32_bf16 v[32:35], v[164:167], v[156:159], v[32:35]
    s_waitcnt lgkmcnt(0)
    s_barrier
    v_mfma_f32_16x16x32_bf16 v[24:27], v[176:179], v[144:147], v[24:27]
    ds_read_b128 v[128:131], v239 offset:0
    ds_read_b64_tr_b16 v[166:167], v241 offset:12288
    v_mfma_f32_16x16x32_bf16 v[24:27], v[180:183], v[148:151], v[24:27]
    ds_read_b64_tr_b16 v[160:161], v241 offset:0
    ds_read_b64_tr_b16 v[170:171], v242 offset:4096
    v_mfma_f32_16x16x32_bf16 v[28:31], v[184:187], v[144:147], v[28:31]
    ds_read_b64_tr_b16 v[162:163], v241 offset:4096
    ds_read_b64_tr_b16 v[174:175], v242 offset:12288
    v_mfma_f32_16x16x32_bf16 v[28:31], v[188:191], v[148:151], v[28:31]
    ds_read_b128 v[132:135], v239 offset:8192
    v_mfma_f32_16x16x32_bf16 v[44:47], v[184:187], v[152:155], v[44:47]
    ds_read_b64_tr_b16 v[164:165], v241 offset:8192
    v_mfma_f32_16x16x32_bf16 v[44:47], v[188:191], v[156:159], v[44:47]
    ds_read_b64_tr_b16 v[168:169], v242 offset:0
    v_mfma_f32_16x16x32_bf16 v[40:43], v[176:179], v[152:155], v[40:43]
    ds_read_b64_tr_b16 v[172:173], v242 offset:8192
    ds_read_b64_tr_b16 v[178:179], v243 offset:4096
    v_mfma_f32_16x16x32_bf16 v[40:43], v[180:183], v[156:159], v[40:43]
    ds_read_b128 v[136:139], v239 offset:1024
    ds_read_b64_tr_b16 v[180:181], v243 offset:8192
    s_waitcnt lgkmcnt(6)
    v_mfma_f32_16x16x32_bf16 v[16:19], v[160:163], v[128:131], v[16:19]
    ds_read_b128 v[140:143], v239 offset:9216
    ds_read_b64_tr_b16 v[182:183], v243 offset:12288
    s_waitcnt lgkmcnt(7)
    v_mfma_f32_16x16x32_bf16 v[16:19], v[164:167], v[132:135], v[16:19]
    ds_read_b64_tr_b16 v[184:185], v244 offset:0
    s_waitcnt lgkmcnt(7)
    v_mfma_f32_16x16x32_bf16 v[20:23], v[168:171], v[128:131], v[20:23]
    ds_read_b64_tr_b16 v[186:187], v244 offset:4096
    s_waitcnt lgkmcnt(6)
    v_mfma_f32_16x16x32_bf16 v[20:23], v[172:175], v[132:135], v[20:23]
    ds_read_b64_tr_b16 v[188:189], v244 offset:8192
    s_waitcnt lgkmcnt(5)
    v_mfma_f32_16x16x32_bf16 v[36:39], v[168:171], v[136:139], v[36:39]
    ds_read_b64_tr_b16 v[190:191], v244 offset:12288
    s_waitcnt lgkmcnt(4)
    v_mfma_f32_16x16x32_bf16 v[36:39], v[172:175], v[140:143], v[36:39]
    ds_read_b64_tr_b16 v[176:177], v243 offset:0
    v_mfma_f32_16x16x32_bf16 v[32:35], v[160:163], v[136:139], v[32:35]
    v_mfma_f32_16x16x32_bf16 v[32:35], v[164:167], v[140:143], v[32:35]
    s_waitcnt vmcnt(0)
    s_waitcnt lgkmcnt(0)
    s_barrier
    v_mfma_f32_16x16x32_bf16 v[24:27], v[176:179], v[128:131], v[24:27]
    ds_read_b128 v[144:147], v239 offset:32768
    ds_read_b64_tr_b16 v[166:167], v241 offset:45056
    v_mfma_f32_16x16x32_bf16 v[24:27], v[180:183], v[132:135], v[24:27]
    ds_read_b64_tr_b16 v[160:161], v241 offset:32768
    ds_read_b64_tr_b16 v[170:171], v242 offset:36864
    v_mfma_f32_16x16x32_bf16 v[28:31], v[184:187], v[128:131], v[28:31]
    ds_read_b64_tr_b16 v[162:163], v241 offset:36864
    ds_read_b64_tr_b16 v[174:175], v242 offset:45056
    v_mfma_f32_16x16x32_bf16 v[28:31], v[188:191], v[132:135], v[28:31]
    ds_read_b128 v[148:151], v239 offset:40960
    v_mfma_f32_16x16x32_bf16 v[44:47], v[184:187], v[136:139], v[44:47]
    ds_read_b64_tr_b16 v[164:165], v241 offset:40960
    v_mfma_f32_16x16x32_bf16 v[44:47], v[188:191], v[140:143], v[44:47]
    ds_read_b64_tr_b16 v[168:169], v242 offset:32768
    v_mfma_f32_16x16x32_bf16 v[40:43], v[176:179], v[136:139], v[40:43]
    ds_read_b64_tr_b16 v[172:173], v242 offset:40960
    ds_read_b64_tr_b16 v[178:179], v243 offset:36864
    v_mfma_f32_16x16x32_bf16 v[40:43], v[180:183], v[140:143], v[40:43]
    ds_read_b128 v[152:155], v239 offset:33792
    ds_read_b64_tr_b16 v[180:181], v243 offset:40960
    s_waitcnt lgkmcnt(6)
    v_mfma_f32_16x16x32_bf16 v[16:19], v[160:163], v[144:147], v[16:19]
    ds_read_b128 v[156:159], v239 offset:41984
    ds_read_b64_tr_b16 v[182:183], v243 offset:45056
    s_waitcnt lgkmcnt(7)
    v_mfma_f32_16x16x32_bf16 v[16:19], v[164:167], v[148:151], v[16:19]
    ds_read_b64_tr_b16 v[184:185], v244 offset:32768
    s_waitcnt lgkmcnt(7)
    v_mfma_f32_16x16x32_bf16 v[20:23], v[168:171], v[144:147], v[20:23]
    ds_read_b64_tr_b16 v[186:187], v244 offset:36864
    s_waitcnt lgkmcnt(6)
    v_mfma_f32_16x16x32_bf16 v[20:23], v[172:175], v[148:151], v[20:23]
    ds_read_b64_tr_b16 v[188:189], v244 offset:40960
    s_waitcnt lgkmcnt(5)
    v_mfma_f32_16x16x32_bf16 v[36:39], v[168:171], v[152:155], v[36:39]
    ds_read_b64_tr_b16 v[190:191], v244 offset:45056
    s_waitcnt lgkmcnt(4)
    v_mfma_f32_16x16x32_bf16 v[36:39], v[172:175], v[156:159], v[36:39]
    ds_read_b64_tr_b16 v[176:177], v243 offset:32768
    v_mfma_f32_16x16x32_bf16 v[32:35], v[160:163], v[152:155], v[32:35]
    v_mfma_f32_16x16x32_bf16 v[32:35], v[164:167], v[156:159], v[32:35]
    s_waitcnt lgkmcnt(0)
    s_barrier
    v_mfma_f32_16x16x32_bf16 v[24:27], v[176:179], v[144:147], v[24:27]
    ds_read_b128 v[128:131], v226 offset:0
    ds_read_b64_tr_b16 v[166:167], v228 offset:12288
    v_mfma_f32_16x16x32_bf16 v[24:27], v[180:183], v[148:151], v[24:27]
    ds_read_b64_tr_b16 v[160:161], v228 offset:0
    ds_read_b64_tr_b16 v[170:171], v229 offset:4096
    v_mfma_f32_16x16x32_bf16 v[28:31], v[184:187], v[144:147], v[28:31]
    ds_read_b64_tr_b16 v[162:163], v228 offset:4096
    ds_read_b64_tr_b16 v[174:175], v229 offset:12288
    v_mfma_f32_16x16x32_bf16 v[28:31], v[188:191], v[148:151], v[28:31]
    ds_read_b128 v[132:135], v226 offset:8192
    v_mfma_f32_16x16x32_bf16 v[44:47], v[184:187], v[152:155], v[44:47]
    ds_read_b64_tr_b16 v[164:165], v228 offset:8192
    v_mfma_f32_16x16x32_bf16 v[44:47], v[188:191], v[156:159], v[44:47]
    ds_read_b64_tr_b16 v[168:169], v229 offset:0
    v_mfma_f32_16x16x32_bf16 v[40:43], v[176:179], v[152:155], v[40:43]
    ds_read_b64_tr_b16 v[172:173], v229 offset:8192
    ds_read_b64_tr_b16 v[178:179], v230 offset:4096
    v_mfma_f32_16x16x32_bf16 v[40:43], v[180:183], v[156:159], v[40:43]
    ds_read_b128 v[136:139], v226 offset:1024
    ds_read_b64_tr_b16 v[180:181], v230 offset:8192
    s_waitcnt lgkmcnt(6)
    v_mfma_f32_16x16x32_bf16 v[16:19], v[160:163], v[128:131], v[16:19]
    ds_read_b128 v[140:143], v226 offset:9216
    ds_read_b64_tr_b16 v[182:183], v230 offset:12288
    s_waitcnt lgkmcnt(7)
    v_mfma_f32_16x16x32_bf16 v[16:19], v[164:167], v[132:135], v[16:19]
    ds_read_b64_tr_b16 v[184:185], v231 offset:0
    s_waitcnt lgkmcnt(7)
    v_mfma_f32_16x16x32_bf16 v[20:23], v[168:171], v[128:131], v[20:23]
    ds_read_b64_tr_b16 v[186:187], v231 offset:4096
    s_waitcnt lgkmcnt(6)
    v_mfma_f32_16x16x32_bf16 v[20:23], v[172:175], v[132:135], v[20:23]
    ds_read_b64_tr_b16 v[188:189], v231 offset:8192
    s_waitcnt lgkmcnt(5)
    v_mfma_f32_16x16x32_bf16 v[36:39], v[168:171], v[136:139], v[36:39]
    ds_read_b64_tr_b16 v[190:191], v231 offset:12288
    s_waitcnt lgkmcnt(4)
    v_mfma_f32_16x16x32_bf16 v[36:39], v[172:175], v[140:143], v[36:39]
    ds_read_b64_tr_b16 v[176:177], v230 offset:0
    v_mfma_f32_16x16x32_bf16 v[32:35], v[160:163], v[136:139], v[32:35]
    v_mfma_f32_16x16x32_bf16 v[32:35], v[164:167], v[140:143], v[32:35]
    s_waitcnt lgkmcnt(0)
    s_barrier
    v_mfma_f32_16x16x32_bf16 v[24:27], v[176:179], v[128:131], v[24:27]
    ds_read_b128 v[144:147], v226 offset:32768
    ds_read_b64_tr_b16 v[166:167], v228 offset:45056
    s_xor_b32 s91, s91, 131072
    v_mfma_f32_16x16x32_bf16 v[24:27], v[180:183], v[132:135], v[24:27]
    ds_read_b64_tr_b16 v[160:161], v228 offset:32768
    ds_read_b64_tr_b16 v[170:171], v229 offset:36864
    buffer_load_dwordx4 v[80:83], v249, s[28:31], s91 offen offset:0 sc1
    v_mfma_f32_16x16x32_bf16 v[28:31], v[184:187], v[128:131], v[28:31]
    ds_read_b64_tr_b16 v[162:163], v228 offset:36864
    ds_read_b64_tr_b16 v[174:175], v229 offset:45056
    v_mfma_f32_16x16x32_bf16 v[28:31], v[188:191], v[132:135], v[28:31]
    ds_read_b128 v[148:151], v226 offset:40960
    buffer_load_dwordx4 v[88:91], v249, s[28:31], s91 offen offset:2048 sc1
    v_mfma_f32_16x16x32_bf16 v[44:47], v[184:187], v[136:139], v[44:47]
    ds_read_b64_tr_b16 v[164:165], v228 offset:40960
    v_mfma_f32_16x16x32_bf16 v[44:47], v[188:191], v[140:143], v[44:47]
    ds_read_b64_tr_b16 v[168:169], v229 offset:32768
    buffer_load_dwordx4 v[84:87], v249, s[28:31], s91 offen offset:1024 sc1
    v_mfma_f32_16x16x32_bf16 v[40:43], v[176:179], v[136:139], v[40:43]
    ds_read_b64_tr_b16 v[172:173], v229 offset:40960
    ds_read_b64_tr_b16 v[178:179], v230 offset:36864
    v_mfma_f32_16x16x32_bf16 v[40:43], v[180:183], v[140:143], v[40:43]
    ds_read_b128 v[152:155], v226 offset:33792
    ds_read_b64_tr_b16 v[180:181], v230 offset:40960
    buffer_load_dwordx4 v[92:95], v249, s[28:31], s91 offen offset:3072 sc1
    s_waitcnt lgkmcnt(6)
    v_mfma_f32_16x16x32_bf16 v[16:19], v[160:163], v[144:147], v[16:19]
    ds_read_b128 v[156:159], v226 offset:41984
    ds_read_b64_tr_b16 v[182:183], v230 offset:45056
    s_waitcnt lgkmcnt(7)
    v_mfma_f32_16x16x32_bf16 v[16:19], v[164:167], v[148:151], v[16:19]
    ds_read_b64_tr_b16 v[184:185], v231 offset:32768
    s_waitcnt lgkmcnt(7)
    v_mfma_f32_16x16x32_bf16 v[20:23], v[168:171], v[144:147], v[20:23]
    ds_read_b64_tr_b16 v[186:187], v231 offset:36864
    s_waitcnt lgkmcnt(6)
    v_mfma_f32_16x16x32_bf16 v[20:23], v[172:175], v[148:151], v[20:23]
    ds_read_b64_tr_b16 v[188:189], v231 offset:40960
    s_waitcnt lgkmcnt(5)
    v_mfma_f32_16x16x32_bf16 v[36:39], v[168:171], v[152:155], v[36:39]
    ds_read_b64_tr_b16 v[190:191], v231 offset:45056
    s_waitcnt lgkmcnt(4)
    v_mfma_f32_16x16x32_bf16 v[36:39], v[172:175], v[156:159], v[36:39]
    ds_read_b64_tr_b16 v[176:177], v230 offset:32768
    v_mfma_f32_16x16x32_bf16 v[32:35], v[160:163], v[152:155], v[32:35]
    v_mfma_f32_16x16x32_bf16 v[32:35], v[164:167], v[156:159], v[32:35]
    s_waitcnt lgkmcnt(0)
    s_barrier
    v_mfma_f32_16x16x32_bf16 v[24:27], v[176:179], v[144:147], v[24:27]
    ds_read_b128 v[128:131], v239 offset:0
    ds_read_b64_tr_b16 v[166:167], v241 offset:12288
    v_mfma_f32_16x16x32_bf16 v[24:27], v[180:183], v[148:151], v[24:27]
    ds_read_b64_tr_b16 v[160:161], v241 offset:0
    ds_read_b64_tr_b16 v[170:171], v242 offset:4096
    v_mfma_f32_16x16x32_bf16 v[28:31], v[184:187], v[144:147], v[28:31]
    ds_read_b64_tr_b16 v[162:163], v241 offset:4096
    ds_read_b64_tr_b16 v[174:175], v242 offset:12288
    v_mfma_f32_16x16x32_bf16 v[28:31], v[188:191], v[148:151], v[28:31]
    ds_read_b128 v[132:135], v239 offset:8192
    v_mfma_f32_16x16x32_bf16 v[44:47], v[184:187], v[152:155], v[44:47]
    ds_read_b64_tr_b16 v[164:165], v241 offset:8192
    v_mfma_f32_16x16x32_bf16 v[44:47], v[188:191], v[156:159], v[44:47]
    ds_read_b64_tr_b16 v[168:169], v242 offset:0
    v_mfma_f32_16x16x32_bf16 v[40:43], v[176:179], v[152:155], v[40:43]
    ds_read_b64_tr_b16 v[172:173], v242 offset:8192
    ds_read_b64_tr_b16 v[178:179], v243 offset:4096
    v_mfma_f32_16x16x32_bf16 v[40:43], v[180:183], v[156:159], v[40:43]
    ds_read_b128 v[136:139], v239 offset:1024
    ds_read_b64_tr_b16 v[180:181], v243 offset:8192
    s_waitcnt lgkmcnt(6)
    v_mfma_f32_16x16x32_bf16 v[16:19], v[160:163], v[128:131], v[16:19]
    ds_read_b128 v[140:143], v239 offset:9216
    ds_read_b64_tr_b16 v[182:183], v243 offset:12288
    s_waitcnt lgkmcnt(7)
    v_mfma_f32_16x16x32_bf16 v[16:19], v[164:167], v[132:135], v[16:19]
    ds_read_b64_tr_b16 v[184:185], v244 offset:0
    s_waitcnt lgkmcnt(7)
    v_mfma_f32_16x16x32_bf16 v[20:23], v[168:171], v[128:131], v[20:23]
    ds_read_b64_tr_b16 v[186:187], v244 offset:4096
    s_waitcnt lgkmcnt(6)
    v_mfma_f32_16x16x32_bf16 v[20:23], v[172:175], v[132:135], v[20:23]
    ds_read_b64_tr_b16 v[188:189], v244 offset:8192
    s_waitcnt lgkmcnt(5)
    v_mfma_f32_16x16x32_bf16 v[36:39], v[168:171], v[136:139], v[36:39]
    ds_read_b64_tr_b16 v[190:191], v244 offset:12288
    s_waitcnt lgkmcnt(4)
    v_mfma_f32_16x16x32_bf16 v[36:39], v[172:175], v[140:143], v[36:39]
    ds_read_b64_tr_b16 v[176:177], v243 offset:0
    v_mfma_f32_16x16x32_bf16 v[32:35], v[160:163], v[136:139], v[32:35]
    v_mfma_f32_16x16x32_bf16 v[32:35], v[164:167], v[140:143], v[32:35]
    s_waitcnt lgkmcnt(0)
    s_barrier
    v_mfma_f32_16x16x32_bf16 v[24:27], v[176:179], v[128:131], v[24:27]
    ds_read_b128 v[144:147], v239 offset:32768
    ds_read_b64_tr_b16 v[166:167], v241 offset:45056
    v_mfma_f32_16x16x32_bf16 v[24:27], v[180:183], v[132:135], v[24:27]
    ds_read_b64_tr_b16 v[160:161], v241 offset:32768
    ds_read_b64_tr_b16 v[170:171], v242 offset:36864
    v_mfma_f32_16x16x32_bf16 v[28:31], v[184:187], v[128:131], v[28:31]
    ds_read_b64_tr_b16 v[162:163], v241 offset:36864
    ds_read_b64_tr_b16 v[174:175], v242 offset:45056
    v_mfma_f32_16x16x32_bf16 v[28:31], v[188:191], v[132:135], v[28:31]
    ds_read_b128 v[148:151], v239 offset:40960
    v_mfma_f32_16x16x32_bf16 v[44:47], v[184:187], v[136:139], v[44:47]
    ds_read_b64_tr_b16 v[164:165], v241 offset:40960
    v_mfma_f32_16x16x32_bf16 v[44:47], v[188:191], v[140:143], v[44:47]
    ds_read_b64_tr_b16 v[168:169], v242 offset:32768
    v_mfma_f32_16x16x32_bf16 v[40:43], v[176:179], v[136:139], v[40:43]
    ds_read_b64_tr_b16 v[172:173], v242 offset:40960
    v_mfma_f32_16x16x32_bf16 v[40:43], v[180:183], v[140:143], v[40:43]
    ds_read_b128 v[152:155], v239 offset:33792
    s_waitcnt lgkmcnt(4)
    v_mfma_f32_16x16x32_bf16 v[16:19], v[160:163], v[144:147], v[16:19]
    ds_read_b128 v[156:159], v239 offset:41984
    s_waitcnt lgkmcnt(4)
    v_mfma_f32_16x16x32_bf16 v[16:19], v[164:167], v[148:151], v[16:19]
    ds_read_b64_tr_b16 v[184:185], v244 offset:32768
    s_waitcnt lgkmcnt(4)
    v_mfma_f32_16x16x32_bf16 v[20:23], v[168:171], v[144:147], v[20:23]
    ds_read_b64_tr_b16 v[186:187], v244 offset:36864
    s_waitcnt lgkmcnt(4)
    v_mfma_f32_16x16x32_bf16 v[20:23], v[172:175], v[148:151], v[20:23]
    ds_read_b64_tr_b16 v[188:189], v244 offset:40960
    s_waitcnt lgkmcnt(4)
    v_mfma_f32_16x16x32_bf16 v[36:39], v[168:171], v[152:155], v[36:39]
    ds_read_b64_tr_b16 v[190:191], v244 offset:45056
    s_waitcnt lgkmcnt(4)
    v_mfma_f32_16x16x32_bf16 v[36:39], v[172:175], v[156:159], v[36:39]
    ds_read_b64_tr_b16 v[176:177], v243 offset:32768
    v_mfma_f32_16x16x32_bf16 v[32:35], v[160:163], v[152:155], v[32:35]
    ds_read_b64_tr_b16 v[178:179], v243 offset:36864
    v_mfma_f32_16x16x32_bf16 v[32:35], v[164:167], v[156:159], v[32:35]
    ds_read_b64_tr_b16 v[180:181], v243 offset:40960
    s_waitcnt vmcnt(0)
    v_mfma_f32_16x16x32_bf16 v[16:19], v[218:221], v[80:83], v[16:19]
    ds_read_b64_tr_b16 v[182:183], v243 offset:45056
    v_mfma_f32_16x16x32_bf16 v[20:23], v[216:219], v[80:83], v[20:23]
    v_mfma_f32_16x16x32_bf16 v[36:39], v[216:219], v[88:91], v[36:39]
    v_mfma_f32_16x16x32_bf16 v[32:35], v[218:221], v[88:91], v[32:35]
    v_mfma_f32_16x16x32_bf16 v[24:27], v[218:221], v[84:87], v[24:27]
    v_mfma_f32_16x16x32_bf16 v[28:31], v[216:219], v[84:87], v[28:31]
    v_mfma_f32_16x16x32_bf16 v[44:47], v[216:219], v[92:95], v[44:47]
    v_mfma_f32_16x16x32_bf16 v[40:43], v[218:221], v[92:95], v[40:43]
    s_waitcnt lgkmcnt(0)
    v_mfma_f32_16x16x32_bf16 v[24:27], v[176:179], v[144:147], v[24:27]
    v_mfma_f32_16x16x32_bf16 v[24:27], v[180:183], v[148:151], v[24:27]
    v_cvt_pk_bf16_f32 v16, v16, v17
    v_cvt_pk_bf16_f32 v17, v18, v19
    v_mfma_f32_16x16x32_bf16 v[28:31], v[184:187], v[144:147], v[28:31]
    v_cvt_pk_bf16_f32 v18, v20, v21
    v_cvt_pk_bf16_f32 v19, v22, v23
    v_mfma_f32_16x16x32_bf16 v[28:31], v[188:191], v[148:151], v[28:31]
    v_cvt_pk_bf16_f32 v32, v32, v33
    v_cvt_pk_bf16_f32 v33, v34, v35
    v_mfma_f32_16x16x32_bf16 v[44:47], v[184:187], v[152:155], v[44:47]
    v_cvt_pk_bf16_f32 v34, v36, v37
    v_cvt_pk_bf16_f32 v35, v38, v39
    v_mfma_f32_16x16x32_bf16 v[44:47], v[188:191], v[156:159], v[44:47]
    v_permlane16_swap_b32 v16, v18
    v_permlane16_swap_b32_e64 v17, v19
    v_mfma_f32_16x16x32_bf16 v[40:43], v[176:179], v[152:155], v[40:43]
    ds_write_b128 v9, v[16:19] offset:0
    v_permlane16_swap_b32_e64 v32, v34
    v_mfma_f32_16x16x32_bf16 v[40:43], v[180:183], v[156:159], v[40:43]
    v_permlane16_swap_b32_e64 v33, v35
    ds_write_b128 v9, v[32:35] offset:2304
    v_cvt_pk_bf16_f32 v24, v24, v25
    v_cvt_pk_bf16_f32 v25, v26, v27
    v_cvt_pk_bf16_f32 v26, v28, v29
    v_cvt_pk_bf16_f32 v27, v30, v31
    s_nop 1
    v_cvt_pk_bf16_f32 v40, v40, v41
    v_cvt_pk_bf16_f32 v41, v42, v43
    v_permlane16_swap_b32 v24, v26
    v_permlane16_swap_b32_e64 v25, v27
    ds_write_b128 v9, v[24:27] offset:64
    ds_read_b128 v[48:51], v11 offset:0
    ds_read_b128 v[52:55], v11 offset:1152
    v_cvt_pk_bf16_f32 v42, v44, v45
    v_cvt_pk_bf16_f32 v43, v46, v47
    s_nop 0
    v_permlane16_swap_b32 v40, v42
    v_permlane16_swap_b32_e64 v41, v43
    ds_write_b128 v9, v[40:43] offset:2368
    ds_read_b128 v[56:59], v11 offset:2304
    ds_read_b128 v[60:63], v11 offset:3456
    s_waitcnt lgkmcnt(4)
    buffer_store_dwordx4 v[48:51], v10, s[32:35], s78 offen sc1
    s_waitcnt lgkmcnt(3)
    buffer_store_dwordx4 v[52:55], v12, s[32:35], s78 offen sc1
    s_waitcnt lgkmcnt(1)
    buffer_store_dwordx4 v[56:59], v10, s[32:35], s79 offen sc1
    s_waitcnt lgkmcnt(0)
    buffer_store_dwordx4 v[60:63], v12, s[32:35], s79 offen sc1
L_end:
    s_endpgm
.section .rodata,"a"
.p2align 6
.amdhsa_kernel gated_mix__linear_kernel_hedgehog__dense_activation_mish__prompt_kernel
  .amdhsa_next_free_vgpr 256
  .amdhsa_next_free_sgpr 102
  .amdhsa_accum_offset 256
  .amdhsa_group_segment_fixed_size 0
  .amdhsa_kernarg_size 96
  .amdhsa_user_sgpr_count 2
  .amdhsa_user_sgpr_kernarg_segment_ptr 1
  .amdhsa_system_sgpr_workgroup_id_x 1
.end_amdhsa_kernel
```
